```python
import torch

def _softmax(x, axis=-1):
    return torch.softmax(x, dim=axis)
def _gelu(x):
    return torch.nn.functional.gelu(x, approximate="tanh")
def _silu(x):
    return torch.nn.functional.silu(x)
def _sigmoid(x):
    return torch.sigmoid(x)
def _layernorm(x, axis=-1, eps=1e-5):
    m = x.mean(dim=axis, keepdim=True)
    v = x.var(dim=axis, keepdim=True, unbiased=False)
    return (x - m) / torch.sqrt(v + eps)
def _scatter_add(tgt, idx, src, axis=0):
    return tgt.clone().index_add_(axis, idx, src)
def _segment_sum(src, seg, n):
    out = torch.zeros((n,) + src.shape[1:], dtype=src.dtype)
    return out.index_add_(0, seg, src)
def _pad(x, pw):
    flat = tuple(v for pair in reversed(pw) for v in pair)
    return torch.nn.functional.pad(x, flat)

kernel_name = 'sequential_preLN__sliding_local_dilated__glu_gated_geglu__prompt'

def setup_inputs():

    _w = (lambda a: (lambda t: t.to(torch.bfloat16) if t.is_floating_point() else t)(torch.as_tensor(a)))
    def _A_setup():
        B, S, D = 1, 2048, 576
        return {
            "x": _w((lambda *s: torch.randn(*s, dtype=torch.bfloat16) * 0.05)(B, S, D)),
            "wqkv": _w((lambda *s: torch.randn(*s, dtype=torch.bfloat16) * 0.05)(D, 3 * D)),
            "wo": _w((lambda *s: torch.randn(*s, dtype=torch.bfloat16) * 0.05)(D, D)),
        }
    _A_in = _A_setup()

    def _B_setup():
        B, S, Dm, Df = 1, 2048, 576, 4608
        return {
            "x": _w((lambda *s: torch.randn(*s, dtype=torch.bfloat16) * 0.05)(B, S, Dm)),
            "w_gate": _w((lambda *s: torch.randn(*s, dtype=torch.bfloat16) * 0.8)(Dm, Df) * (Dm ** -0.5)),
            "w_up": _w((lambda *s: torch.randn(*s, dtype=torch.bfloat16) * 0.8)(Dm, Df) * (Dm ** -0.5)),
            "w_down": _w((lambda *s: torch.randn(*s, dtype=torch.bfloat16) * 0.8)(Df, Dm) * (Df ** -0.5)),
        }
    _B_in = _B_setup()

    return {
        "A_x": _A_in["x"],
        "A_wqkv": _A_in["wqkv"],
        "A_wo": _A_in["wo"],
        "B_x": _B_in["x"],
        "B_w_gate": _B_in["w_gate"],
        "B_w_up": _B_in["w_up"],
        "B_w_down": _B_in["w_down"],
    }

def reference(A_x, A_wqkv, A_wo, B_x, B_w_gate, B_w_up, B_w_down):
    def _A_ref(x, wqkv, wo):
        B, S, D = x.shape
        H = 32; Dh = D // H
        W, dil = 8, 2
        qkv = (lambda x, *d: x.permute(*d))((x @ wqkv).reshape(B, S, 3, H, Dh), 2, 0, 3, 1, 4)
        q, k, v = qkv[0], qkv[1], qkv[2]
        scale = Dh ** -0.5
        pos = torch.arange(S)
        off = torch.arange(W) * dil
        idx = pos[:, None] - off[None, :]
        mask = idx >= 0
        idx_c = torch.where(mask, idx, 0).reshape(-1)
        kg = k[:, :, idx_c, :].reshape(B, H, S, W, Dh)
        vg = v[:, :, idx_c, :].reshape(B, H, S, W, Dh)
        logits = torch.einsum("bhsd,bhswd->bhsw", q, kg) * scale
        logits = torch.where(mask[None, None, :, :], logits, -1e9)
        attn = _softmax(logits, axis=-1)
        o = torch.einsum("bhsw,bhswd->bhsd", attn, vg)
        return (lambda x, *d: x.permute(*d))(o, 0, 2, 1, 3).reshape(B, S, D) @ wo

    def _B_ref(x, w_gate, w_up, w_down):
        g = torch.einsum("bsd,df->bsf", x, w_gate)
        u = torch.einsum("bsd,df->bsf", x, w_up)
        h = _gelu(g) * u
        return torch.einsum("bsf,fd->bsd", h, w_down)

    x = A_x
    h = x + _A_ref(_layernorm(x, axis=-1), A_wqkv, A_wo)
    h2 = h + _B_ref(_layernorm(h, axis=-1), B_w_gate, B_w_up, B_w_down)
    return h2
```

```asm
; @launch grid=(256,1,1) block=(256,1,1) lds=158720
.amdgcn_target "amdgcn-amd-amdhsa--gfx950"
.text
.globl sequential_preLN__sliding_local_dilated__glu_gated_geglu__prompt_kernel
.p2align 8
.type sequential_preLN__sliding_local_dilated__glu_gated_geglu__prompt_kernel,@function
sequential_preLN__sliding_local_dilated__glu_gated_geglu__prompt_kernel:
s_cmp_ge_u32 s2, 256
s_cbranch_scc1 L_sequential_preLN__sliding_local_dilated__glu_gated_geglu__prompt_kernel_end
s_load_dwordx2 s[100:101], s[0:1], 64
s_load_dwordx4 s[4:7], s[0:1], 0
s_load_dwordx2 s[34:35], s[0:1], 72
s_load_dwordx2 s[96:97], s[0:1], 16
s_load_dwordx2 s[98:99], s[0:1], 32
v_lshrrev_b32 v1, 6, v0
v_and_b32 v0, 63, v0
v_readfirstlane_b32 s20, v1
s_and_b32 s21, s2, 1
s_lshl_b32 s21, s21, 2
s_bfe_u32 s28, s2, 0x20003
s_add_u32 s21, s21, s28
s_bfe_u32 s22, s2, 0x20001
s_lshl_b32 s22, s22, 3
s_lshr_b32 s28, s2, 5
s_add_u32 s22, s22, s28
v_lshrrev_b32 v1, 3, v0
v_and_b32 v27, 7, v0
s_and_b32 s28, s20, 1
s_lshl_b32 s28, s28, 2
v_lshrrev_b32 v28, 1, v1
v_add_u32 v28, s28, v28
v_xor_b32 v28, v28, v27
v_lshlrev_b32 v28, 4, v28
v_mul_u32_u24 v29, 1152, v1
v_add_u32 v14, v28, v29
s_waitcnt lgkmcnt(0)
s_mov_b32 s8, s4
s_mov_b32 s9, s5
s_mov_b32 s10, 0x240000
s_mov_b32 s11, 0x20000
s_mov_b32 s12, s6
s_mov_b32 s13, s7
s_mov_b32 s14, 0x1e6000
s_mov_b32 s15, 0x20000
s_mov_b32 s16, s34
s_mov_b32 s17, s35
s_mov_b32 s18, 0x2b40000
s_mov_b32 s19, 0x20000
s_cmp_lg_u32 s2, 0
s_cbranch_scc1 L_sequential_preLN__sliding_local_dilated__glu_gated_geglu__prompt_kernel_p0_noinit
s_lshl_b32 s50, s20, 6
v_add_u32 v30, s50, v0
v_mov_b32 v40, 0
v_mov_b32 v41, 0
v_mov_b32 v42, 0
v_mov_b32 v43, 0
v_lshlrev_b32 v31, 4, v30
s_mov_b32 s50, 0x4b0000
buffer_store_dwordx4 v[40:43], v31, s[16:19], s50 offen sc1
v_lshlrev_b32 v31, 8, v30
v_cmp_gt_u32 vcc, 160, v30
v_mov_b32 v32, 0x7fff0000
s_mov_b32 s50, 0x4b2000
v_cndmask_b32 v31, v32, v31, vcc
buffer_store_dword v40, v31, s[16:19], s50 offen sc1
L_sequential_preLN__sliding_local_dilated__glu_gated_geglu__prompt_kernel_p0_noinit:
s_add_u32 s28, s20, 0
s_lshl_b32 s29, s22, 3
s_add_u32 s29, s29, s28
s_sub_u32 s29, s29, 2
s_max_i32 s29, s29, 0
s_mul_i32 s29, s29, 9216
s_mul_i32 s28, s28, 9216
s_add_u32 m0, s28, 0
s_add_u32 s36, s29, 0
buffer_load_dwordx4 v14, s[8:11], s36 offen lds
s_lshl_b32 s31, s20, 6
s_add_u32 s31, s31, 0
v_add_u32 v27, s31, v0
v_mul_u32_u24 v28, 7282, v27
s_add_u32 m0, s28, 1024
s_add_u32 s36, s29, 128
buffer_load_dwordx4 v14, s[8:11], s36 offen lds
v_lshrrev_b32 v28, 16, v28
v_mul_u32_u24 v29, 9, v28
v_sub_u32 v29, v27, v29
v_lshrrev_b32 v30, 5, v28
s_add_u32 m0, s28, 2048
s_add_u32 s36, s29, 256
buffer_load_dwordx4 v14, s[8:11], s36 offen lds
v_and_b32 v28, 31, v28
v_mul_u32_u24 v30, 1152, v30
v_lshl_add_u32 v29, v29, 4, v30
v_mul_u32_u24 v28, 3456, v28
s_add_u32 m0, s28, 3072
s_add_u32 s36, s29, 384
buffer_load_dwordx4 v14, s[8:11], s36 offen lds
v_add_u32 v10, v29, v28
v_cmp_le_u32 vcc, 864, v27
v_mov_b32 v30, 0x7fff0000
s_nop 0
v_cndmask_b32 v10, v10, v30, vcc
s_lshl_b32 s31, s20, 6
s_add_u32 s31, s31, 256
s_add_u32 m0, s28, 4096
s_add_u32 s36, s29, 512
buffer_load_dwordx4 v14, s[8:11], s36 offen lds
v_add_u32 v27, s31, v0
v_mul_u32_u24 v28, 7282, v27
v_lshrrev_b32 v28, 16, v28
v_mul_u32_u24 v29, 9, v28
s_add_u32 m0, s28, 5120
s_add_u32 s36, s29, 640
buffer_load_dwordx4 v14, s[8:11], s36 offen lds
v_sub_u32 v29, v27, v29
v_lshrrev_b32 v30, 5, v28
v_and_b32 v28, 31, v28
v_mul_u32_u24 v30, 1152, v30
s_add_u32 m0, s28, 6144
s_add_u32 s36, s29, 768
buffer_load_dwordx4 v14, s[8:11], s36 offen lds
v_lshl_add_u32 v29, v29, 4, v30
v_mul_u32_u24 v28, 3456, v28
v_add_u32 v11, v29, v28
v_cmp_le_u32 vcc, 864, v27
v_mov_b32 v30, 0x7fff0000
s_nop 0
v_cndmask_b32 v11, v11, v30, vcc
s_add_u32 m0, s28, 7168
s_add_u32 s36, s29, 896
buffer_load_dwordx4 v14, s[8:11], s36 offen lds
s_lshl_b32 s31, s20, 6
s_add_u32 s31, s31, 512
v_add_u32 v27, s31, v0
v_mul_u32_u24 v28, 7282, v27
s_add_u32 m0, s28, 8192
s_add_u32 s36, s29, 1024
buffer_load_dwordx4 v14, s[8:11], s36 offen lds
v_lshrrev_b32 v28, 16, v28
v_mul_u32_u24 v29, 9, v28
v_sub_u32 v29, v27, v29
v_lshrrev_b32 v30, 5, v28
s_add_u32 s28, s20, 4
s_lshl_b32 s29, s22, 3
s_add_u32 s29, s29, s28
s_sub_u32 s29, s29, 2
s_max_i32 s29, s29, 0
s_mul_i32 s29, s29, 9216
s_mul_i32 s28, s28, 9216
s_add_u32 m0, s28, 0
s_add_u32 s36, s29, 0
buffer_load_dwordx4 v14, s[8:11], s36 offen lds
v_and_b32 v28, 31, v28
v_mul_u32_u24 v30, 1152, v30
v_lshl_add_u32 v29, v29, 4, v30
v_mul_u32_u24 v28, 3456, v28
s_add_u32 m0, s28, 1024
s_add_u32 s36, s29, 128
buffer_load_dwordx4 v14, s[8:11], s36 offen lds
v_add_u32 v12, v29, v28
v_cmp_le_u32 vcc, 864, v27
v_mov_b32 v30, 0x7fff0000
s_nop 0
v_cndmask_b32 v12, v12, v30, vcc
s_lshl_b32 s31, s20, 6
s_add_u32 s31, s31, 768
s_add_u32 m0, s28, 2048
s_add_u32 s36, s29, 256
buffer_load_dwordx4 v14, s[8:11], s36 offen lds
v_add_u32 v27, s31, v0
v_mul_u32_u24 v28, 7282, v27
v_lshrrev_b32 v28, 16, v28
v_mul_u32_u24 v29, 9, v28
s_add_u32 m0, s28, 3072
s_add_u32 s36, s29, 384
buffer_load_dwordx4 v14, s[8:11], s36 offen lds
v_sub_u32 v29, v27, v29
v_lshrrev_b32 v30, 5, v28
v_and_b32 v28, 31, v28
v_mul_u32_u24 v30, 1152, v30
s_add_u32 m0, s28, 4096
s_add_u32 s36, s29, 512
buffer_load_dwordx4 v14, s[8:11], s36 offen lds
v_lshl_add_u32 v29, v29, 4, v30
v_mul_u32_u24 v28, 3456, v28
v_add_u32 v13, v29, v28
v_cmp_le_u32 vcc, 864, v27
v_mov_b32 v30, 0x7fff0000
s_nop 0
v_cndmask_b32 v13, v13, v30, vcc
s_add_u32 m0, s28, 5120
s_add_u32 s36, s29, 640
buffer_load_dwordx4 v14, s[8:11], s36 offen lds
s_add_u32 m0, s28, 6144
s_add_u32 s36, s29, 768
buffer_load_dwordx4 v14, s[8:11], s36 offen lds
s_add_u32 m0, s28, 7168
s_add_u32 s36, s29, 896
buffer_load_dwordx4 v14, s[8:11], s36 offen lds
s_add_u32 m0, s28, 8192
s_add_u32 s36, s29, 1024
buffer_load_dwordx4 v14, s[8:11], s36 offen lds
s_cmp_ge_u32 s20, 2
s_cbranch_scc1 L_sequential_preLN__sliding_local_dilated__glu_gated_geglu__prompt_kernel_p0_nox
s_add_u32 s28, s20, 8
s_lshl_b32 s29, s22, 3
s_add_u32 s29, s29, s28
s_sub_u32 s29, s29, 2
s_max_i32 s29, s29, 0
s_mul_i32 s29, s29, 9216
s_mul_i32 s28, s28, 9216
s_add_u32 m0, s28, 0
s_add_u32 s36, s29, 0
buffer_load_dwordx4 v14, s[8:11], s36 offen lds
s_add_u32 m0, s28, 1024
s_add_u32 s36, s29, 128
buffer_load_dwordx4 v14, s[8:11], s36 offen lds
s_add_u32 m0, s28, 2048
s_add_u32 s36, s29, 256
buffer_load_dwordx4 v14, s[8:11], s36 offen lds
s_add_u32 m0, s28, 3072
s_add_u32 s36, s29, 384
buffer_load_dwordx4 v14, s[8:11], s36 offen lds
s_add_u32 m0, s28, 4096
s_add_u32 s36, s29, 512
buffer_load_dwordx4 v14, s[8:11], s36 offen lds
s_add_u32 m0, s28, 5120
s_add_u32 s36, s29, 640
buffer_load_dwordx4 v14, s[8:11], s36 offen lds
s_add_u32 m0, s28, 6144
s_add_u32 s36, s29, 768
buffer_load_dwordx4 v14, s[8:11], s36 offen lds
s_add_u32 m0, s28, 7168
s_add_u32 s36, s29, 896
buffer_load_dwordx4 v14, s[8:11], s36 offen lds
s_add_u32 m0, s28, 8192
s_add_u32 s36, s29, 1024
buffer_load_dwordx4 v14, s[8:11], s36 offen lds
L_sequential_preLN__sliding_local_dilated__glu_gated_geglu__prompt_kernel_p0_nox:
s_mul_i32 s27, s21, 144
s_lshl_b32 s26, s20, 10
s_add_u32 s26, s26, 92160
s_add_u32 m0, s26, 0
s_add_u32 s28, s27, 0
buffer_load_dwordx4 v10, s[12:15], s28 offen lds
v_and_b32 v32, 15, v0
v_lshrrev_b32 v33, 4, v0
v_lshrrev_b32 v28, 3, v32
v_mul_u32_u24 v28, 9216, v28
v_and_b32 v29, 7, v32
v_lshl_add_u32 v28, v29, 7, v28
v_lshrrev_b32 v29, 1, v32
v_add_u32 v30, 0, v33
v_xor_b32 v30, v30, v29
v_lshl_add_u32 v2, v30, 4, v28
v_add_u32 v4, 73728, v2
v_add_u32 v30, 4, v33
v_xor_b32 v30, v30, v29
v_lshl_add_u32 v3, v30, 4, v28
v_add_u32 v5, 73728, v3
v_bfe_u32 v29, v0, 2, 2
v_lshl_add_u32 v29, v33, 3, v29
v_mul_u32_u24 v29, 144, v29
s_add_u32 m0, s26, 4096
s_nop 0
buffer_load_dwordx4 v11, s[12:15], s28 offen lds
v_add_u32 v29, 92160, v29
v_and_b32 v28, 3, v0
v_lshlrev_b32 v28, 2, v28
s_lshl_b32 s31, s20, 6
s_add_u32 s31, s31, 0
v_add_u32 v30, s31, v28
v_min_u32 v30, 212, v30
v_mul_u32_u24 v31, 911, v30
v_lshrrev_b32 v31, 16, v31
v_mul_u32_u24 v31, 4464, v31
v_lshl_add_u32 v30, v30, 1, v31
v_add_u32 v20, v30, v29
s_lshl_b32 s31, s20, 6
s_add_u32 s31, s31, 16
v_add_u32 v30, s31, v28
v_min_u32 v30, 212, v30
v_mul_u32_u24 v31, 911, v30
v_lshrrev_b32 v31, 16, v31
s_add_u32 m0, s26, 8192
s_nop 0
buffer_load_dwordx4 v12, s[12:15], s28 offen lds
v_mul_u32_u24 v31, 4464, v31
v_lshl_add_u32 v30, v30, 1, v31
v_add_u32 v21, v30, v29
s_lshl_b32 s31, s20, 6
s_add_u32 s31, s31, 32
v_add_u32 v30, s31, v28
v_min_u32 v30, 212, v30
v_mul_u32_u24 v31, 911, v30
v_lshrrev_b32 v31, 16, v31
v_mul_u32_u24 v31, 4464, v31
v_lshl_add_u32 v30, v30, 1, v31
v_add_u32 v22, v30, v29
s_lshl_b32 s31, s20, 6
s_add_u32 s31, s31, 48
v_add_u32 v30, s31, v28
v_min_u32 v30, 212, v30
v_mul_u32_u24 v31, 911, v30
v_lshrrev_b32 v31, 16, v31
s_add_u32 m0, s26, 12288
s_nop 0
buffer_load_dwordx4 v13, s[12:15], s28 offen lds
v_mul_u32_u24 v31, 4464, v31
v_lshl_add_u32 v30, v30, 1, v31
v_add_u32 v23, v30, v29
v_mov_b32 v16, 0x3f803f80
v_mov_b32 v17, 0x3f803f80
v_mov_b32 v18, 0x3f803f80
v_mov_b32 v19, 0x3f803f80
v_cmp_eq_u32 s[32:33], 0, v32
s_lshl_b32 s31, s20, 6
s_add_u32 s31, s31, 0
v_lshl_add_u32 v28, v33, 2, s31
v_mul_u32_u24 v29, 3641, v28
v_lshrrev_b32 v29, 16, v29
v_mul_u32_u24 v30, 18, v29
v_sub_u32 v30, v28, v30
v_min_u32 v29, 12, v29
v_mul_u32_u24 v29, 3200, v29
v_lshl_add_u32 v29, v30, 1, v29
s_add_u32 m0, s26, 16384
s_add_u32 s28, s27, 110592
buffer_load_dwordx4 v10, s[12:15], s28 offen lds
v_mul_u32_u24 v30, 40, v32
v_add_u32 v192, v29, v30
s_lshl_b32 s31, s20, 6
s_add_u32 s31, s31, 2
v_lshl_add_u32 v28, v33, 2, s31
v_mul_u32_u24 v29, 3641, v28
v_lshrrev_b32 v29, 16, v29
v_mul_u32_u24 v30, 18, v29
v_sub_u32 v30, v28, v30
v_min_u32 v29, 12, v29
v_mul_u32_u24 v29, 3200, v29
v_lshl_add_u32 v29, v30, 1, v29
v_mul_u32_u24 v30, 40, v32
v_add_u32 v193, v29, v30
s_lshl_b32 s31, s20, 6
s_add_u32 s31, s31, 16
v_lshl_add_u32 v28, v33, 2, s31
v_mul_u32_u24 v29, 3641, v28
s_add_u32 m0, s26, 20480
s_nop 0
buffer_load_dwordx4 v11, s[12:15], s28 offen lds
v_lshrrev_b32 v29, 16, v29
v_mul_u32_u24 v30, 18, v29
v_sub_u32 v30, v28, v30
v_min_u32 v29, 12, v29
v_mul_u32_u24 v29, 3200, v29
v_lshl_add_u32 v29, v30, 1, v29
v_mul_u32_u24 v30, 40, v32
v_add_u32 v194, v29, v30
s_lshl_b32 s31, s20, 6
s_add_u32 s31, s31, 18
v_lshl_add_u32 v28, v33, 2, s31
v_mul_u32_u24 v29, 3641, v28
v_lshrrev_b32 v29, 16, v29
v_mul_u32_u24 v30, 18, v29
v_sub_u32 v30, v28, v30
v_min_u32 v29, 12, v29
v_mul_u32_u24 v29, 3200, v29
v_lshl_add_u32 v29, v30, 1, v29
s_add_u32 m0, s26, 24576
s_nop 0
buffer_load_dwordx4 v12, s[12:15], s28 offen lds
v_mul_u32_u24 v30, 40, v32
v_add_u32 v195, v29, v30
s_lshl_b32 s31, s20, 6
s_add_u32 s31, s31, 32
v_lshl_add_u32 v28, v33, 2, s31
v_mul_u32_u24 v29, 3641, v28
v_lshrrev_b32 v29, 16, v29
v_mul_u32_u24 v30, 18, v29
v_sub_u32 v30, v28, v30
v_min_u32 v29, 12, v29
v_mul_u32_u24 v29, 3200, v29
v_lshl_add_u32 v29, v30, 1, v29
v_mul_u32_u24 v30, 40, v32
v_add_u32 v196, v29, v30
s_lshl_b32 s31, s20, 6
s_add_u32 s31, s31, 34
v_lshl_add_u32 v28, v33, 2, s31
v_mul_u32_u24 v29, 3641, v28
s_add_u32 m0, s26, 28672
s_nop 0
buffer_load_dwordx4 v13, s[12:15], s28 offen lds
v_lshrrev_b32 v29, 16, v29
v_mul_u32_u24 v30, 18, v29
v_sub_u32 v30, v28, v30
v_min_u32 v29, 12, v29
v_mul_u32_u24 v29, 3200, v29
v_lshl_add_u32 v29, v30, 1, v29
v_mul_u32_u24 v30, 40, v32
v_add_u32 v197, v29, v30
s_lshl_b32 s31, s20, 6
s_add_u32 s31, s31, 48
v_lshl_add_u32 v28, v33, 2, s31
v_mul_u32_u24 v29, 3641, v28
v_lshrrev_b32 v29, 16, v29
v_mul_u32_u24 v30, 18, v29
v_sub_u32 v30, v28, v30
v_min_u32 v29, 12, v29
v_mul_u32_u24 v29, 3200, v29
v_lshl_add_u32 v29, v30, 1, v29
s_add_u32 m0, s26, 32768
s_add_u32 s28, s27, 221184
buffer_load_dwordx4 v10, s[12:15], s28 offen lds
v_mul_u32_u24 v30, 40, v32
v_add_u32 v198, v29, v30
s_lshl_b32 s31, s20, 6
s_add_u32 s31, s31, 50
v_lshl_add_u32 v28, v33, 2, s31
v_mul_u32_u24 v29, 3641, v28
v_lshrrev_b32 v29, 16, v29
v_mul_u32_u24 v30, 18, v29
v_sub_u32 v30, v28, v30
v_min_u32 v29, 12, v29
v_mul_u32_u24 v29, 3200, v29
v_lshl_add_u32 v29, v30, 1, v29
v_mul_u32_u24 v30, 40, v32
v_add_u32 v199, v29, v30
v_mov_b32 v112, 0
v_mov_b32 v113, 0
v_mov_b32 v114, 0
v_mov_b32 v115, 0
s_add_u32 m0, s26, 36864
s_nop 0
buffer_load_dwordx4 v11, s[12:15], s28 offen lds
v_mov_b32 v116, 0
v_mov_b32 v117, 0
v_mov_b32 v118, 0
v_mov_b32 v119, 0
v_mov_b32 v120, 0
v_mov_b32 v121, 0
v_mov_b32 v122, 0
v_mov_b32 v123, 0
v_mov_b32 v124, 0
v_mov_b32 v125, 0
v_mov_b32 v126, 0
v_mov_b32 v127, 0
v_mov_b32 v128, 0
v_mov_b32 v129, 0
v_mov_b32 v130, 0
v_mov_b32 v131, 0
v_mov_b32 v132, 0
v_mov_b32 v133, 0
s_add_u32 m0, s26, 40960
s_nop 0
buffer_load_dwordx4 v12, s[12:15], s28 offen lds
v_mov_b32 v134, 0
v_mov_b32 v135, 0
v_mov_b32 v136, 0
v_mov_b32 v137, 0
v_mov_b32 v138, 0
v_mov_b32 v139, 0
v_mov_b32 v140, 0
v_mov_b32 v141, 0
v_mov_b32 v142, 0
v_mov_b32 v143, 0
v_mov_b32 v144, 0
v_mov_b32 v145, 0
v_mov_b32 v146, 0
v_mov_b32 v147, 0
v_mov_b32 v148, 0
v_mov_b32 v149, 0
v_mov_b32 v150, 0
v_mov_b32 v151, 0
s_add_u32 m0, s26, 45056
s_nop 0
buffer_load_dwordx4 v13, s[12:15], s28 offen lds
v_mov_b32 v152, 0
v_mov_b32 v153, 0
v_mov_b32 v154, 0
v_mov_b32 v155, 0
v_mov_b32 v156, 0
v_mov_b32 v157, 0
v_mov_b32 v158, 0
v_mov_b32 v159, 0
v_mov_b32 v160, 0
v_mov_b32 v161, 0
v_mov_b32 v162, 0
v_mov_b32 v163, 0
v_mov_b32 v164, 0
v_mov_b32 v165, 0
v_mov_b32 v166, 0
v_mov_b32 v167, 0
v_mov_b32 v168, 0
v_mov_b32 v169, 0
s_add_u32 m0, s26, 49152
s_add_u32 s28, s27, 331776
buffer_load_dwordx4 v10, s[12:15], s28 offen lds
v_mov_b32 v170, 0
v_mov_b32 v171, 0
v_mov_b32 v172, 0
v_mov_b32 v173, 0
v_mov_b32 v174, 0
v_mov_b32 v175, 0
v_mov_b32 v176, 0
v_mov_b32 v177, 0
v_mov_b32 v178, 0
v_mov_b32 v179, 0
v_mov_b32 v180, 0
v_mov_b32 v181, 0
v_mov_b32 v182, 0
v_mov_b32 v183, 0
v_mov_b32 v184, 0
v_mov_b32 v185, 0
v_mov_b32 v186, 0
v_mov_b32 v187, 0
s_add_u32 m0, s26, 53248
s_nop 0
buffer_load_dwordx4 v11, s[12:15], s28 offen lds
v_mov_b32 v188, 0
v_mov_b32 v189, 0
v_mov_b32 v190, 0
v_mov_b32 v191, 0
s_mul_i32 s37, s21, 72
s_lshl_b32 s38, s20, 2
s_add_u32 s37, s37, s38
s_add_u32 s38, s37, 0
s_lshr_b32 s40, s38, 5
s_lshl_b32 s40, s40, 10
s_bfe_u32 s39, s38, 0x20002
s_lshl_b32 s39, s39, 8
s_add_u32 s40, s40, s39
s_bfe_u32 s39, s38, 0x10004
s_lshl_b32 s39, s39, 3
s_add_u32 s40, s40, s39
s_add_u32 s38, s37, 16
s_lshr_b32 s41, s38, 5
s_add_u32 m0, s26, 57344
s_nop 0
buffer_load_dwordx4 v12, s[12:15], s28 offen lds
s_lshl_b32 s41, s41, 10
s_bfe_u32 s39, s38, 0x20002
s_lshl_b32 s39, s39, 8
s_add_u32 s41, s41, s39
s_bfe_u32 s39, s38, 0x10004
s_lshl_b32 s39, s39, 3
s_add_u32 s41, s41, s39
s_add_u32 s38, s37, 32
s_lshr_b32 s42, s38, 5
s_lshl_b32 s42, s42, 10
s_bfe_u32 s39, s38, 0x20002
s_lshl_b32 s39, s39, 8
s_add_u32 s42, s42, s39
s_bfe_u32 s39, s38, 0x10004
s_lshl_b32 s39, s39, 3
s_add_u32 s42, s42, s39
s_add_u32 s38, s37, 48
s_lshr_b32 s43, s38, 5
s_add_u32 m0, s26, 61440
s_nop 0
buffer_load_dwordx4 v13, s[12:15], s28 offen lds
s_lshl_b32 s43, s43, 10
s_bfe_u32 s39, s38, 0x20002
s_lshl_b32 s39, s39, 8
s_add_u32 s43, s43, s39
s_bfe_u32 s39, s38, 0x10004
s_lshl_b32 s39, s39, 3
s_add_u32 s43, s43, s39
s_add_u32 s38, s37, 64
s_lshr_b32 s44, s38, 5
s_lshl_b32 s44, s44, 10
s_bfe_u32 s39, s38, 0x20002
s_lshl_b32 s39, s39, 8
s_add_u32 s44, s44, s39
s_bfe_u32 s39, s38, 0x10004
s_lshl_b32 s39, s39, 3
s_add_u32 s44, s44, s39
s_add_u32 s27, s27, 442368
s_lshr_b32 s60, s2, 3
s_and_b32 s61, s2, 7
s_lshl_b32 s50, s20, 6
v_add_u32 v36, s50, v0
s_getpc_b64 s[52:53]
L_sequential_preLN__sliding_local_dilated__glu_gated_geglu__prompt_kernel_p0_pc:
s_sub_u32 s52, s52, L_sequential_preLN__sliding_local_dilated__glu_gated_geglu__prompt_kernel_p0_pc - sequential_preLN__sliding_local_dilated__glu_gated_geglu__prompt_kernel
s_subb_u32 s53, s53, 0
s_mov_b32 s54, L_text_end - sequential_preLN__sliding_local_dilated__glu_gated_geglu__prompt_kernel
s_mov_b32 s55, 0x20000
s_mul_i32 s50, s60, 14
v_add_u32 v37, s50, v36
v_lshlrev_b32 v37, 7, v37
v_cmp_gt_u32 vcc, 14, v36
v_mov_b32 v38, 0x7fff0000
s_nop 0
v_cndmask_b32 v37, v38, v37, vcc
buffer_load_dword v38, v37, s[52:55], 0 offen
v_mul_u32_u24 v37, 4370, v36
v_lshrrev_b32 v37, 16, v37
v_mul_u32_u24 v39, 15, v37
v_sub_u32 v39, v36, v39
s_mul_i32 s50, s60, 14
s_add_u32 s50, s50, 128
v_add_u32 v37, s50, v37
v_mul_u32_u24 v37, 3456, v37
v_mul_u32_u24 v27, 52, v39
v_lshrrev_b32 v27, 8, v27
v_mul_u32_u24 v28, 5, v27
v_sub_u32 v39, v39, v28
v_mul_u32_u24 v27, 1152, v27
v_add_u32 v37, v37, v27
v_lshl_add_u32 v37, v39, 7, v37
v_cmp_gt_u32 vcc, 210, v36
v_mov_b32 v27, 0x7fff0000
s_and_b32 s50, s61, 1
s_lshl_b32 s50, s50, 9
v_cndmask_b32 v37, v27, v37, vcc
buffer_load_dword v39, v37, s[12:15], s50 offen
s_mov_b32 s52, s96
s_mov_b32 s53, s97
s_lshl_b32 s50, s20, 8
s_add_u32 s62, s50, s2
v_lshlrev_b32 v208, 4, v0
v_add_u32 v209, 1024, v208
v_cmp_gt_u32 vcc, 8, v0
v_mov_b32 v200, 0x7fff0000
s_mul_i32 s51, s62, 1152
v_cndmask_b32 v209, v200, v209, vcc
s_mov_b32 s54, 0xa2000
s_mov_b32 s55, 0x20000
buffer_load_dwordx4 v[200:203], v208, s[52:55], s51 offen
buffer_load_dwordx4 v[204:207], v209, s[52:55], s51 offen
s_waitcnt vmcnt(14)
s_barrier
s_or_b32 s50, s2, s20
s_cmp_lg_u32 s50, 0
s_cbranch_scc1 L_sequential_preLN__sliding_local_dilated__glu_gated_geglu__prompt_kernel_p0_noann
s_mov_b32 s52, s100
s_mov_b32 s53, s101
s_mov_b32 s54, 256
s_mov_b32 s55, 0x20000
v_mov_b32 v30, 1
buffer_store_dword v30, off, s[52:55], 0 sc1
L_sequential_preLN__sliding_local_dilated__glu_gated_geglu__prompt_kernel_p0_noann:
v_mov_b32 v6, v20
v_mov_b32 v7, v21
v_mov_b32 v8, v22
v_mov_b32 v9, v23
ds_read_b128 v[40:43], v2 offset:0
ds_read_b128 v[44:47], v2 offset:18432
ds_read_b128 v[48:51], v2 offset:36864
ds_read_b128 v[52:55], v2 offset:55296
ds_read_b128 v[56:59], v4 offset:0
ds_read_b64_tr_b16 v[80:81], v6 offset:0
ds_read_b64_tr_b16 v[82:83], v6 offset:576
ds_read_b64_tr_b16 v[84:85], v7 offset:0
ds_read_b64_tr_b16 v[86:87], v7 offset:576
ds_read_b64_tr_b16 v[88:89], v8 offset:0
ds_read_b64_tr_b16 v[90:91], v8 offset:576
ds_read_b64_tr_b16 v[92:93], v9 offset:0
ds_read_b64_tr_b16 v[94:95], v9 offset:576
s_mov_b32 s23, 0
s_mov_b32 s30, 9
s_waitcnt lgkmcnt(0)
v_cndmask_b32 v40, v40, v16, s[32:33]
v_cndmask_b32 v41, v41, v16, s[32:33]
v_cndmask_b32 v42, v42, v16, s[32:33]
v_cndmask_b32 v43, v43, v16, s[32:33]
s_cmp_eq_u32 s20, 3
s_cbranch_scc1 L_sequential_preLN__sliding_local_dilated__glu_gated_geglu__prompt_kernel_p0_loop3
.p2align 6
L_sequential_preLN__sliding_local_dilated__glu_gated_geglu__prompt_kernel_p0_loop:
s_waitcnt vmcnt(8)
s_barrier
v_mfma_f32_16x16x32_bf16 v[112:115], v[80:83], v[40:43], v[112:115]
s_lshl_b32 s28, s23, 14
ds_read_b128 v[60:63], v3 offset:0
v_mfma_f32_16x16x32_bf16 v[116:119], v[80:83], v[44:47], v[116:119]
s_add_u32 s25, s26, s28
ds_read_b128 v[64:67], v3 offset:18432
v_mfma_f32_16x16x32_bf16 v[120:123], v[80:83], v[48:51], v[120:123]
s_add_u32 s23, s23, 1
ds_read_b128 v[68:71], v3 offset:36864
v_mfma_f32_16x16x32_bf16 v[124:127], v[80:83], v[52:55], v[124:127]
s_and_b32 s23, s23, 3
ds_read_b128 v[72:75], v3 offset:55296
v_mfma_f32_16x16x32_bf16 v[128:131], v[80:83], v[56:59], v[128:131]
s_lshl_b32 s24, s23, 14
ds_read_b128 v[76:79], v5 offset:0
v_mfma_f32_16x16x32_bf16 v[132:135], v[84:87], v[40:43], v[132:135]
v_add_u32 v6, s24, v20
v_mfma_f32_16x16x32_bf16 v[136:139], v[84:87], v[44:47], v[136:139]
ds_read_b64_tr_b16 v[96:97], v6 offset:0
v_add_u32 v7, s24, v21
v_mfma_f32_16x16x32_bf16 v[140:143], v[84:87], v[48:51], v[140:143]
ds_read_b64_tr_b16 v[98:99], v6 offset:576
v_add_u32 v8, s24, v22
v_mfma_f32_16x16x32_bf16 v[144:147], v[84:87], v[52:55], v[144:147]
ds_read_b64_tr_b16 v[100:101], v7 offset:0
v_add_u32 v9, s24, v23
v_mfma_f32_16x16x32_bf16 v[148:151], v[84:87], v[56:59], v[148:151]
ds_read_b64_tr_b16 v[102:103], v7 offset:576
v_mfma_f32_16x16x32_bf16 v[152:155], v[88:91], v[40:43], v[152:155]
ds_read_b64_tr_b16 v[104:105], v8 offset:0
v_add_u32 v2, 1024, v2
v_mfma_f32_16x16x32_bf16 v[156:159], v[88:91], v[44:47], v[156:159]
ds_read_b64_tr_b16 v[106:107], v8 offset:576
v_add_u32 v4, 1024, v4
v_mfma_f32_16x16x32_bf16 v[160:163], v[88:91], v[48:51], v[160:163]
s_waitcnt lgkmcnt(10)
ds_read_b64_tr_b16 v[108:109], v9 offset:0
v_mfma_f32_16x16x32_bf16 v[164:167], v[88:91], v[52:55], v[164:167]
s_add_u32 m0, s25, 0
ds_read_b64_tr_b16 v[110:111], v9 offset:576
v_mfma_f32_16x16x32_bf16 v[168:171], v[88:91], v[56:59], v[168:171]
buffer_load_dwordx4 v10, s[12:15], s27 offen lds
v_mfma_f32_16x16x32_bf16 v[172:175], v[92:95], v[40:43], v[172:175]
s_add_u32 m0, s25, 4096
v_cndmask_b32 v60, v60, v16, s[32:33]
v_cndmask_b32 v61, v61, v16, s[32:33]
v_mfma_f32_16x16x32_bf16 v[176:179], v[92:95], v[44:47], v[176:179]
buffer_load_dwordx4 v11, s[12:15], s27 offen lds
v_mfma_f32_16x16x32_bf16 v[180:183], v[92:95], v[48:51], v[180:183]
s_add_u32 m0, s25, 8192
v_cndmask_b32 v62, v62, v16, s[32:33]
v_cndmask_b32 v63, v63, v16, s[32:33]
v_mfma_f32_16x16x32_bf16 v[184:187], v[92:95], v[52:55], v[184:187]
buffer_load_dwordx4 v12, s[12:15], s27 offen lds
v_mfma_f32_16x16x32_bf16 v[188:191], v[92:95], v[56:59], v[188:191]
s_add_u32 m0, s25, 12288
s_nop 0
buffer_load_dwordx4 v13, s[12:15], s27 offen lds
s_add_u32 s27, s27, 110592
s_waitcnt lgkmcnt(0)
s_waitcnt vmcnt(8)
s_barrier
v_mfma_f32_16x16x32_bf16 v[112:115], v[96:99], v[60:63], v[112:115]
s_lshl_b32 s28, s23, 14
ds_read_b128 v[40:43], v2 offset:0
v_mfma_f32_16x16x32_bf16 v[116:119], v[96:99], v[64:67], v[116:119]
s_add_u32 s25, s26, s28
ds_read_b128 v[44:47], v2 offset:18432
v_mfma_f32_16x16x32_bf16 v[120:123], v[96:99], v[68:71], v[120:123]
s_add_u32 s23, s23, 1
ds_read_b128 v[48:51], v2 offset:36864
v_mfma_f32_16x16x32_bf16 v[124:127], v[96:99], v[72:75], v[124:127]
s_and_b32 s23, s23, 3
ds_read_b128 v[52:55], v2 offset:55296
v_mfma_f32_16x16x32_bf16 v[128:131], v[96:99], v[76:79], v[128:131]
s_lshl_b32 s24, s23, 14
ds_read_b128 v[56:59], v4 offset:0
v_mfma_f32_16x16x32_bf16 v[132:135], v[100:103], v[60:63], v[132:135]
v_add_u32 v6, s24, v20
v_mfma_f32_16x16x32_bf16 v[136:139], v[100:103], v[64:67], v[136:139]
ds_read_b64_tr_b16 v[80:81], v6 offset:0
v_add_u32 v7, s24, v21
v_mfma_f32_16x16x32_bf16 v[140:143], v[100:103], v[68:71], v[140:143]
ds_read_b64_tr_b16 v[82:83], v6 offset:576
v_add_u32 v8, s24, v22
v_mfma_f32_16x16x32_bf16 v[144:147], v[100:103], v[72:75], v[144:147]
ds_read_b64_tr_b16 v[84:85], v7 offset:0
v_add_u32 v9, s24, v23
v_mfma_f32_16x16x32_bf16 v[148:151], v[100:103], v[76:79], v[148:151]
ds_read_b64_tr_b16 v[86:87], v7 offset:576
v_mfma_f32_16x16x32_bf16 v[152:155], v[104:107], v[60:63], v[152:155]
ds_read_b64_tr_b16 v[88:89], v8 offset:0
v_add_u32 v3, 1024, v3
v_mfma_f32_16x16x32_bf16 v[156:159], v[104:107], v[64:67], v[156:159]
ds_read_b64_tr_b16 v[90:91], v8 offset:576
v_add_u32 v5, 1024, v5
v_mfma_f32_16x16x32_bf16 v[160:163], v[104:107], v[68:71], v[160:163]
s_waitcnt lgkmcnt(10)
ds_read_b64_tr_b16 v[92:93], v9 offset:0
v_mfma_f32_16x16x32_bf16 v[164:167], v[104:107], v[72:75], v[164:167]
s_add_u32 m0, s25, 0
ds_read_b64_tr_b16 v[94:95], v9 offset:576
v_mfma_f32_16x16x32_bf16 v[168:171], v[104:107], v[76:79], v[168:171]
buffer_load_dwordx4 v10, s[12:15], s27 offen lds
v_mfma_f32_16x16x32_bf16 v[172:175], v[108:111], v[60:63], v[172:175]
s_add_u32 m0, s25, 4096
v_cndmask_b32 v40, v40, v16, s[32:33]
v_cndmask_b32 v41, v41, v16, s[32:33]
v_mfma_f32_16x16x32_bf16 v[176:179], v[108:111], v[64:67], v[176:179]
buffer_load_dwordx4 v11, s[12:15], s27 offen lds
v_mfma_f32_16x16x32_bf16 v[180:183], v[108:111], v[68:71], v[180:183]
s_add_u32 m0, s25, 8192
v_cndmask_b32 v42, v42, v16, s[32:33]
v_cndmask_b32 v43, v43, v16, s[32:33]
v_mfma_f32_16x16x32_bf16 v[184:187], v[108:111], v[72:75], v[184:187]
buffer_load_dwordx4 v12, s[12:15], s27 offen lds
v_mfma_f32_16x16x32_bf16 v[188:191], v[108:111], v[76:79], v[188:191]
s_add_u32 m0, s25, 12288
s_nop 0
buffer_load_dwordx4 v13, s[12:15], s27 offen lds
s_add_u32 s27, s27, 110592
s_waitcnt lgkmcnt(0)
s_sub_u32 s30, s30, 1
s_cmp_lg_u32 s30, 0
s_cbranch_scc1 L_sequential_preLN__sliding_local_dilated__glu_gated_geglu__prompt_kernel_p0_loop
s_waitcnt vmcnt(0)
s_branch L_sequential_preLN__sliding_local_dilated__glu_gated_geglu__prompt_kernel_p0_after
.p2align 6
L_sequential_preLN__sliding_local_dilated__glu_gated_geglu__prompt_kernel_p0_loop3:
s_waitcnt vmcnt(8)
s_barrier
v_mfma_f32_16x16x32_bf16 v[112:115], v[80:83], v[40:43], v[112:115]
s_lshl_b32 s28, s23, 14
ds_read_b128 v[60:63], v3 offset:0
v_mfma_f32_16x16x32_bf16 v[116:119], v[80:83], v[44:47], v[116:119]
s_add_u32 s25, s26, s28
ds_read_b128 v[64:67], v3 offset:18432
v_mfma_f32_16x16x32_bf16 v[120:123], v[80:83], v[48:51], v[120:123]
s_add_u32 s23, s23, 1
ds_read_b128 v[68:71], v3 offset:36864
v_mfma_f32_16x16x32_bf16 v[124:127], v[80:83], v[52:55], v[124:127]
s_and_b32 s23, s23, 3
ds_read_b128 v[72:75], v3 offset:55296
v_mfma_f32_16x16x32_bf16 v[128:131], v[80:83], v[56:59], v[128:131]
s_lshl_b32 s24, s23, 14
ds_read_b128 v[76:79], v5 offset:0
v_mfma_f32_16x16x32_bf16 v[132:135], v[84:87], v[40:43], v[132:135]
v_add_u32 v6, s24, v20
v_mfma_f32_16x16x32_bf16 v[136:139], v[84:87], v[44:47], v[136:139]
ds_read_b64_tr_b16 v[96:97], v6 offset:0
v_add_u32 v7, s24, v21
v_mfma_f32_16x16x32_bf16 v[140:143], v[84:87], v[48:51], v[140:143]
ds_read_b64_tr_b16 v[98:99], v6 offset:576
v_mfma_f32_16x16x32_bf16 v[144:147], v[84:87], v[52:55], v[144:147]
ds_read_b64_tr_b16 v[100:101], v7 offset:0
v_mfma_f32_16x16x32_bf16 v[148:151], v[84:87], v[56:59], v[148:151]
ds_read_b64_tr_b16 v[102:103], v7 offset:576
v_mfma_f32_16x16x32_bf16 v[152:155], v[16:19], v[40:43], v[152:155]
v_add_u32 v2, 1024, v2
v_mfma_f32_16x16x32_bf16 v[156:159], v[16:19], v[44:47], v[156:159]
v_add_u32 v4, 1024, v4
v_mfma_f32_16x16x32_bf16 v[160:163], v[16:19], v[48:51], v[160:163]
s_waitcnt lgkmcnt(8)
v_mfma_f32_16x16x32_bf16 v[164:167], v[16:19], v[52:55], v[164:167]
s_add_u32 m0, s25, 0
v_mfma_f32_16x16x32_bf16 v[168:171], v[16:19], v[56:59], v[168:171]
buffer_load_dwordx4 v10, s[12:15], s27 offen lds
v_mfma_f32_16x16x32_bf16 v[172:175], v[40:43], v[40:43], v[172:175]
s_add_u32 m0, s25, 4096
v_cndmask_b32 v60, v60, v16, s[32:33]
v_cndmask_b32 v61, v61, v16, s[32:33]
v_mfma_f32_16x16x32_bf16 v[176:179], v[44:47], v[44:47], v[176:179]
buffer_load_dwordx4 v11, s[12:15], s27 offen lds
v_mfma_f32_16x16x32_bf16 v[180:183], v[48:51], v[48:51], v[180:183]
s_add_u32 m0, s25, 8192
v_cndmask_b32 v62, v62, v16, s[32:33]
v_cndmask_b32 v63, v63, v16, s[32:33]
v_mfma_f32_16x16x32_bf16 v[184:187], v[52:55], v[52:55], v[184:187]
buffer_load_dwordx4 v12, s[12:15], s27 offen lds
v_mfma_f32_16x16x32_bf16 v[188:191], v[56:59], v[56:59], v[188:191]
s_add_u32 m0, s25, 12288
s_nop 0
buffer_load_dwordx4 v13, s[12:15], s27 offen lds
s_add_u32 s27, s27, 110592
s_waitcnt lgkmcnt(0)
s_waitcnt vmcnt(8)
s_barrier
v_mfma_f32_16x16x32_bf16 v[112:115], v[96:99], v[60:63], v[112:115]
s_lshl_b32 s28, s23, 14
ds_read_b128 v[40:43], v2 offset:0
v_mfma_f32_16x16x32_bf16 v[116:119], v[96:99], v[64:67], v[116:119]
s_add_u32 s25, s26, s28
ds_read_b128 v[44:47], v2 offset:18432
v_mfma_f32_16x16x32_bf16 v[120:123], v[96:99], v[68:71], v[120:123]
s_add_u32 s23, s23, 1
ds_read_b128 v[48:51], v2 offset:36864
v_mfma_f32_16x16x32_bf16 v[124:127], v[96:99], v[72:75], v[124:127]
s_and_b32 s23, s23, 3
ds_read_b128 v[52:55], v2 offset:55296
v_mfma_f32_16x16x32_bf16 v[128:131], v[96:99], v[76:79], v[128:131]
s_lshl_b32 s24, s23, 14
ds_read_b128 v[56:59], v4 offset:0
v_mfma_f32_16x16x32_bf16 v[132:135], v[100:103], v[60:63], v[132:135]
v_add_u32 v6, s24, v20
v_mfma_f32_16x16x32_bf16 v[136:139], v[100:103], v[64:67], v[136:139]
ds_read_b64_tr_b16 v[80:81], v6 offset:0
v_add_u32 v7, s24, v21
v_mfma_f32_16x16x32_bf16 v[140:143], v[100:103], v[68:71], v[140:143]
ds_read_b64_tr_b16 v[82:83], v6 offset:576
v_mfma_f32_16x16x32_bf16 v[144:147], v[100:103], v[72:75], v[144:147]
ds_read_b64_tr_b16 v[84:85], v7 offset:0
v_mfma_f32_16x16x32_bf16 v[148:151], v[100:103], v[76:79], v[148:151]
ds_read_b64_tr_b16 v[86:87], v7 offset:576
v_mfma_f32_16x16x32_bf16 v[152:155], v[16:19], v[60:63], v[152:155]
v_add_u32 v3, 1024, v3
v_mfma_f32_16x16x32_bf16 v[156:159], v[16:19], v[64:67], v[156:159]
v_add_u32 v5, 1024, v5
v_mfma_f32_16x16x32_bf16 v[160:163], v[16:19], v[68:71], v[160:163]
s_waitcnt lgkmcnt(8)
v_mfma_f32_16x16x32_bf16 v[164:167], v[16:19], v[72:75], v[164:167]
s_add_u32 m0, s25, 0
v_mfma_f32_16x16x32_bf16 v[168:171], v[16:19], v[76:79], v[168:171]
buffer_load_dwordx4 v10, s[12:15], s27 offen lds
v_mfma_f32_16x16x32_bf16 v[172:175], v[60:63], v[60:63], v[172:175]
s_add_u32 m0, s25, 4096
v_cndmask_b32 v40, v40, v16, s[32:33]
v_cndmask_b32 v41, v41, v16, s[32:33]
v_mfma_f32_16x16x32_bf16 v[176:179], v[64:67], v[64:67], v[176:179]
buffer_load_dwordx4 v11, s[12:15], s27 offen lds
v_mfma_f32_16x16x32_bf16 v[180:183], v[68:71], v[68:71], v[180:183]
s_add_u32 m0, s25, 8192
v_cndmask_b32 v42, v42, v16, s[32:33]
v_cndmask_b32 v43, v43, v16, s[32:33]
v_mfma_f32_16x16x32_bf16 v[184:187], v[72:75], v[72:75], v[184:187]
buffer_load_dwordx4 v12, s[12:15], s27 offen lds
v_mfma_f32_16x16x32_bf16 v[188:191], v[76:79], v[76:79], v[188:191]
s_add_u32 m0, s25, 12288
s_nop 0
buffer_load_dwordx4 v13, s[12:15], s27 offen lds
s_add_u32 s27, s27, 110592
s_waitcnt lgkmcnt(0)
s_sub_u32 s30, s30, 1
s_cmp_lg_u32 s30, 0
s_cbranch_scc1 L_sequential_preLN__sliding_local_dilated__glu_gated_geglu__prompt_kernel_p0_loop3
s_waitcnt vmcnt(0)
v_and_b32 v1, 15, v0
v_lshrrev_b32 v27, 4, v0
v_lshrrev_b32 v28, 2, v1
v_and_b32 v29, 3, v1
v_cmp_eq_u32 s[50:51], v27, v28
v_cmp_eq_u32 s[52:53], 1, v29
v_cmp_eq_u32 s[54:55], 2, v29
v_cmp_eq_u32 s[56:57], 3, v29
v_lshlrev_b32 v1, 3, v1
v_add_u32 v1, 157696, v1
s_mov_b32 s28, 0x3ae38e39
v_cndmask_b32 v172, v172, v173, s[52:53]
v_cndmask_b32 v172, v172, v174, s[54:55]
v_cndmask_b32 v172, v172, v175, s[56:57]
v_cndmask_b32 v176, v176, v177, s[52:53]
v_cndmask_b32 v176, v176, v178, s[54:55]
v_cndmask_b32 v176, v176, v179, s[56:57]
v_cndmask_b32 v180, v180, v181, s[52:53]
v_cndmask_b32 v180, v180, v182, s[54:55]
v_cndmask_b32 v180, v180, v183, s[56:57]
v_cndmask_b32 v184, v184, v185, s[52:53]
v_cndmask_b32 v184, v184, v186, s[54:55]
v_cndmask_b32 v184, v184, v187, s[56:57]
v_cndmask_b32 v188, v188, v189, s[52:53]
v_cndmask_b32 v188, v188, v190, s[54:55]
v_cndmask_b32 v188, v188, v191, s[56:57]
v_mul_f32 v152, s28, v152
v_mul_f32 v156, s28, v156
v_mul_f32 v160, s28, v160
v_mul_f32 v164, s28, v164
v_mul_f32 v168, s28, v168
v_mul_f32 v172, s28, v172
v_mul_f32 v176, s28, v176
v_mul_f32 v180, s28, v180
v_mul_f32 v184, s28, v184
v_mul_f32 v188, s28, v188
s_cmp_lg_u32 s21, 0
s_cbranch_scc1 L_sequential_preLN__sliding_local_dilated__glu_gated_geglu__prompt_kernel_p0_nomx
v_and_b32 v30, 15, v0
v_lshlrev_b32 v30, 2, v30
s_lshl_b32 s29, s22, 8
s_add_u32 s29, s29, 0x4a4000
s_mov_b64 exec, s[50:51]
buffer_store_dword v156, v30, s[16:19], s29 offen offset:0 sc1
buffer_store_dword v160, v30, s[16:19], s29 offen offset:64 sc1
buffer_store_dword v164, v30, s[16:19], s29 offen offset:128 sc1
buffer_store_dword v168, v30, s[16:19], s29 offen offset:192 sc1
s_mov_b64 exec, -1
L_sequential_preLN__sliding_local_dilated__glu_gated_geglu__prompt_kernel_p0_nomx:
v_fma_f32 v172, -v152, v152, v172
v_fma_f32 v176, -v156, v156, v176
v_fma_f32 v180, -v160, v160, v180
v_fma_f32 v184, -v164, v164, v184
v_fma_f32 v188, -v168, v168, v188
v_max_f32 v172, 0, v172
v_max_f32 v176, 0, v176
v_max_f32 v180, 0, v180
v_max_f32 v184, 0, v184
v_max_f32 v188, 0, v188
v_add_f32 v172, 0x3727c5ac, v172
v_add_f32 v176, 0x3727c5ac, v176
v_add_f32 v180, 0x3727c5ac, v180
v_add_f32 v184, 0x3727c5ac, v184
v_add_f32 v188, 0x3727c5ac, v188
v_rsq_f32 v173, v172
v_rsq_f32 v177, v176
v_rsq_f32 v181, v180
v_rsq_f32 v185, v184
v_rsq_f32 v189, v188
s_nop 0
v_mul_f32 v172, -v152, v173
v_mul_f32 v176, -v156, v177
v_mul_f32 v180, -v160, v181
v_mul_f32 v184, -v164, v185
v_mul_f32 v188, -v168, v189
s_mov_b64 exec, s[50:51]
ds_write_b64 v1, v[172:173] offset:0
ds_write_b64 v1, v[176:177] offset:128
ds_write_b64 v1, v[180:181] offset:256
ds_write_b64 v1, v[184:185] offset:384
ds_write_b64 v1, v[188:189] offset:512
s_mov_b64 exec, -1
L_sequential_preLN__sliding_local_dilated__glu_gated_geglu__prompt_kernel_p0_after:
s_cmp_ge_u32 s62, 576
s_cbranch_scc1 L_sequential_preLN__sliding_local_dilated__glu_gated_geglu__prompt_kernel_p0_nowb
v_mov_b32 v208, 0x3f803f80
v_dot2_f32_bf16 v209, v200, v208, 0
v_dot2_f32_bf16 v209, v201, v208, v209
v_dot2_f32_bf16 v209, v202, v208, v209
v_dot2_f32_bf16 v209, v203, v208, v209
v_dot2_f32_bf16 v209, v204, v208, v209
v_dot2_f32_bf16 v209, v205, v208, v209
v_dot2_f32_bf16 v209, v206, v208, v209
v_dot2_f32_bf16 v209, v207, v208, v209
s_nop 2
v_add_f32_dpp v209, v209, v209 quad_perm:[1,0,3,2] row_mask:0xf bank_mask:0xf
s_nop 1
v_add_f32_dpp v209, v209, v209 quad_perm:[2,3,0,1] row_mask:0xf bank_mask:0xf
s_nop 1
v_add_f32_dpp v209, v209, v209 row_half_mirror row_mask:0xf bank_mask:0xf
s_nop 1
v_add_f32_dpp v209, v209, v209 row_mirror row_mask:0xf bank_mask:0xf
s_nop 1
v_mov_b32 v210, v209
s_nop 1
v_permlane16_swap_b32 v209, v210
s_nop 1
v_add_f32 v209, v209, v210
v_mov_b32 v210, v209
s_nop 1
v_permlane32_swap_b32 v209, v210
s_nop 1
v_add_f32 v209, v209, v210
v_mul_f32 v209, 0x3ae38e39, v209
v_cvt_pk_bf16_f32 v200, v209, 0
v_lshlrev_b32 v201, 16, v200
v_sub_f32 v201, v209, v201
v_cvt_pk_bf16_f32 v201, v201, 0
s_lshr_b32 s50, s62, 5
s_lshl_b32 s50, s50, 6
s_bfe_u32 s51, s62, 0x20002
s_lshl_b32 s51, s51, 4
s_add_u32 s50, s50, s51
s_bfe_u32 s51, s62, 0x10004
s_lshl_b32 s51, s51, 3
s_add_u32 s50, s50, s51
s_and_b32 s51, s62, 3
s_lshl_b32 s51, s51, 1
s_add_u32 s50, s50, s51
s_add_u32 s50, s50, 0x4a6000
s_mov_b64 exec, 1
buffer_store_short v200, off, s[16:19], s50 sc1
buffer_store_short v201, off, s[16:19], s50 offset:1152 sc1
s_mov_b64 exec, -1
L_sequential_preLN__sliding_local_dilated__glu_gated_geglu__prompt_kernel_p0_nowb:
s_mov_b32 s52, s100
s_mov_b32 s53, s101
s_mov_b32 s54, 256
s_mov_b32 s55, 0x20000
buffer_load_dword v211, off, s[52:55], 0 sc1
s_mov_b32 s52, s96
s_mov_b32 s53, s97
s_mov_b32 s56, s98
s_mov_b32 s57, s99
v_mul_u32_u24 v37, 7282, v36
v_lshrrev_b32 v37, 16, v37
v_mul_u32_u24 v38, 9, v37
v_sub_u32 v38, v36, v38
s_mul_i32 s50, s60, 18
v_add_u32 v37, s50, v37
v_mul_u32_u24 v37, 9216, v37
v_lshl_add_u32 v37, v38, 7, v37
s_mul_i32 s50, s60, 162
v_add_u32 v38, s50, v36
v_lshlrev_b32 v38, 7, v38
v_cmp_gt_u32 vcc, 162, v36
v_mov_b32 v39, 0x7fff0000
s_mul_i32 s51, s61, 1152
v_cndmask_b32 v37, v39, v37, vcc
v_cndmask_b32 v38, v39, v38, vcc
s_mov_b32 s54, 0xa2000
s_mov_b32 s55, 0x20000
s_mov_b32 s58, 0x510000
s_mov_b32 s59, 0x20000
buffer_load_dword v14, v38, s[52:55], 0 offen
buffer_load_dword v15, v37, s[56:59], s51 offen
s_nop 4
v_mov_b32_dpp v40, v112 row_newbcast:0 row_mask:0xf bank_mask:0xf
v_mov_b32_dpp v41, v113 row_newbcast:0 row_mask:0xf bank_mask:0xf
v_mov_b32_dpp v42, v114 row_newbcast:0 row_mask:0xf bank_mask:0xf
v_mov_b32_dpp v43, v115 row_newbcast:0 row_mask:0xf bank_mask:0xf
v_mov_b32_dpp v44, v132 row_newbcast:0 row_mask:0xf bank_mask:0xf
v_mov_b32_dpp v45, v133 row_newbcast:0 row_mask:0xf bank_mask:0xf
v_mov_b32_dpp v46, v134 row_newbcast:0 row_mask:0xf bank_mask:0xf
v_mov_b32_dpp v47, v135 row_newbcast:0 row_mask:0xf bank_mask:0xf
v_mov_b32_dpp v48, v152 row_newbcast:0 row_mask:0xf bank_mask:0xf
v_mov_b32_dpp v49, v153 row_newbcast:0 row_mask:0xf bank_mask:0xf
v_mov_b32_dpp v50, v154 row_newbcast:0 row_mask:0xf bank_mask:0xf
v_mov_b32_dpp v51, v155 row_newbcast:0 row_mask:0xf bank_mask:0xf
v_mov_b32_dpp v52, v172 row_newbcast:0 row_mask:0xf bank_mask:0xf
v_mov_b32_dpp v53, v173 row_newbcast:0 row_mask:0xf bank_mask:0xf
v_mov_b32_dpp v54, v174 row_newbcast:0 row_mask:0xf bank_mask:0xf
v_mov_b32_dpp v55, v175 row_newbcast:0 row_mask:0xf bank_mask:0xf
s_waitcnt lgkmcnt(0)
s_barrier
v_and_b32 v1, 15, v0
v_lshlrev_b32 v1, 3, v1
v_add_u32 v1, 157696, v1
ds_read_b64 v[60:61], v1 offset:0
ds_read_b64 v[62:63], v1 offset:128
ds_read_b64 v[64:65], v1 offset:256
ds_read_b64 v[66:67], v1 offset:384
ds_read_b64 v[68:69], v1 offset:512
s_waitcnt lgkmcnt(0)
v_mul_f32 v27, v60, v40
v_mul_f32 v28, v60, v41
v_mul_f32 v29, v60, v42
v_mul_f32 v30, v60, v43
v_fma_f32 v112, v112, v61, v27
v_fma_f32 v113, v113, v61, v28
v_fma_f32 v114, v114, v61, v29
v_fma_f32 v115, v115, v61, v30
v_cvt_pk_bf16_f32 v112, v112, v113
v_cvt_pk_bf16_f32 v113, v114, v115
ds_write_b32 v192, v112 offset:0
ds_write_b32 v193, v113 offset:0
v_mul_f32 v31, v60, v44
v_mul_f32 v32, v60, v45
v_mul_f32 v33, v60, v46
v_mul_f32 v34, v60, v47
v_fma_f32 v132, v132, v61, v31
v_fma_f32 v133, v133, v61, v32
v_fma_f32 v134, v134, v61, v33
v_fma_f32 v135, v135, v61, v34
v_cvt_pk_bf16_f32 v132, v132, v133
v_cvt_pk_bf16_f32 v133, v134, v135
ds_write_b32 v194, v132 offset:0
ds_write_b32 v195, v133 offset:0
v_mul_f32 v27, v60, v48
v_mul_f32 v28, v60, v49
v_mul_f32 v29, v60, v50
v_mul_f32 v30, v60, v51
v_fma_f32 v152, v152, v61, v27
v_fma_f32 v153, v153, v61, v28
v_fma_f32 v154, v154, v61, v29
v_fma_f32 v155, v155, v61, v30
v_cvt_pk_bf16_f32 v152, v152, v153
v_cvt_pk_bf16_f32 v153, v154, v155
ds_write_b32 v196, v152 offset:0
ds_write_b32 v197, v153 offset:0
v_mul_f32 v31, v60, v52
v_mul_f32 v32, v60, v53
v_mul_f32 v33, v60, v54
v_mul_f32 v34, v60, v55
v_fma_f32 v172, v172, v61, v31
v_fma_f32 v173, v173, v61, v32
v_fma_f32 v174, v174, v61, v33
v_fma_f32 v175, v175, v61, v34
v_cvt_pk_bf16_f32 v172, v172, v173
v_cvt_pk_bf16_f32 v173, v174, v175
ds_write_b32 v198, v172 offset:0
ds_write_b32 v199, v173 offset:0
v_mul_f32 v27, v62, v40
v_mul_f32 v28, v62, v41
v_mul_f32 v29, v62, v42
v_mul_f32 v30, v62, v43
v_fma_f32 v116, v116, v63, v27
v_fma_f32 v117, v117, v63, v28
v_fma_f32 v118, v118, v63, v29
v_fma_f32 v119, v119, v63, v30
v_cvt_pk_bf16_f32 v116, v116, v117
v_cvt_pk_bf16_f32 v117, v118, v119
ds_write_b32 v192, v116 offset:640
ds_write_b32 v193, v117 offset:640
v_mul_f32 v31, v62, v44
v_mul_f32 v32, v62, v45
v_mul_f32 v33, v62, v46
v_mul_f32 v34, v62, v47
v_fma_f32 v136, v136, v63, v31
v_fma_f32 v137, v137, v63, v32
v_fma_f32 v138, v138, v63, v33
v_fma_f32 v139, v139, v63, v34
v_cvt_pk_bf16_f32 v136, v136, v137
v_cvt_pk_bf16_f32 v137, v138, v139
ds_write_b32 v194, v136 offset:640
ds_write_b32 v195, v137 offset:640
v_mul_f32 v27, v62, v48
v_mul_f32 v28, v62, v49
v_mul_f32 v29, v62, v50
v_mul_f32 v30, v62, v51
v_fma_f32 v156, v156, v63, v27
v_fma_f32 v157, v157, v63, v28
v_fma_f32 v158, v158, v63, v29
v_fma_f32 v159, v159, v63, v30
v_cvt_pk_bf16_f32 v156, v156, v157
v_cvt_pk_bf16_f32 v157, v158, v159
ds_write_b32 v196, v156 offset:640
ds_write_b32 v197, v157 offset:640
v_mul_f32 v31, v62, v52
v_mul_f32 v32, v62, v53
v_mul_f32 v33, v62, v54
v_mul_f32 v34, v62, v55
v_fma_f32 v176, v176, v63, v31
v_fma_f32 v177, v177, v63, v32
v_fma_f32 v178, v178, v63, v33
v_fma_f32 v179, v179, v63, v34
v_cvt_pk_bf16_f32 v176, v176, v177
v_cvt_pk_bf16_f32 v177, v178, v179
ds_write_b32 v198, v176 offset:640
ds_write_b32 v199, v177 offset:640
v_mul_f32 v27, v64, v40
v_mul_f32 v28, v64, v41
v_mul_f32 v29, v64, v42
v_mul_f32 v30, v64, v43
v_fma_f32 v120, v120, v65, v27
v_fma_f32 v121, v121, v65, v28
v_fma_f32 v122, v122, v65, v29
v_fma_f32 v123, v123, v65, v30
v_cvt_pk_bf16_f32 v120, v120, v121
v_cvt_pk_bf16_f32 v121, v122, v123
ds_write_b32 v192, v120 offset:1280
ds_write_b32 v193, v121 offset:1280
v_mul_f32 v31, v64, v44
v_mul_f32 v32, v64, v45
v_mul_f32 v33, v64, v46
v_mul_f32 v34, v64, v47
v_fma_f32 v140, v140, v65, v31
v_fma_f32 v141, v141, v65, v32
v_fma_f32 v142, v142, v65, v33
v_fma_f32 v143, v143, v65, v34
v_cvt_pk_bf16_f32 v140, v140, v141
v_cvt_pk_bf16_f32 v141, v142, v143
ds_write_b32 v194, v140 offset:1280
ds_write_b32 v195, v141 offset:1280
v_mul_f32 v27, v64, v48
v_mul_f32 v28, v64, v49
v_mul_f32 v29, v64, v50
v_mul_f32 v30, v64, v51
v_fma_f32 v160, v160, v65, v27
v_fma_f32 v161, v161, v65, v28
v_fma_f32 v162, v162, v65, v29
v_fma_f32 v163, v163, v65, v30
v_cvt_pk_bf16_f32 v160, v160, v161
v_cvt_pk_bf16_f32 v161, v162, v163
ds_write_b32 v196, v160 offset:1280
ds_write_b32 v197, v161 offset:1280
v_mul_f32 v31, v64, v52
v_mul_f32 v32, v64, v53
v_mul_f32 v33, v64, v54
v_mul_f32 v34, v64, v55
v_fma_f32 v180, v180, v65, v31
v_fma_f32 v181, v181, v65, v32
v_fma_f32 v182, v182, v65, v33
v_fma_f32 v183, v183, v65, v34
v_cvt_pk_bf16_f32 v180, v180, v181
v_cvt_pk_bf16_f32 v181, v182, v183
ds_write_b32 v198, v180 offset:1280
ds_write_b32 v199, v181 offset:1280
v_mul_f32 v27, v66, v40
v_mul_f32 v28, v66, v41
v_mul_f32 v29, v66, v42
v_mul_f32 v30, v66, v43
v_fma_f32 v124, v124, v67, v27
v_fma_f32 v125, v125, v67, v28
v_fma_f32 v126, v126, v67, v29
v_fma_f32 v127, v127, v67, v30
v_cvt_pk_bf16_f32 v124, v124, v125
v_cvt_pk_bf16_f32 v125, v126, v127
ds_write_b32 v192, v124 offset:1920
ds_write_b32 v193, v125 offset:1920
v_mul_f32 v31, v66, v44
v_mul_f32 v32, v66, v45
v_mul_f32 v33, v66, v46
v_mul_f32 v34, v66, v47
v_fma_f32 v144, v144, v67, v31
v_fma_f32 v145, v145, v67, v32
v_fma_f32 v146, v146, v67, v33
v_fma_f32 v147, v147, v67, v34
v_cvt_pk_bf16_f32 v144, v144, v145
v_cvt_pk_bf16_f32 v145, v146, v147
ds_write_b32 v194, v144 offset:1920
ds_write_b32 v195, v145 offset:1920
v_mul_f32 v27, v66, v48
v_mul_f32 v28, v66, v49
v_mul_f32 v29, v66, v50
v_mul_f32 v30, v66, v51
v_fma_f32 v164, v164, v67, v27
v_fma_f32 v165, v165, v67, v28
v_fma_f32 v166, v166, v67, v29
v_fma_f32 v167, v167, v67, v30
v_cvt_pk_bf16_f32 v164, v164, v165
v_cvt_pk_bf16_f32 v165, v166, v167
ds_write_b32 v196, v164 offset:1920
ds_write_b32 v197, v165 offset:1920
v_mul_f32 v31, v66, v52
v_mul_f32 v32, v66, v53
v_mul_f32 v33, v66, v54
v_mul_f32 v34, v66, v55
v_fma_f32 v184, v184, v67, v31
v_fma_f32 v185, v185, v67, v32
v_fma_f32 v186, v186, v67, v33
v_fma_f32 v187, v187, v67, v34
v_cvt_pk_bf16_f32 v184, v184, v185
v_cvt_pk_bf16_f32 v185, v186, v187
ds_write_b32 v198, v184 offset:1920
ds_write_b32 v199, v185 offset:1920
v_mul_f32 v27, v68, v40
v_mul_f32 v28, v68, v41
v_mul_f32 v29, v68, v42
v_mul_f32 v30, v68, v43
v_fma_f32 v128, v128, v69, v27
v_fma_f32 v129, v129, v69, v28
v_fma_f32 v130, v130, v69, v29
v_fma_f32 v131, v131, v69, v30
v_cvt_pk_bf16_f32 v128, v128, v129
v_cvt_pk_bf16_f32 v129, v130, v131
ds_write_b32 v192, v128 offset:2560
ds_write_b32 v193, v129 offset:2560
v_mul_f32 v31, v68, v44
v_mul_f32 v32, v68, v45
v_mul_f32 v33, v68, v46
v_mul_f32 v34, v68, v47
v_fma_f32 v148, v148, v69, v31
v_fma_f32 v149, v149, v69, v32
v_fma_f32 v150, v150, v69, v33
v_fma_f32 v151, v151, v69, v34
v_cvt_pk_bf16_f32 v148, v148, v149
v_cvt_pk_bf16_f32 v149, v150, v151
ds_write_b32 v194, v148 offset:2560
ds_write_b32 v195, v149 offset:2560
v_mul_f32 v27, v68, v48
v_mul_f32 v28, v68, v49
v_mul_f32 v29, v68, v50
v_mul_f32 v30, v68, v51
v_fma_f32 v168, v168, v69, v27
v_fma_f32 v169, v169, v69, v28
v_fma_f32 v170, v170, v69, v29
v_fma_f32 v171, v171, v69, v30
v_cvt_pk_bf16_f32 v168, v168, v169
v_cvt_pk_bf16_f32 v169, v170, v171
ds_write_b32 v196, v168 offset:2560
ds_write_b32 v197, v169 offset:2560
v_mul_f32 v31, v68, v52
v_mul_f32 v32, v68, v53
v_mul_f32 v33, v68, v54
v_mul_f32 v34, v68, v55
v_fma_f32 v188, v188, v69, v31
v_fma_f32 v189, v189, v69, v32
v_fma_f32 v190, v190, v69, v33
v_fma_f32 v191, v191, v69, v34
v_cvt_pk_bf16_f32 v188, v188, v189
v_cvt_pk_bf16_f32 v189, v190, v191
ds_write_b32 v198, v188 offset:2560
ds_write_b32 v199, v189 offset:2560
s_waitcnt lgkmcnt(0)
s_barrier
v_add_u32 v1, 2, v0
v_mul_u32_u24 v2, 40, v1
s_mul_i32 s28, s20, 3200
v_add_u32 v2, s28, v2
ds_read_b64 v[40:41], v2 offset:560
ds_read_b64 v[42:43], v2 offset:568
ds_read_b64 v[44:45], v2 offset:576
ds_read_b64 v[46:47], v2 offset:584
ds_read_b64 v[48:49], v2 offset:592
ds_read_b64 v[112:113], v2 offset:13360
ds_read_b64 v[114:115], v2 offset:13368
ds_read_b64 v[116:117], v2 offset:13376
ds_read_b64 v[118:119], v2 offset:13384
ds_read_b64 v[120:121], v2 offset:13392
ds_read_b64 v[122:123], v2 offset:13280
ds_read_b64 v[124:125], v2 offset:13288
ds_read_b64 v[126:127], v2 offset:13296
ds_read_b64 v[128:129], v2 offset:13304
ds_read_b64 v[130:131], v2 offset:13312
s_waitcnt lgkmcnt(0)
ds_read_b64 v[132:133], v2 offset:13200
ds_read_b64 v[134:135], v2 offset:13208
ds_read_b64 v[136:137], v2 offset:13216
ds_read_b64 v[138:139], v2 offset:13224
ds_read_b64 v[140:141], v2 offset:13232
ds_read_b64 v[142:143], v2 offset:13120
ds_read_b64 v[144:145], v2 offset:13128
ds_read_b64 v[146:147], v2 offset:13136
ds_read_b64 v[148:149], v2 offset:13144
ds_read_b64 v[150:151], v2 offset:13152
v_dot2_f32_bf16 v50, v40, v112, 0
v_dot2_f32_bf16 v51, v40, v122, 0
v_dot2_f32_bf16 v50, v41, v113, v50
v_dot2_f32_bf16 v51, v41, v123, v51
v_dot2_f32_bf16 v50, v42, v114, v50
v_dot2_f32_bf16 v51, v42, v124, v51
v_dot2_f32_bf16 v50, v43, v115, v50
v_dot2_f32_bf16 v51, v43, v125, v51
v_dot2_f32_bf16 v50, v44, v116, v50
v_dot2_f32_bf16 v51, v44, v126, v51
v_dot2_f32_bf16 v50, v45, v117, v50
v_dot2_f32_bf16 v51, v45, v127, v51
v_dot2_f32_bf16 v50, v46, v118, v50
v_dot2_f32_bf16 v51, v46, v128, v51
v_dot2_f32_bf16 v50, v47, v119, v50
v_dot2_f32_bf16 v51, v47, v129, v51
v_dot2_f32_bf16 v50, v48, v120, v50
v_dot2_f32_bf16 v51, v48, v130, v51
s_waitcnt lgkmcnt(0)
ds_read_b64 v[152:153], v2 offset:13040
ds_read_b64 v[154:155], v2 offset:13048
ds_read_b64 v[156:157], v2 offset:13056
ds_read_b64 v[158:159], v2 offset:13064
ds_read_b64 v[160:161], v2 offset:13072
ds_read_b64 v[162:163], v2 offset:12960
ds_read_b64 v[164:165], v2 offset:12968
ds_read_b64 v[166:167], v2 offset:12976
ds_read_b64 v[168:169], v2 offset:12984
ds_read_b64 v[170:171], v2 offset:12992
v_dot2_f32_bf16 v52, v40, v132, 0
v_dot2_f32_bf16 v53, v40, v142, 0
v_dot2_f32_bf16 v52, v41, v133, v52
v_dot2_f32_bf16 v53, v41, v143, v53
v_dot2_f32_bf16 v52, v42, v134, v52
v_dot2_f32_bf16 v53, v42, v144, v53
v_dot2_f32_bf16 v52, v43, v135, v52
v_dot2_f32_bf16 v53, v43, v145, v53
v_dot2_f32_bf16 v52, v44, v136, v52
v_dot2_f32_bf16 v53, v44, v146, v53
v_dot2_f32_bf16 v52, v45, v137, v52
v_dot2_f32_bf16 v53, v45, v147, v53
v_dot2_f32_bf16 v52, v46, v138, v52
v_dot2_f32_bf16 v53, v46, v148, v53
v_dot2_f32_bf16 v52, v47, v139, v52
v_dot2_f32_bf16 v53, v47, v149, v53
v_dot2_f32_bf16 v52, v48, v140, v52
v_dot2_f32_bf16 v53, v48, v150, v53
s_waitcnt lgkmcnt(0)
ds_read_b64 v[172:173], v2 offset:12880
ds_read_b64 v[174:175], v2 offset:12888
ds_read_b64 v[176:177], v2 offset:12896
ds_read_b64 v[178:179], v2 offset:12904
ds_read_b64 v[180:181], v2 offset:12912
ds_read_b64 v[182:183], v2 offset:12800
ds_read_b64 v[184:185], v2 offset:12808
ds_read_b64 v[186:187], v2 offset:12816
ds_read_b64 v[188:189], v2 offset:12824
ds_read_b64 v[190:191], v2 offset:12832
v_dot2_f32_bf16 v54, v40, v152, 0
v_dot2_f32_bf16 v55, v40, v162, 0
v_dot2_f32_bf16 v54, v41, v153, v54
v_dot2_f32_bf16 v55, v41, v163, v55
v_dot2_f32_bf16 v54, v42, v154, v54
v_dot2_f32_bf16 v55, v42, v164, v55
v_dot2_f32_bf16 v54, v43, v155, v54
v_dot2_f32_bf16 v55, v43, v165, v55
v_dot2_f32_bf16 v54, v44, v156, v54
v_dot2_f32_bf16 v55, v44, v166, v55
v_dot2_f32_bf16 v54, v45, v157, v54
v_dot2_f32_bf16 v55, v45, v167, v55
v_dot2_f32_bf16 v54, v46, v158, v54
v_dot2_f32_bf16 v55, v46, v168, v55
v_dot2_f32_bf16 v54, v47, v159, v54
v_dot2_f32_bf16 v55, v47, v169, v55
v_dot2_f32_bf16 v54, v48, v160, v54
v_dot2_f32_bf16 v55, v48, v170, v55
s_waitcnt lgkmcnt(0)
v_dot2_f32_bf16 v56, v40, v172, 0
v_dot2_f32_bf16 v57, v40, v182, 0
v_dot2_f32_bf16 v56, v41, v173, v56
v_dot2_f32_bf16 v57, v41, v183, v57
v_dot2_f32_bf16 v56, v42, v174, v56
v_dot2_f32_bf16 v57, v42, v184, v57
v_dot2_f32_bf16 v56, v43, v175, v56
v_dot2_f32_bf16 v57, v43, v185, v57
v_dot2_f32_bf16 v56, v44, v176, v56
v_dot2_f32_bf16 v57, v44, v186, v57
v_dot2_f32_bf16 v56, v45, v177, v56
v_dot2_f32_bf16 v57, v45, v187, v57
v_dot2_f32_bf16 v56, v46, v178, v56
v_dot2_f32_bf16 v57, v46, v188, v57
v_dot2_f32_bf16 v56, v47, v179, v56
v_dot2_f32_bf16 v57, v47, v189, v57
v_dot2_f32_bf16 v56, v48, v180, v56
v_dot2_f32_bf16 v57, v48, v190, v57
ds_read_b64 v[112:113], v2 offset:26160
ds_read_b64 v[114:115], v2 offset:26168
ds_read_b64 v[116:117], v2 offset:26176
ds_read_b64 v[118:119], v2 offset:26184
ds_read_b64 v[120:121], v2 offset:26192
ds_read_b64 v[122:123], v2 offset:26080
ds_read_b64 v[124:125], v2 offset:26088
ds_read_b64 v[126:127], v2 offset:26096
ds_read_b64 v[128:129], v2 offset:26104
ds_read_b64 v[130:131], v2 offset:26112
ds_read_b64 v[132:133], v2 offset:26000
ds_read_b64 v[134:135], v2 offset:26008
ds_read_b64 v[136:137], v2 offset:26016
ds_read_b64 v[138:139], v2 offset:26024
ds_read_b64 v[140:141], v2 offset:26032
s_lshl_b32 s28, s22, 6
v_add_u32 v27, s28, v0
v_mov_b32 v28, 0xce6e6b28
v_cmp_gt_u32 vcc, 2, v27
s_nop 1
v_cndmask_b32 v51, v51, v28, vcc
v_cmp_gt_u32 vcc, 4, v27
s_nop 1
v_cndmask_b32 v52, v52, v28, vcc
v_cmp_gt_u32 vcc, 6, v27
s_nop 1
v_cndmask_b32 v53, v53, v28, vcc
v_cmp_gt_u32 vcc, 8, v27
s_nop 1
v_cndmask_b32 v54, v54, v28, vcc
v_cmp_gt_u32 vcc, 10, v27
s_nop 1
v_cndmask_b32 v55, v55, v28, vcc
v_cmp_gt_u32 vcc, 12, v27
s_nop 1
v_cndmask_b32 v56, v56, v28, vcc
v_cmp_gt_u32 vcc, 14, v27
s_nop 1
v_cndmask_b32 v57, v57, v28, vcc
v_max3_f32 v29, v50, v51, v52
v_max3_f32 v30, v53, v54, v55
v_max3_f32 v29, v29, v56, v57
v_max_f32 v29, v29, v30
s_mov_b32 s29, 0x3eae1a93
v_mul_f32 v29, s29, v29
v_fma_f32 v50, v50, s29, -v29
v_fma_f32 v51, v51, s29, -v29
v_fma_f32 v52, v52, s29, -v29
v_fma_f32 v53, v53, s29, -v29
v_fma_f32 v54, v54, s29, -v29
v_fma_f32 v55, v55, s29, -v29
v_fma_f32 v56, v56, s29, -v29
v_fma_f32 v57, v57, s29, -v29
v_exp_f32 v50, v50
v_exp_f32 v51, v51
v_exp_f32 v52, v52
v_exp_f32 v53, v53
v_exp_f32 v54, v54
v_exp_f32 v55, v55
v_exp_f32 v56, v56
v_exp_f32 v57, v57
s_waitcnt lgkmcnt(0)
ds_read_b64 v[142:143], v2 offset:25920
ds_read_b64 v[144:145], v2 offset:25928
ds_read_b64 v[146:147], v2 offset:25936
ds_read_b64 v[148:149], v2 offset:25944
ds_read_b64 v[150:151], v2 offset:25952
ds_read_b64 v[152:153], v2 offset:25840
ds_read_b64 v[154:155], v2 offset:25848
ds_read_b64 v[156:157], v2 offset:25856
ds_read_b64 v[158:159], v2 offset:25864
ds_read_b64 v[160:161], v2 offset:25872
ds_read_b64 v[162:163], v2 offset:25760
ds_read_b64 v[164:165], v2 offset:25768
ds_read_b64 v[166:167], v2 offset:25776
ds_read_b64 v[168:169], v2 offset:25784
ds_read_b64 v[170:171], v2 offset:25792
v_add_f32 v29, v50, v51
v_add_f32 v30, v52, v53
v_add_f32 v31, v54, v55
v_add_f32 v32, v56, v57
v_add_f32 v29, v29, v30
v_add_f32 v31, v31, v32
v_add_f32 v29, v29, v31
v_rcp_f32 v29, v29
s_nop 0
v_mul_f32 v50, v50, v29
v_mul_f32 v51, v51, v29
v_mul_f32 v52, v52, v29
v_mul_f32 v53, v53, v29
v_mul_f32 v54, v54, v29
v_mul_f32 v55, v55, v29
v_mul_f32 v56, v56, v29
v_mul_f32 v57, v57, v29
v_cvt_pk_bf16_f32 v60, v50, 0
v_cvt_pk_bf16_f32 v68, 0, v50
v_cvt_pk_bf16_f32 v61, v51, 0
v_cvt_pk_bf16_f32 v69, 0, v51
v_cvt_pk_bf16_f32 v62, v52, 0
v_cvt_pk_bf16_f32 v70, 0, v52
v_cvt_pk_bf16_f32 v63, v53, 0
v_cvt_pk_bf16_f32 v71, 0, v53
v_cvt_pk_bf16_f32 v64, v54, 0
v_cvt_pk_bf16_f32 v72, 0, v54
v_cvt_pk_bf16_f32 v65, v55, 0
v_cvt_pk_bf16_f32 v73, 0, v55
v_cvt_pk_bf16_f32 v66, v56, 0
v_cvt_pk_bf16_f32 v74, 0, v56
v_cvt_pk_bf16_f32 v67, v57, 0
v_cvt_pk_bf16_f32 v75, 0, v57
s_cmp_ge_u32 s62, 576
s_cbranch_scc1 L_sequential_preLN__sliding_local_dilated__glu_gated_geglu__prompt_kernel_p0_now
s_waitcnt vmcnt(2)
v_readfirstlane_b32 s50, v211
s_nop 3
s_cmp_eq_u32 s50, 1
s_cbranch_scc1 L_sequential_preLN__sliding_local_dilated__glu_gated_geglu__prompt_kernel_p0_ann
s_mov_b32 s52, s100
s_mov_b32 s53, s101
s_mov_b32 s54, 256
s_mov_b32 s55, 0x20000
s_mov_b32 s51, 0x4000
L_sequential_preLN__sliding_local_dilated__glu_gated_geglu__prompt_kernel_p0_annw:
s_sleep 8
buffer_load_dword v211, off, s[52:55], 0 sc1
s_waitcnt vmcnt(0)
v_readfirstlane_b32 s50, v211
s_sub_u32 s51, s51, 1
s_cmp_eq_u32 s51, 0
s_cbranch_scc1 L_sequential_preLN__sliding_local_dilated__glu_gated_geglu__prompt_kernel_p0_ann
s_cmp_eq_u32 s50, 1
s_cbranch_scc0 L_sequential_preLN__sliding_local_dilated__glu_gated_geglu__prompt_kernel_p0_annw
L_sequential_preLN__sliding_local_dilated__glu_gated_geglu__prompt_kernel_p0_ann:
s_and_b32 s50, s2, 7
s_lshl_b32 s50, s50, 8
s_add_u32 s50, s50, 0x4b8000
v_mov_b32 v211, 1
s_mov_b64 exec, 1
buffer_atomic_add v211, off, s[16:19], s50
s_mov_b64 exec, -1
L_sequential_preLN__sliding_local_dilated__glu_gated_geglu__prompt_kernel_p0_now:
v_dot2_f32_bf16 v80, v112, v60, 0
v_dot2_f32_bf16 v90, v112, v68, 0
v_dot2_f32_bf16 v81, v113, v60, 0
v_dot2_f32_bf16 v91, v113, v68, 0
v_dot2_f32_bf16 v82, v114, v60, 0
v_dot2_f32_bf16 v92, v114, v68, 0
v_dot2_f32_bf16 v83, v115, v60, 0
v_dot2_f32_bf16 v93, v115, v68, 0
v_dot2_f32_bf16 v84, v116, v60, 0
v_dot2_f32_bf16 v94, v116, v68, 0
v_dot2_f32_bf16 v85, v117, v60, 0
v_dot2_f32_bf16 v95, v117, v68, 0
v_dot2_f32_bf16 v86, v118, v60, 0
v_dot2_f32_bf16 v96, v118, v68, 0
v_dot2_f32_bf16 v87, v119, v60, 0
v_dot2_f32_bf16 v97, v119, v68, 0
v_dot2_f32_bf16 v88, v120, v60, 0
v_dot2_f32_bf16 v98, v120, v68, 0
v_dot2_f32_bf16 v80, v122, v61, v80
v_dot2_f32_bf16 v90, v122, v69, v90
v_dot2_f32_bf16 v81, v123, v61, v81
v_dot2_f32_bf16 v91, v123, v69, v91
v_dot2_f32_bf16 v82, v124, v61, v82
v_dot2_f32_bf16 v92, v124, v69, v92
v_dot2_f32_bf16 v83, v125, v61, v83
v_dot2_f32_bf16 v93, v125, v69, v93
v_dot2_f32_bf16 v84, v126, v61, v84
v_dot2_f32_bf16 v94, v126, v69, v94
v_dot2_f32_bf16 v85, v127, v61, v85
v_dot2_f32_bf16 v95, v127, v69, v95
v_dot2_f32_bf16 v86, v128, v61, v86
v_dot2_f32_bf16 v96, v128, v69, v96
v_dot2_f32_bf16 v87, v129, v61, v87
v_dot2_f32_bf16 v97, v129, v69, v97
v_dot2_f32_bf16 v88, v130, v61, v88
v_dot2_f32_bf16 v98, v130, v69, v98
v_dot2_f32_bf16 v80, v132, v62, v80
v_dot2_f32_bf16 v90, v132, v70, v90
v_dot2_f32_bf16 v81, v133, v62, v81
v_dot2_f32_bf16 v91, v133, v70, v91
v_dot2_f32_bf16 v82, v134, v62, v82
v_dot2_f32_bf16 v92, v134, v70, v92
v_dot2_f32_bf16 v83, v135, v62, v83
v_dot2_f32_bf16 v93, v135, v70, v93
v_dot2_f32_bf16 v84, v136, v62, v84
v_dot2_f32_bf16 v94, v136, v70, v94
v_dot2_f32_bf16 v85, v137, v62, v85
v_dot2_f32_bf16 v95, v137, v70, v95
v_dot2_f32_bf16 v86, v138, v62, v86
v_dot2_f32_bf16 v96, v138, v70, v96
v_dot2_f32_bf16 v87, v139, v62, v87
v_dot2_f32_bf16 v97, v139, v70, v97
v_dot2_f32_bf16 v88, v140, v62, v88
v_dot2_f32_bf16 v98, v140, v70, v98
s_waitcnt lgkmcnt(0)
ds_read_b64 v[172:173], v2 offset:25680
ds_read_b64 v[174:175], v2 offset:25688
ds_read_b64 v[176:177], v2 offset:25696
ds_read_b64 v[178:179], v2 offset:25704
ds_read_b64 v[180:181], v2 offset:25712
ds_read_b64 v[182:183], v2 offset:25600
ds_read_b64 v[184:185], v2 offset:25608
ds_read_b64 v[186:187], v2 offset:25616
ds_read_b64 v[188:189], v2 offset:25624
ds_read_b64 v[190:191], v2 offset:25632
v_dot2_f32_bf16 v80, v142, v63, v80
v_dot2_f32_bf16 v90, v142, v71, v90
v_dot2_f32_bf16 v81, v143, v63, v81
v_dot2_f32_bf16 v91, v143, v71, v91
v_dot2_f32_bf16 v82, v144, v63, v82
v_dot2_f32_bf16 v92, v144, v71, v92
v_dot2_f32_bf16 v83, v145, v63, v83
v_dot2_f32_bf16 v93, v145, v71, v93
v_dot2_f32_bf16 v84, v146, v63, v84
v_dot2_f32_bf16 v94, v146, v71, v94
v_dot2_f32_bf16 v85, v147, v63, v85
v_dot2_f32_bf16 v95, v147, v71, v95
v_dot2_f32_bf16 v86, v148, v63, v86
v_dot2_f32_bf16 v96, v148, v71, v96
v_dot2_f32_bf16 v87, v149, v63, v87
v_dot2_f32_bf16 v97, v149, v71, v97
v_dot2_f32_bf16 v88, v150, v63, v88
v_dot2_f32_bf16 v98, v150, v71, v98
v_dot2_f32_bf16 v80, v152, v64, v80
v_dot2_f32_bf16 v90, v152, v72, v90
v_dot2_f32_bf16 v81, v153, v64, v81
v_dot2_f32_bf16 v91, v153, v72, v91
v_dot2_f32_bf16 v82, v154, v64, v82
v_dot2_f32_bf16 v92, v154, v72, v92
v_dot2_f32_bf16 v83, v155, v64, v83
v_dot2_f32_bf16 v93, v155, v72, v93
v_dot2_f32_bf16 v84, v156, v64, v84
v_dot2_f32_bf16 v94, v156, v72, v94
v_dot2_f32_bf16 v85, v157, v64, v85
v_dot2_f32_bf16 v95, v157, v72, v95
v_dot2_f32_bf16 v86, v158, v64, v86
v_dot2_f32_bf16 v96, v158, v72, v96
v_dot2_f32_bf16 v87, v159, v64, v87
v_dot2_f32_bf16 v97, v159, v72, v97
v_dot2_f32_bf16 v88, v160, v64, v88
v_dot2_f32_bf16 v98, v160, v72, v98
v_dot2_f32_bf16 v80, v162, v65, v80
v_dot2_f32_bf16 v90, v162, v73, v90
v_dot2_f32_bf16 v81, v163, v65, v81
v_dot2_f32_bf16 v91, v163, v73, v91
v_dot2_f32_bf16 v82, v164, v65, v82
v_dot2_f32_bf16 v92, v164, v73, v92
v_dot2_f32_bf16 v83, v165, v65, v83
v_dot2_f32_bf16 v93, v165, v73, v93
v_dot2_f32_bf16 v84, v166, v65, v84
v_dot2_f32_bf16 v94, v166, v73, v94
v_dot2_f32_bf16 v85, v167, v65, v85
v_dot2_f32_bf16 v95, v167, v73, v95
v_dot2_f32_bf16 v86, v168, v65, v86
v_dot2_f32_bf16 v96, v168, v73, v96
v_dot2_f32_bf16 v87, v169, v65, v87
v_dot2_f32_bf16 v97, v169, v73, v97
v_dot2_f32_bf16 v88, v170, v65, v88
v_dot2_f32_bf16 v98, v170, v73, v98
s_waitcnt lgkmcnt(0)
v_dot2_f32_bf16 v80, v172, v66, v80
v_dot2_f32_bf16 v90, v172, v74, v90
v_dot2_f32_bf16 v81, v173, v66, v81
v_dot2_f32_bf16 v91, v173, v74, v91
v_dot2_f32_bf16 v82, v174, v66, v82
v_dot2_f32_bf16 v92, v174, v74, v92
v_dot2_f32_bf16 v83, v175, v66, v83
v_dot2_f32_bf16 v93, v175, v74, v93
v_dot2_f32_bf16 v84, v176, v66, v84
v_dot2_f32_bf16 v94, v176, v74, v94
v_dot2_f32_bf16 v85, v177, v66, v85
v_dot2_f32_bf16 v95, v177, v74, v95
v_dot2_f32_bf16 v86, v178, v66, v86
v_dot2_f32_bf16 v96, v178, v74, v96
v_dot2_f32_bf16 v87, v179, v66, v87
v_dot2_f32_bf16 v97, v179, v74, v97
v_dot2_f32_bf16 v88, v180, v66, v88
v_dot2_f32_bf16 v98, v180, v74, v98
v_dot2_f32_bf16 v80, v182, v67, v80
v_dot2_f32_bf16 v90, v182, v75, v90
v_dot2_f32_bf16 v81, v183, v67, v81
v_dot2_f32_bf16 v91, v183, v75, v91
v_dot2_f32_bf16 v82, v184, v67, v82
v_dot2_f32_bf16 v92, v184, v75, v92
v_dot2_f32_bf16 v83, v185, v67, v83
v_dot2_f32_bf16 v93, v185, v75, v93
v_dot2_f32_bf16 v84, v186, v67, v84
v_dot2_f32_bf16 v94, v186, v75, v94
v_dot2_f32_bf16 v85, v187, v67, v85
v_dot2_f32_bf16 v95, v187, v75, v95
v_dot2_f32_bf16 v86, v188, v67, v86
v_dot2_f32_bf16 v96, v188, v75, v96
v_dot2_f32_bf16 v87, v189, v67, v87
v_dot2_f32_bf16 v97, v189, v75, v97
v_dot2_f32_bf16 v88, v190, v67, v88
v_dot2_f32_bf16 v98, v190, v75, v98
v_lshrrev_b32 v27, 4, v0
s_lshl_b32 s28, s22, 2
v_add_u32 v27, s28, v27
v_mul_u32_u24 v27, 18432, v27
v_and_b32 v28, 15, v0
v_lshl_add_u32 v27, v28, 4, v27
v_cvt_pk_bf16_f32 v40, v80, v90
v_cvt_pk_bf16_f32 v41, v81, v91
v_cvt_pk_bf16_f32 v42, v82, v92
v_cvt_pk_bf16_f32 v43, v83, v93
v_cvt_pk_bf16_f32 v44, v84, v94
v_cvt_pk_bf16_f32 v45, v85, v95
v_cvt_pk_bf16_f32 v46, v86, v96
v_cvt_pk_bf16_f32 v47, v87, v97
v_cvt_pk_bf16_f32 v48, v88, v98
v_mul_u32_u24 v29, 152, v0
s_mul_i32 s28, s20, 36
s_add_u32 s28, s28, 49152
v_add_u32 v30, s28, v29
ds_write_b32 v30, v40 offset:0
ds_write_b32 v30, v41 offset:4
ds_write_b32 v30, v42 offset:8
ds_write_b32 v30, v43 offset:12
ds_write_b32 v30, v44 offset:16
ds_write_b32 v30, v45 offset:20
ds_write_b32 v30, v46 offset:24
ds_write_b32 v30, v47 offset:28
ds_write_b32 v30, v48 offset:32
s_lshl_b32 s28, s20, 3
s_add_u32 s28, s28, 49152
v_add_u32 v30, s28, v29
s_waitcnt lgkmcnt(0)
s_barrier
ds_read_b64 v[80:81], v30 offset:0
ds_read_b64 v[82:83], v30 offset:32
ds_read_b64 v[84:85], v30 offset:64
ds_read_b64 v[86:87], v30 offset:96
ds_read_b64 v[88:89], v30 offset:128
s_waitcnt lgkmcnt(4)
buffer_store_dwordx2 v[80:81], v27, s[16:19], s40 offen sc1
s_waitcnt lgkmcnt(3)
buffer_store_dwordx2 v[82:83], v27, s[16:19], s41 offen sc1
s_waitcnt lgkmcnt(2)
buffer_store_dwordx2 v[84:85], v27, s[16:19], s42 offen sc1
s_waitcnt lgkmcnt(1)
buffer_store_dwordx2 v[86:87], v27, s[16:19], s43 offen sc1
s_waitcnt lgkmcnt(0)
s_cmp_ge_u32 s20, 2
s_cbranch_scc1 L_sequential_preLN__sliding_local_dilated__glu_gated_geglu__prompt_kernel_p0_no5
buffer_store_dwordx2 v[88:89], v27, s[16:19], s44 offen sc1
L_sequential_preLN__sliding_local_dilated__glu_gated_geglu__prompt_kernel_p0_no5:
s_waitcnt vmcnt(0)
s_barrier
s_cmp_lg_u32 s20, 0
s_cbranch_scc1 L_sequential_preLN__sliding_local_dilated__glu_gated_geglu__prompt_kernel_p0_nosig
s_lshl_b32 s50, s22, 8
s_add_u32 s50, s50, 0x4b6000
v_mov_b32 v211, 1
s_mov_b64 exec, 1
buffer_atomic_add v211, off, s[16:19], s50
s_mov_b64 exec, -1
L_sequential_preLN__sliding_local_dilated__glu_gated_geglu__prompt_kernel_p0_nosig:
s_lshl_b32 s50, s20, 6
v_add_u32 v0, s50, v0
s_load_dwordx2 s[4:5], s[0:1], 72
s_load_dwordx2 s[6:7], s[0:1], 16
s_load_dwordx2 s[28:29], s[0:1], 0
v_mov_b32 v15, v0
v_lshrrev_b32 v8, 6, v0
v_and_b32 v0, 63, v0
v_readfirstlane_b32 s20, v8
v_lshlrev_b32 v1, 4, v0
s_lshr_b32 s24, s2, 3
s_mul_i32 s25, s24, 57
s_lshr_b32 s25, s25, 9
s_mul_i32 s22, s25, 9
s_sub_u32 s22, s24, s22
s_lshl_b32 s21, s25, 3
s_and_b32 s24, s2, 7
s_add_u32 s21, s21, s24
s_cmp_lt_u32 s2, 216
s_cbranch_scc1 L_sequential_preLN__sliding_local_dilated__glu_gated_geglu__prompt_kernel_p1_tile
s_load_dwordx2 s[44:45], s[0:1], 40
s_load_dwordx2 s[46:47], s[0:1], 48
s_lshr_b32 s50, s2, 3
s_sub_u32 s50, s50, 27
s_mul_i32 s50, s50, 192
v_add_u32 v208, s50, v15
v_cmp_gt_u32 vcc, 192, v15
v_mov_b32 v211, 0x00800000
s_nop 0
v_cndmask_b32 v208, v211, v208, vcc
v_mul_u32_u24 v209, 7282, v208
v_lshrrev_b32 v209, 16, v209
v_mul_u32_u24 v210, 9, v209
v_sub_u32 v210, v208, v210
v_mul_u32_u24 v209, 9216, v209
v_lshl_add_u32 v209, v210, 7, v209
v_cmp_gt_u32 vcc, 954, v208
v_mov_b32 v211, 0x7fff0000
v_lshlrev_b32 v208, 7, v208
v_cndmask_b32 v209, v211, v209, vcc
s_and_b32 s51, s2, 7
s_mul_i32 s52, s51, 1152
s_mul_i32 s53, s51, 663552
s_waitcnt lgkmcnt(0)
s_mov_b32 s56, s44
s_mov_b32 s57, s45
s_mov_b32 s58, 0x510000
s_mov_b32 s59, 0x20000
s_mov_b32 s60, s46
s_mov_b32 s61, s47
s_mov_b32 s62, 0x510000
s_mov_b32 s63, 0x20000
buffer_load_dword v16, v209, s[56:59], s52 offen
buffer_load_dword v24, v208, s[60:63], s53 offen
s_add_u32 s52, s52, 976896
s_add_u32 s53, s53, 122880
buffer_load_dword v17, v209, s[56:59], s52 offen
buffer_load_dword v25, v208, s[60:63], s53 offen
s_add_u32 s52, s52, 976896
s_add_u32 s53, s53, 122880
buffer_load_dword v18, v209, s[56:59], s52 offen
buffer_load_dword v26, v208, s[60:63], s53 offen
s_add_u32 s52, s52, 976896
s_add_u32 s53, s53, 122880
buffer_load_dword v19, v209, s[56:59], s52 offen
buffer_load_dword v27, v208, s[60:63], s53 offen
s_add_u32 s52, s52, 976896
s_add_u32 s53, s53, 122880
buffer_load_dword v20, v209, s[56:59], s52 offen
buffer_load_dword v28, v208, s[60:63], s53 offen
s_add_u32 s52, s52, 976896
s_add_u32 s53, s53, 122880
buffer_load_dword v21, v209, s[56:59], s52 offen
buffer_load_dword v29, v208, s[60:63], s53 offen
s_add_u32 s52, s52, 976896
s_add_u32 s53, s53, 122880
s_waitcnt vmcnt(0)
s_branch L_sequential_preLN__sliding_local_dilated__glu_gated_geglu__prompt_kernel_mlp
L_sequential_preLN__sliding_local_dilated__glu_gated_geglu__prompt_kernel_p1_tile:
s_waitcnt lgkmcnt(0)
s_cmp_ge_u32 s21, 22
s_cbranch_scc1 L_sequential_preLN__sliding_local_dilated__glu_gated_geglu__prompt_kernel_mlp
s_cmp_eq_u32 s20, 3
s_cbranch_scc1 L_sequential_preLN__sliding_local_dilated__glu_gated_geglu__prompt_kernel_p1_w3
s_mul_i32 s23, s21, 6
s_lshl_b32 s24, s20, 1
s_add_u32 s23, s23, s24
s_mul_i32 s26, s23, 18432
v_bfe_u32 v8, v0, 1, 3
v_mul_u32_u24 v8, 1152, v8
v_lshrrev_b32 v9, 4, v0
v_lshl_add_u32 v8, v9, 5, v8
v_and_b32 v10, 1, v0
v_lshl_add_u32 v2, v10, 4, v8
v_add_u32 v3, 8192, v2
v_add_u32 v4, 16384, v2
s_mul_i32 s27, s20, 73728
s_lshl_b32 s24, s22, 7
s_add_u32 s27, s27, s24
s_lshl_b32 s30, s20, 13
s_add_u32 s30, s30, 73728
s_waitcnt lgkmcnt(0)
s_mov_b32 s8, s4
s_mov_b32 s9, s5
s_mov_b32 s10, 0x2b40000
s_mov_b32 s11, 0x20000
s_mov_b32 s12, s6
s_mov_b32 s13, s7
s_mov_b32 s14, 0xa2000
s_mov_b32 s15, 0x20000
s_mov_b32 s16, s28
s_mov_b32 s17, s29
s_mov_b32 s18, 0x240000
s_mov_b32 s19, 0x20000
s_add_u32 s24, s27, 0
s_add_u32 m0, s30, 0
s_nop 0
buffer_load_dwordx4 v2, s[12:15], s24 offen offset:0 lds
buffer_load_dwordx4 v3, s[12:15], s24 offen offset:1024 lds
buffer_load_dwordx4 v4, s[12:15], s24 offen offset:2048 lds
s_add_u32 s24, s27, 27648
s_add_u32 m0, s30, 3072
s_nop 0
buffer_load_dwordx4 v2, s[12:15], s24 offen offset:0 lds
buffer_load_dwordx4 v3, s[12:15], s24 offen offset:1024 lds
buffer_load_dwordx4 v4, s[12:15], s24 offen offset:2048 lds
s_add_u32 s24, s27, 55296
s_add_u32 m0, s30, 6144
s_nop 0
buffer_load_dwordx4 v2, s[12:15], s24 offen offset:0 lds
buffer_load_dwordx4 v3, s[12:15], s24 offen offset:1024 lds
s_add_u32 s24, s27, 221184
s_add_u32 m0, s30, 24576
s_nop 0
buffer_load_dwordx4 v2, s[12:15], s24 offen offset:0 lds
buffer_load_dwordx4 v3, s[12:15], s24 offen offset:1024 lds
buffer_load_dwordx4 v4, s[12:15], s24 offen offset:2048 lds
s_add_u32 s24, s27, 248832
s_add_u32 m0, s30, 27648
s_nop 0
buffer_load_dwordx4 v2, s[12:15], s24 offen offset:0 lds
buffer_load_dwordx4 v3, s[12:15], s24 offen offset:1024 lds
buffer_load_dwordx4 v4, s[12:15], s24 offen offset:2048 lds
s_add_u32 s24, s27, 276480
s_add_u32 m0, s30, 30720
s_nop 0
buffer_load_dwordx4 v2, s[12:15], s24 offen offset:0 lds
buffer_load_dwordx4 v3, s[12:15], s24 offen offset:1024 lds
s_add_u32 s24, s27, 442368
s_add_u32 m0, s30, 49152
s_nop 0
buffer_load_dwordx4 v2, s[12:15], s24 offen offset:0 lds
buffer_load_dwordx4 v3, s[12:15], s24 offen offset:1024 lds
buffer_load_dwordx4 v4, s[12:15], s24 offen offset:2048 lds
s_add_u32 s24, s27, 470016
s_add_u32 m0, s30, 52224
s_nop 0
buffer_load_dwordx4 v2, s[12:15], s24 offen offset:0 lds
buffer_load_dwordx4 v3, s[12:15], s24 offen offset:1024 lds
buffer_load_dwordx4 v4, s[12:15], s24 offen offset:2048 lds
s_add_u32 s24, s27, 497664
s_add_u32 m0, s30, 55296
s_nop 0
buffer_load_dwordx4 v2, s[12:15], s24 offen offset:0 lds
buffer_load_dwordx4 v3, s[12:15], s24 offen offset:1024 lds
s_cmp_lg_u32 s20, 0
s_cbranch_scc1 L_sequential_preLN__sliding_local_dilated__glu_gated_geglu__prompt_kernel_p1_go1
s_mul_i32 s40, s21, 3
s_lshr_b32 s40, s40, 1
s_add_u32 s41, s40, 1
s_min_u32 s41, s41, 31
s_lshl_b32 s40, s40, 8
s_add_u32 s40, s40, 0x4b6000
s_lshl_b32 s41, s41, 8
s_add_u32 s41, s41, 0x4b6000
v_lshlrev_b32 v208, 8, v0
v_add_u32 v208, 0x4b8000, v208
v_mov_b32 v209, 72
v_cmp_le_u32 vcc, 8, v0
v_mov_b32 v210, s40
v_mov_b32 v211, 8
v_cndmask_b32 v208, v208, v210, vcc
v_cndmask_b32 v209, v209, v211, vcc
v_cmp_le_u32 vcc, 9, v0
v_mov_b32 v210, s41
s_nop 0
v_cndmask_b32 v208, v208, v210, vcc
s_mov_b32 s42, 0x4000
L_sequential_preLN__sliding_local_dilated__glu_gated_geglu__prompt_kernel_p1_wait1:
buffer_load_dword v210, v208, s[8:11], 0 offen sc1
s_waitcnt vmcnt(0)
v_cmp_lt_u32 s[44:45], v210, v209
s_sub_u32 s42, s42, 1
s_cmp_eq_u32 s42, 0
s_cbranch_scc1 L_sequential_preLN__sliding_local_dilated__glu_gated_geglu__prompt_kernel_p1_go1
s_nop 3
s_cmp_eq_u64 s[44:45], 0
s_cbranch_scc1 L_sequential_preLN__sliding_local_dilated__glu_gated_geglu__prompt_kernel_p1_go1
s_sleep 6
s_branch L_sequential_preLN__sliding_local_dilated__glu_gated_geglu__prompt_kernel_p1_wait1
L_sequential_preLN__sliding_local_dilated__glu_gated_geglu__prompt_kernel_p1_go1:
s_barrier
v_and_b32 v250, 1, v0
v_mul_u32_u24 v250, 1152, v250
v_lshrrev_b32 v8, 4, v0
v_lshl_add_u32 v250, v8, 4, v250
v_add_u32 v250, 147456, v250
s_lshl_b32 s37, s20, 10
s_add_u32 s38, s37, 147456
s_add_u32 s37, s37, 0x4a6000
s_add_u32 s25, s26, 0
buffer_load_dwordx4 v[16:19], v1, s[8:11], s25 offen sc1
s_add_u32 s25, s26, 18432
buffer_load_dwordx4 v[20:23], v1, s[8:11], s25 offen sc1
s_add_u32 s25, s26, 1024
buffer_load_dwordx4 v[24:27], v1, s[8:11], s25 offen sc1
s_add_u32 s25, s26, 19456
buffer_load_dwordx4 v[28:31], v1, s[8:11], s25 offen sc1
s_add_u32 s25, s26, 2048
buffer_load_dwordx4 v[32:35], v1, s[8:11], s25 offen sc1
s_add_u32 s25, s26, 20480
buffer_load_dwordx4 v[36:39], v1, s[8:11], s25 offen sc1
s_add_u32 s25, s26, 3072
buffer_load_dwordx4 v[40:43], v1, s[8:11], s25 offen sc1
s_add_u32 s25, s26, 21504
buffer_load_dwordx4 v[44:47], v1, s[8:11], s25 offen sc1
s_add_u32 s25, s26, 4096
buffer_load_dwordx4 v[48:51], v1, s[8:11], s25 offen sc1
s_add_u32 s25, s26, 22528
buffer_load_dwordx4 v[52:55], v1, s[8:11], s25 offen sc1
s_add_u32 s25, s26, 5120
buffer_load_dwordx4 v[56:59], v1, s[8:11], s25 offen sc1
s_add_u32 s25, s26, 23552
buffer_load_dwordx4 v[60:63], v1, s[8:11], s25 offen sc1
buffer_load_dwordx4 v[212:215], v1, s[8:11], s37 offen sc1
s_add_u32 s25, s26, 6144
buffer_load_dwordx4 v[64:67], v1, s[8:11], s25 offen sc1
s_add_u32 s25, s26, 24576
buffer_load_dwordx4 v[68:71], v1, s[8:11], s25 offen sc1
s_add_u32 s25, s26, 7168
buffer_load_dwordx4 v[72:75], v1, s[8:11], s25 offen sc1
s_add_u32 s25, s26, 25600
buffer_load_dwordx4 v[76:79], v1, s[8:11], s25 offen sc1
s_add_u32 s25, s26, 8192
buffer_load_dwordx4 v[80:83], v1, s[8:11], s25 offen sc1
s_add_u32 s25, s26, 26624
buffer_load_dwordx4 v[84:87], v1, s[8:11], s25 offen sc1
s_add_u32 s25, s26, 9216
buffer_load_dwordx4 v[88:91], v1, s[8:11], s25 offen sc1
s_add_u32 s25, s26, 27648
buffer_load_dwordx4 v[92:95], v1, s[8:11], s25 offen sc1
s_add_u32 s25, s26, 10240
buffer_load_dwordx4 v[96:99], v1, s[8:11], s25 offen sc1
s_add_u32 s25, s26, 28672
buffer_load_dwordx4 v[100:103], v1, s[8:11], s25 offen sc1
s_add_u32 s25, s26, 11264
buffer_load_dwordx4 v[104:107], v1, s[8:11], s25 offen sc1
s_add_u32 s25, s26, 29696
buffer_load_dwordx4 v[108:111], v1, s[8:11], s25 offen sc1
v_lshrrev_b32 v9, 4, v0
v_bfe_u32 v8, v0, 2, 2
v_lshlrev_b32 v8, 5, v8
v_and_b32 v10, 3, v0
v_lshl_add_u32 v8, v10, 3, v8
v_and_b32 v10, 1, v9
v_lshl_add_u32 v8, v10, 7, v8
v_lshrrev_b32 v10, 1, v9
v_lshl_add_u32 v5, v10, 10, v8
v_add_u32 v5, 73728, v5
v_add_u32 v6, 36864, v5
v_and_b32 v251, 15, v0
v_lshlrev_b32 v251, 2, v251
v_and_b32 v8, 15, v0
v_mul_u32_u24 v8, 1152, v8
v_lshl_add_u32 v7, v9, 3, v8
s_mul_i32 s31, s23, 18432
s_lshl_b32 s24, s22, 7
s_add_u32 s31, s31, s24
s_mov_b32 s32, 0x3f80
s_mov_b32 s33, 0x3f800000
s_waitcnt vmcnt(12)
v_add_u32 v216, s38, v1
ds_write_b128 v216, v[212:215]
s_waitcnt lgkmcnt(0)
s_barrier
ds_read_b128 a[48:51], v250 offset:0
ds_read_b128 a[52:55], v250 offset:64
ds_read_b128 a[56:59], v250 offset:128
ds_read_b128 a[60:63], v250 offset:192
ds_read_b128 a[64:67], v250 offset:256
ds_read_b128 a[68:71], v250 offset:320
ds_read_b128 a[72:75], v250 offset:384
ds_read_b128 a[76:79], v250 offset:448
ds_read_b128 a[80:83], v250 offset:512
s_waitcnt lgkmcnt(0)
ds_read_b128 a[84:87], v250 offset:576
ds_read_b128 a[88:91], v250 offset:640
ds_read_b128 a[92:95], v250 offset:704
ds_read_b128 a[96:99], v250 offset:768
ds_read_b128 a[100:103], v250 offset:832
ds_read_b128 a[104:107], v250 offset:896
ds_read_b128 a[108:111], v250 offset:960
ds_read_b128 a[112:115], v250 offset:1024
ds_read_b128 a[116:119], v250 offset:1088
s_waitcnt lgkmcnt(0)
ds_read_b64_tr_b16 a[0:1], v5 offset:0
ds_read_b64_tr_b16 a[2:3], v5 offset:2048
ds_read_b64_tr_b16 a[4:5], v5 offset:4096
ds_read_b64_tr_b16 a[6:7], v5 offset:6144
ds_read_b64_tr_b16 a[8:9], v5 offset:8192
ds_read_b64_tr_b16 a[10:11], v5 offset:10240
ds_read_b64_tr_b16 a[12:13], v5 offset:12288
ds_read_b64_tr_b16 a[14:15], v5 offset:14336
ds_read_b64_tr_b16 a[16:17], v5 offset:16384
ds_read_b64_tr_b16 a[18:19], v5 offset:18432
ds_read_b64_tr_b16 a[20:21], v5 offset:20480
ds_read_b64_tr_b16 a[22:23], v5 offset:22528
v_mfma_f32_16x16x32_bf16 v[240:243], a[48:51], v[16:19], 0
s_add_u32 s25, s26, 12288
v_mfma_f32_16x16x32_bf16 v[240:243], a[52:55], v[24:27], v[240:243]
buffer_load_dwordx4 v[112:115], v1, s[8:11], s25 offen sc1
v_mfma_f32_16x16x32_bf16 v[240:243], a[56:59], v[32:35], v[240:243]
s_add_u32 s25, s26, 30720
v_mfma_f32_16x16x32_bf16 v[240:243], a[60:63], v[40:43], v[240:243]
buffer_load_dwordx4 v[116:119], v1, s[8:11], s25 offen sc1
v_mfma_f32_16x16x32_bf16 v[240:243], a[64:67], v[48:51], v[240:243]
s_add_u32 s25, s26, 13312
v_mfma_f32_16x16x32_bf16 v[240:243], a[68:71], v[56:59], v[240:243]
buffer_load_dwordx4 v[120:123], v1, s[8:11], s25 offen sc1
v_mfma_f32_16x16x32_bf16 v[244:247], a[48:51], v[20:23], 0
s_add_u32 s25, s26, 31744
v_mfma_f32_16x16x32_bf16 v[244:247], a[52:55], v[28:31], v[244:247]
buffer_load_dwordx4 v[124:127], v1, s[8:11], s25 offen sc1
v_mfma_f32_16x16x32_bf16 v[244:247], a[56:59], v[36:39], v[244:247]
s_add_u32 s25, s26, 14336
v_mfma_f32_16x16x32_bf16 v[244:247], a[60:63], v[44:47], v[244:247]
buffer_load_dwordx4 v[128:131], v1, s[8:11], s25 offen sc1
v_mfma_f32_16x16x32_bf16 v[244:247], a[64:67], v[52:55], v[244:247]
s_add_u32 s25, s26, 32768
v_mfma_f32_16x16x32_bf16 v[244:247], a[68:71], v[60:63], v[244:247]
s_waitcnt lgkmcnt(6)
buffer_load_dwordx4 v[132:135], v1, s[8:11], s25 offen sc1
v_mfma_f32_16x16x32_bf16 v[160:163], a[0:3], v[16:19], 0
s_add_u32 s25, s26, 15360
ds_read_b64_tr_b16 a[24:25], v5 offset:256
v_mfma_f32_16x16x32_bf16 v[160:163], a[4:7], v[24:27], v[160:163]
buffer_load_dwordx4 v[136:139], v1, s[8:11], s25 offen sc1
v_mfma_f32_16x16x32_bf16 v[160:163], a[8:11], v[32:35], v[160:163]
s_add_u32 s25, s26, 33792
ds_read_b64_tr_b16 a[26:27], v5 offset:2304
ds_read_b64_tr_b16 a[28:29], v5 offset:4352
v_mfma_f32_16x16x32_bf16 v[164:167], a[0:3], v[20:23], 0
buffer_load_dwordx4 v[140:143], v1, s[8:11], s25 offen sc1
v_mfma_f32_16x16x32_bf16 v[164:167], a[4:7], v[28:31], v[164:167]
s_add_u32 s25, s26, 16384
ds_read_b64_tr_b16 a[30:31], v5 offset:6400
ds_read_b64_tr_b16 a[32:33], v5 offset:8448
v_mfma_f32_16x16x32_bf16 v[164:167], a[8:11], v[36:39], v[164:167]
s_waitcnt lgkmcnt(5)
buffer_load_dwordx4 v[144:147], v1, s[8:11], s25 offen sc1
v_mfma_f32_16x16x32_bf16 v[160:163], a[12:15], v[40:43], v[160:163]
s_add_u32 s25, s26, 34816
ds_read_b64_tr_b16 a[34:35], v5 offset:10496
ds_read_b64_tr_b16 a[36:37], v5 offset:12544
v_mfma_f32_16x16x32_bf16 v[160:163], a[16:19], v[48:51], v[160:163]
buffer_load_dwordx4 v[148:151], v1, s[8:11], s25 offen sc1
v_mfma_f32_16x16x32_bf16 v[160:163], a[20:23], v[56:59], v[160:163]
s_add_u32 s25, s26, 17408
ds_read_b64_tr_b16 a[38:39], v5 offset:14592
ds_read_b64_tr_b16 a[40:41], v5 offset:16640
v_mfma_f32_16x16x32_bf16 v[164:167], a[12:15], v[44:47], v[164:167]
buffer_load_dwordx4 v[152:155], v1, s[8:11], s25 offen sc1
v_mfma_f32_16x16x32_bf16 v[164:167], a[16:19], v[52:55], v[164:167]
s_add_u32 s25, s26, 35840
ds_read_b64_tr_b16 a[42:43], v5 offset:18688
ds_read_b64_tr_b16 a[44:45], v5 offset:20736
v_mfma_f32_16x16x32_bf16 v[164:167], a[20:23], v[60:63], v[164:167]
s_waitcnt lgkmcnt(5)
buffer_load_dwordx4 v[156:159], v1, s[8:11], s25 offen sc1
v_mfma_f32_16x16x32_bf16 v[168:171], a[24:27], v[16:19], 0
ds_read_b64_tr_b16 a[46:47], v5 offset:22784
ds_read_b64_tr_b16 a[0:1], v5 offset:512
v_mfma_f32_16x16x32_bf16 v[168:171], a[28:31], v[24:27], v[168:171]
ds_read_b64_tr_b16 a[2:3], v5 offset:2560
v_mfma_f32_16x16x32_bf16 v[168:171], a[32:35], v[32:35], v[168:171]
ds_read_b64_tr_b16 a[4:5], v5 offset:4608
v_mfma_f32_16x16x32_bf16 v[172:175], a[24:27], v[20:23], 0
ds_read_b64_tr_b16 a[6:7], v5 offset:6656
v_mfma_f32_16x16x32_bf16 v[172:175], a[28:31], v[28:31], v[172:175]
ds_read_b64_tr_b16 a[8:9], v5 offset:8704
v_mfma_f32_16x16x32_bf16 v[172:175], a[32:35], v[36:39], v[172:175]
s_waitcnt lgkmcnt(5)
ds_read_b64_tr_b16 a[10:11], v5 offset:10752
v_mfma_f32_16x16x32_bf16 v[168:171], a[36:39], v[40:43], v[168:171]
ds_read_b64_tr_b16 a[12:13], v5 offset:12800
v_mfma_f32_16x16x32_bf16 v[168:171], a[40:43], v[48:51], v[168:171]
ds_read_b64_tr_b16 a[14:15], v5 offset:14848
v_mfma_f32_16x16x32_bf16 v[168:171], a[44:47], v[56:59], v[168:171]
ds_read_b64_tr_b16 a[16:17], v5 offset:16896
v_mfma_f32_16x16x32_bf16 v[172:175], a[36:39], v[44:47], v[172:175]
ds_read_b64_tr_b16 a[18:19], v5 offset:18944
v_mfma_f32_16x16x32_bf16 v[172:175], a[40:43], v[52:55], v[172:175]
ds_read_b64_tr_b16 a[20:21], v5 offset:20992
v_mfma_f32_16x16x32_bf16 v[172:175], a[44:47], v[60:63], v[172:175]
s_waitcnt lgkmcnt(5)
ds_read_b64_tr_b16 a[22:23], v5 offset:23040
v_mfma_f32_16x16x32_bf16 v[176:179], a[0:3], v[16:19], 0
ds_read_b64_tr_b16 a[24:25], v5 offset:768
v_mfma_f32_16x16x32_bf16 v[176:179], a[4:7], v[24:27], v[176:179]
ds_read_b64_tr_b16 a[26:27], v5 offset:2816
v_mfma_f32_16x16x32_bf16 v[176:179], a[8:11], v[32:35], v[176:179]
ds_read_b64_tr_b16 a[28:29], v5 offset:4864
v_mfma_f32_16x16x32_bf16 v[180:183], a[0:3], v[20:23], 0
ds_read_b64_tr_b16 a[30:31], v5 offset:6912
v_mfma_f32_16x16x32_bf16 v[180:183], a[4:7], v[28:31], v[180:183]
ds_read_b64_tr_b16 a[32:33], v5 offset:8960
v_mfma_f32_16x16x32_bf16 v[180:183], a[8:11], v[36:39], v[180:183]
s_waitcnt lgkmcnt(5)
ds_read_b64_tr_b16 a[34:35], v5 offset:11008
v_mfma_f32_16x16x32_bf16 v[176:179], a[12:15], v[40:43], v[176:179]
ds_read_b64_tr_b16 a[36:37], v5 offset:13056
v_mfma_f32_16x16x32_bf16 v[176:179], a[16:19], v[48:51], v[176:179]
ds_read_b64_tr_b16 a[38:39], v5 offset:15104
v_mfma_f32_16x16x32_bf16 v[176:179], a[20:23], v[56:59], v[176:179]
ds_read_b64_tr_b16 a[40:41], v5 offset:17152
v_mfma_f32_16x16x32_bf16 v[180:183], a[12:15], v[44:47], v[180:183]
ds_read_b64_tr_b16 a[42:43], v5 offset:19200
v_mfma_f32_16x16x32_bf16 v[180:183], a[16:19], v[52:55], v[180:183]
s_waitcnt vmcnt(12)
ds_read_b64_tr_b16 a[44:45], v5 offset:21248
s_barrier
v_mfma_f32_16x16x32_bf16 v[180:183], a[20:23], v[60:63], v[180:183]
s_waitcnt lgkmcnt(5)
ds_read_b64_tr_b16 a[46:47], v5 offset:23296
v_mfma_f32_16x16x32_bf16 v[184:187], a[24:27], v[16:19], 0
ds_read_b64_tr_b16 a[0:1], v5 offset:24576
v_mfma_f32_16x16x32_bf16 v[184:187], a[28:31], v[24:27], v[184:187]
ds_read_b64_tr_b16 a[2:3], v5 offset:26624
v_mfma_f32_16x16x32_bf16 v[184:187], a[32:35], v[32:35], v[184:187]
ds_read_b64_tr_b16 a[4:5], v5 offset:28672
v_mfma_f32_16x16x32_bf16 v[188:191], a[24:27], v[20:23], 0
ds_read_b64_tr_b16 a[6:7], v5 offset:30720
v_mfma_f32_16x16x32_bf16 v[188:191], a[28:31], v[28:31], v[188:191]
ds_read_b64_tr_b16 a[8:9], v5 offset:32768
v_mfma_f32_16x16x32_bf16 v[188:191], a[32:35], v[36:39], v[188:191]
s_waitcnt lgkmcnt(5)
ds_read_b64_tr_b16 a[10:11], v5 offset:34816
v_mfma_f32_16x16x32_bf16 v[184:187], a[36:39], v[40:43], v[184:187]
ds_read_b64_tr_b16 a[12:13], v6 offset:0
v_mfma_f32_16x16x32_bf16 v[184:187], a[40:43], v[48:51], v[184:187]
ds_read_b64_tr_b16 a[14:15], v6 offset:2048
v_mfma_f32_16x16x32_bf16 v[184:187], a[44:47], v[56:59], v[184:187]
ds_read_b64_tr_b16 a[16:17], v6 offset:4096
v_mfma_f32_16x16x32_bf16 v[188:191], a[36:39], v[44:47], v[188:191]
ds_read_b64_tr_b16 a[18:19], v6 offset:6144
v_mfma_f32_16x16x32_bf16 v[188:191], a[40:43], v[52:55], v[188:191]
s_lshl_b32 s38, s23, 6
ds_read_b64_tr_b16 a[20:21], v6 offset:8192
v_mfma_f32_16x16x32_bf16 v[188:191], a[44:47], v[60:63], v[188:191]
s_add_u32 s38, s38, 0x4a4000
ds_read_b64_tr_b16 a[22:23], v6 offset:10240
v_mfma_f32_16x16x32_bf16 v[240:243], a[72:75], v[64:67], v[240:243]
buffer_load_dword v248, v251, s[8:11], s38 offen offset:0 sc1
v_mfma_f32_16x16x32_bf16 v[240:243], a[76:79], v[72:75], v[240:243]
buffer_load_dword v249, v251, s[8:11], s38 offen offset:64 sc1
v_mfma_f32_16x16x32_bf16 v[240:243], a[80:83], v[80:83], v[240:243]
s_add_u32 s36, s31, 0
v_mfma_f32_16x16x32_bf16 v[240:243], a[84:87], v[88:91], v[240:243]
buffer_load_dwordx2 v[192:193], v7, s[16:19], s36 offen offset:0
v_mfma_f32_16x16x32_bf16 v[240:243], a[88:91], v[96:99], v[240:243]
buffer_load_dwordx2 v[194:195], v7, s[16:19], s36 offen offset:32
v_mfma_f32_16x16x32_bf16 v[240:243], a[92:95], v[104:107], v[240:243]
buffer_load_dwordx2 v[196:197], v7, s[16:19], s36 offen offset:64
v_mfma_f32_16x16x32_bf16 v[244:247], a[72:75], v[68:71], v[244:247]
buffer_load_dwordx2 v[198:199], v7, s[16:19], s36 offen offset:96
s_add_u32 s36, s31, 18432
v_mfma_f32_16x16x32_bf16 v[244:247], a[76:79], v[76:79], v[244:247]
buffer_load_dwordx2 v[200:201], v7, s[16:19], s36 offen offset:0
v_mfma_f32_16x16x32_bf16 v[244:247], a[80:83], v[84:87], v[244:247]
buffer_load_dwordx2 v[202:203], v7, s[16:19], s36 offen offset:32
v_mfma_f32_16x16x32_bf16 v[244:247], a[84:87], v[92:95], v[244:247]
buffer_load_dwordx2 v[204:205], v7, s[16:19], s36 offen offset:64
v_mfma_f32_16x16x32_bf16 v[244:247], a[88:91], v[100:103], v[244:247]
buffer_load_dwordx2 v[206:207], v7, s[16:19], s36 offen offset:96
v_mfma_f32_16x16x32_bf16 v[244:247], a[92:95], v[108:111], v[244:247]
s_waitcnt lgkmcnt(6)
v_mfma_f32_16x16x32_bf16 v[160:163], a[0:3], v[64:67], v[160:163]
ds_read_b64_tr_b16 a[24:25], v5 offset:24832
v_mfma_f32_16x16x32_bf16 v[160:163], a[4:7], v[72:75], v[160:163]
ds_read_b64_tr_b16 a[26:27], v5 offset:26880
v_mfma_f32_16x16x32_bf16 v[160:163], a[8:11], v[80:83], v[160:163]
ds_read_b64_tr_b16 a[28:29], v5 offset:28928
v_mfma_f32_16x16x32_bf16 v[164:167], a[0:3], v[68:71], v[164:167]
ds_read_b64_tr_b16 a[30:31], v5 offset:30976
v_mfma_f32_16x16x32_bf16 v[164:167], a[4:7], v[76:79], v[164:167]
ds_read_b64_tr_b16 a[32:33], v5 offset:33024
v_mfma_f32_16x16x32_bf16 v[164:167], a[8:11], v[84:87], v[164:167]
s_waitcnt lgkmcnt(5)
ds_read_b64_tr_b16 a[34:35], v5 offset:35072
v_mfma_f32_16x16x32_bf16 v[160:163], a[12:15], v[88:91], v[160:163]
ds_read_b64_tr_b16 a[36:37], v6 offset:256
v_mfma_f32_16x16x32_bf16 v[160:163], a[16:19], v[96:99], v[160:163]
ds_read_b64_tr_b16 a[38:39], v6 offset:2304
v_mfma_f32_16x16x32_bf16 v[160:163], a[20:23], v[104:107], v[160:163]
ds_read_b64_tr_b16 a[40:41], v6 offset:4352
v_mfma_f32_16x16x32_bf16 v[164:167], a[12:15], v[92:95], v[164:167]
ds_read_b64_tr_b16 a[42:43], v6 offset:6400
v_mfma_f32_16x16x32_bf16 v[164:167], a[16:19], v[100:103], v[164:167]
ds_read_b64_tr_b16 a[44:45], v6 offset:8448
v_mfma_f32_16x16x32_bf16 v[164:167], a[20:23], v[108:111], v[164:167]
s_waitcnt lgkmcnt(5)
ds_read_b64_tr_b16 a[46:47], v6 offset:10496
v_mfma_f32_16x16x32_bf16 v[168:171], a[24:27], v[64:67], v[168:171]
ds_read_b64_tr_b16 a[0:1], v5 offset:25088
v_mfma_f32_16x16x32_bf16 v[168:171], a[28:31], v[72:75], v[168:171]
ds_read_b64_tr_b16 a[2:3], v5 offset:27136
v_mfma_f32_16x16x32_bf16 v[168:171], a[32:35], v[80:83], v[168:171]
ds_read_b64_tr_b16 a[4:5], v5 offset:29184
v_mfma_f32_16x16x32_bf16 v[172:175], a[24:27], v[68:71], v[172:175]
ds_read_b64_tr_b16 a[6:7], v5 offset:31232
v_mfma_f32_16x16x32_bf16 v[172:175], a[28:31], v[76:79], v[172:175]
ds_read_b64_tr_b16 a[8:9], v5 offset:33280
v_mfma_f32_16x16x32_bf16 v[172:175], a[32:35], v[84:87], v[172:175]
s_waitcnt lgkmcnt(5)
ds_read_b64_tr_b16 a[10:11], v5 offset:35328
v_mfma_f32_16x16x32_bf16 v[168:171], a[36:39], v[88:91], v[168:171]
ds_read_b64_tr_b16 a[12:13], v6 offset:512
v_mfma_f32_16x16x32_bf16 v[168:171], a[40:43], v[96:99], v[168:171]
ds_read_b64_tr_b16 a[14:15], v6 offset:2560
v_mfma_f32_16x16x32_bf16 v[168:171], a[44:47], v[104:107], v[168:171]
ds_read_b64_tr_b16 a[16:17], v6 offset:4608
v_mfma_f32_16x16x32_bf16 v[172:175], a[36:39], v[92:95], v[172:175]
ds_read_b64_tr_b16 a[18:19], v6 offset:6656
v_mfma_f32_16x16x32_bf16 v[172:175], a[40:43], v[100:103], v[172:175]
ds_read_b64_tr_b16 a[20:21], v6 offset:8704
v_mfma_f32_16x16x32_bf16 v[172:175], a[44:47], v[108:111], v[172:175]
s_waitcnt lgkmcnt(5)
ds_read_b64_tr_b16 a[22:23], v6 offset:10752
v_mfma_f32_16x16x32_bf16 v[176:179], a[0:3], v[64:67], v[176:179]
ds_read_b64_tr_b16 a[24:25], v5 offset:25344
v_mfma_f32_16x16x32_bf16 v[176:179], a[4:7], v[72:75], v[176:179]
ds_read_b64_tr_b16 a[26:27], v5 offset:27392
v_mfma_f32_16x16x32_bf16 v[176:179], a[8:11], v[80:83], v[176:179]
ds_read_b64_tr_b16 a[28:29], v5 offset:29440
v_mfma_f32_16x16x32_bf16 v[180:183], a[0:3], v[68:71], v[180:183]
ds_read_b64_tr_b16 a[30:31], v5 offset:31488
v_mfma_f32_16x16x32_bf16 v[180:183], a[4:7], v[76:79], v[180:183]
ds_read_b64_tr_b16 a[32:33], v5 offset:33536
v_mfma_f32_16x16x32_bf16 v[180:183], a[8:11], v[84:87], v[180:183]
s_waitcnt lgkmcnt(5)
ds_read_b64_tr_b16 a[34:35], v5 offset:35584
v_mfma_f32_16x16x32_bf16 v[176:179], a[12:15], v[88:91], v[176:179]
ds_read_b64_tr_b16 a[36:37], v6 offset:768
v_mfma_f32_16x16x32_bf16 v[176:179], a[16:19], v[96:99], v[176:179]
ds_read_b64_tr_b16 a[38:39], v6 offset:2816
v_mfma_f32_16x16x32_bf16 v[176:179], a[20:23], v[104:107], v[176:179]
ds_read_b64_tr_b16 a[40:41], v6 offset:4864
v_mfma_f32_16x16x32_bf16 v[180:183], a[12:15], v[92:95], v[180:183]
ds_read_b64_tr_b16 a[42:43], v6 offset:6912
v_mfma_f32_16x16x32_bf16 v[180:183], a[16:19], v[100:103], v[180:183]
s_waitcnt vmcnt(10)
ds_read_b64_tr_b16 a[44:45], v6 offset:8960
s_barrier
v_mfma_f32_16x16x32_bf16 v[180:183], a[20:23], v[108:111], v[180:183]
s_waitcnt lgkmcnt(5)
ds_read_b64_tr_b16 a[46:47], v6 offset:11008
v_mfma_f32_16x16x32_bf16 v[184:187], a[24:27], v[64:67], v[184:187]
ds_read_b64_tr_b16 a[0:1], v6 offset:12288
v_mfma_f32_16x16x32_bf16 v[184:187], a[28:31], v[72:75], v[184:187]
ds_read_b64_tr_b16 a[2:3], v6 offset:14336
v_mfma_f32_16x16x32_bf16 v[184:187], a[32:35], v[80:83], v[184:187]
ds_read_b64_tr_b16 a[4:5], v6 offset:16384
v_mfma_f32_16x16x32_bf16 v[188:191], a[24:27], v[68:71], v[188:191]
ds_read_b64_tr_b16 a[6:7], v6 offset:18432
v_mfma_f32_16x16x32_bf16 v[188:191], a[28:31], v[76:79], v[188:191]
ds_read_b64_tr_b16 a[8:9], v6 offset:20480
v_mfma_f32_16x16x32_bf16 v[188:191], a[32:35], v[84:87], v[188:191]
s_waitcnt lgkmcnt(5)
ds_read_b64_tr_b16 a[10:11], v6 offset:22528
v_mfma_f32_16x16x32_bf16 v[184:187], a[36:39], v[88:91], v[184:187]
ds_read_b64_tr_b16 a[12:13], v6 offset:24576
v_mfma_f32_16x16x32_bf16 v[184:187], a[40:43], v[96:99], v[184:187]
ds_read_b64_tr_b16 a[14:15], v6 offset:26624
v_mfma_f32_16x16x32_bf16 v[184:187], a[44:47], v[104:107], v[184:187]
ds_read_b64_tr_b16 a[16:17], v6 offset:28672
v_mfma_f32_16x16x32_bf16 v[188:191], a[36:39], v[92:95], v[188:191]
ds_read_b64_tr_b16 a[18:19], v6 offset:30720
v_mfma_f32_16x16x32_bf16 v[188:191], a[40:43], v[100:103], v[188:191]
ds_read_b64_tr_b16 a[20:21], v6 offset:32768
v_mfma_f32_16x16x32_bf16 v[188:191], a[44:47], v[108:111], v[188:191]
ds_read_b64_tr_b16 a[22:23], v6 offset:34816
v_mfma_f32_16x16x32_bf16 v[240:243], a[96:99], v[112:115], v[240:243]
v_mfma_f32_16x16x32_bf16 v[240:243], a[100:103], v[120:123], v[240:243]
v_mfma_f32_16x16x32_bf16 v[240:243], a[104:107], v[128:131], v[240:243]
v_mfma_f32_16x16x32_bf16 v[240:243], a[108:111], v[136:139], v[240:243]
v_mfma_f32_16x16x32_bf16 v[240:243], a[112:115], v[144:147], v[240:243]
v_mfma_f32_16x16x32_bf16 v[240:243], a[116:119], v[152:155], v[240:243]
v_mfma_f32_16x16x32_bf16 v[244:247], a[96:99], v[116:119], v[244:247]
v_mfma_f32_16x16x32_bf16 v[244:247], a[100:103], v[124:127], v[244:247]
v_mfma_f32_16x16x32_bf16 v[244:247], a[104:107], v[132:135], v[244:247]
v_mfma_f32_16x16x32_bf16 v[244:247], a[108:111], v[140:143], v[244:247]
v_mfma_f32_16x16x32_bf16 v[244:247], a[112:115], v[148:151], v[244:247]
v_mfma_f32_16x16x32_bf16 v[244:247], a[116:119], v[156:159], v[244:247]
s_waitcnt lgkmcnt(6)
v_mfma_f32_16x16x32_bf16 v[160:163], a[0:3], v[112:115], v[160:163]
ds_read_b64_tr_b16 a[24:25], v6 offset:12544
v_mfma_f32_16x16x32_bf16 v[160:163], a[4:7], v[120:123], v[160:163]
ds_read_b64_tr_b16 a[26:27], v6 offset:14592
v_mfma_f32_16x16x32_bf16 v[160:163], a[8:11], v[128:131], v[160:163]
ds_read_b64_tr_b16 a[28:29], v6 offset:16640
v_mfma_f32_16x16x32_bf16 v[164:167], a[0:3], v[116:119], v[164:167]
ds_read_b64_tr_b16 a[30:31], v6 offset:18688
v_mfma_f32_16x16x32_bf16 v[164:167], a[4:7], v[124:127], v[164:167]
ds_read_b64_tr_b16 a[32:33], v6 offset:20736
v_mfma_f32_16x16x32_bf16 v[164:167], a[8:11], v[132:135], v[164:167]
s_waitcnt lgkmcnt(5)
ds_read_b64_tr_b16 a[34:35], v6 offset:22784
v_mfma_f32_16x16x32_bf16 v[160:163], a[12:15], v[136:139], v[160:163]
ds_read_b64_tr_b16 a[36:37], v6 offset:24832
v_mfma_f32_16x16x32_bf16 v[160:163], a[16:19], v[144:147], v[160:163]
ds_read_b64_tr_b16 a[38:39], v6 offset:26880
v_mfma_f32_16x16x32_bf16 v[160:163], a[20:23], v[152:155], v[160:163]
ds_read_b64_tr_b16 a[40:41], v6 offset:28928
v_mfma_f32_16x16x32_bf16 v[164:167], a[12:15], v[140:143], v[164:167]
ds_read_b64_tr_b16 a[42:43], v6 offset:30976
v_mfma_f32_16x16x32_bf16 v[164:167], a[16:19], v[148:151], v[164:167]
ds_read_b64_tr_b16 a[44:45], v6 offset:33024
v_mfma_f32_16x16x32_bf16 v[164:167], a[20:23], v[156:159], v[164:167]
s_waitcnt lgkmcnt(5)
ds_read_b64_tr_b16 a[46:47], v6 offset:35072
v_mfma_f32_16x16x32_bf16 v[168:171], a[24:27], v[112:115], v[168:171]
ds_read_b64_tr_b16 a[0:1], v6 offset:12800
v_mfma_f32_16x16x32_bf16 v[168:171], a[28:31], v[120:123], v[168:171]
ds_read_b64_tr_b16 a[2:3], v6 offset:14848
v_mfma_f32_16x16x32_bf16 v[168:171], a[32:35], v[128:131], v[168:171]
ds_read_b64_tr_b16 a[4:5], v6 offset:16896
v_mfma_f32_16x16x32_bf16 v[172:175], a[24:27], v[116:119], v[172:175]
ds_read_b64_tr_b16 a[6:7], v6 offset:18944
v_mfma_f32_16x16x32_bf16 v[172:175], a[28:31], v[124:127], v[172:175]
ds_read_b64_tr_b16 a[8:9], v6 offset:20992
v_mfma_f32_16x16x32_bf16 v[172:175], a[32:35], v[132:135], v[172:175]
s_waitcnt lgkmcnt(5)
ds_read_b64_tr_b16 a[10:11], v6 offset:23040
v_mfma_f32_16x16x32_bf16 v[168:171], a[36:39], v[136:139], v[168:171]
ds_read_b64_tr_b16 a[12:13], v6 offset:25088
v_mfma_f32_16x16x32_bf16 v[168:171], a[40:43], v[144:147], v[168:171]
ds_read_b64_tr_b16 a[14:15], v6 offset:27136
v_mfma_f32_16x16x32_bf16 v[168:171], a[44:47], v[152:155], v[168:171]
ds_read_b64_tr_b16 a[16:17], v6 offset:29184
v_mfma_f32_16x16x32_bf16 v[172:175], a[36:39], v[140:143], v[172:175]
ds_read_b64_tr_b16 a[18:19], v6 offset:31232
v_mfma_f32_16x16x32_bf16 v[172:175], a[40:43], v[148:151], v[172:175]
ds_read_b64_tr_b16 a[20:21], v6 offset:33280
v_mfma_f32_16x16x32_bf16 v[172:175], a[44:47], v[156:159], v[172:175]
s_waitcnt lgkmcnt(5)
ds_read_b64_tr_b16 a[22:23], v6 offset:35328
v_mfma_f32_16x16x32_bf16 v[176:179], a[0:3], v[112:115], v[176:179]
ds_read_b64_tr_b16 a[24:25], v6 offset:13056
v_mfma_f32_16x16x32_bf16 v[176:179], a[4:7], v[120:123], v[176:179]
ds_read_b64_tr_b16 a[26:27], v6 offset:15104
v_mfma_f32_16x16x32_bf16 v[176:179], a[8:11], v[128:131], v[176:179]
ds_read_b64_tr_b16 a[28:29], v6 offset:17152
v_mfma_f32_16x16x32_bf16 v[180:183], a[0:3], v[116:119], v[180:183]
ds_read_b64_tr_b16 a[30:31], v6 offset:19200
v_mfma_f32_16x16x32_bf16 v[180:183], a[4:7], v[124:127], v[180:183]
ds_read_b64_tr_b16 a[32:33], v6 offset:21248
v_mfma_f32_16x16x32_bf16 v[180:183], a[8:11], v[132:135], v[180:183]
s_waitcnt lgkmcnt(5)
ds_read_b64_tr_b16 a[34:35], v6 offset:23296
v_mfma_f32_16x16x32_bf16 v[176:179], a[12:15], v[136:139], v[176:179]
ds_read_b64_tr_b16 a[36:37], v6 offset:25344
v_mfma_f32_16x16x32_bf16 v[176:179], a[16:19], v[144:147], v[176:179]
ds_read_b64_tr_b16 a[38:39], v6 offset:27392
v_mfma_f32_16x16x32_bf16 v[176:179], a[20:23], v[152:155], v[176:179]
ds_read_b64_tr_b16 a[40:41], v6 offset:29440
v_mfma_f32_16x16x32_bf16 v[180:183], a[12:15], v[140:143], v[180:183]
ds_read_b64_tr_b16 a[42:43], v6 offset:31488
v_mfma_f32_16x16x32_bf16 v[180:183], a[16:19], v[148:151], v[180:183]
ds_read_b64_tr_b16 a[44:45], v6 offset:33536
v_mfma_f32_16x16x32_bf16 v[180:183], a[20:23], v[156:159], v[180:183]
s_waitcnt lgkmcnt(5)
ds_read_b64_tr_b16 a[46:47], v6 offset:35584
v_mfma_f32_16x16x32_bf16 v[184:187], a[24:27], v[112:115], v[184:187]
v_mfma_f32_16x16x32_bf16 v[184:187], a[28:31], v[120:123], v[184:187]
v_mfma_f32_16x16x32_bf16 v[184:187], a[32:35], v[128:131], v[184:187]
v_mfma_f32_16x16x32_bf16 v[188:191], a[24:27], v[116:119], v[188:191]
v_mfma_f32_16x16x32_bf16 v[188:191], a[28:31], v[124:127], v[188:191]
v_mfma_f32_16x16x32_bf16 v[188:191], a[32:35], v[132:135], v[188:191]
s_waitcnt lgkmcnt(0)
v_mfma_f32_16x16x32_bf16 v[184:187], a[36:39], v[136:139], v[184:187]
v_mfma_f32_16x16x32_bf16 v[184:187], a[40:43], v[144:147], v[184:187]
v_mfma_f32_16x16x32_bf16 v[184:187], a[44:47], v[152:155], v[184:187]
v_mfma_f32_16x16x32_bf16 v[188:191], a[36:39], v[140:143], v[188:191]
v_mfma_f32_16x16x32_bf16 v[188:191], a[40:43], v[148:151], v[188:191]
v_mfma_f32_16x16x32_bf16 v[188:191], a[44:47], v[156:159], v[188:191]
s_cmp_ge_u32 s23, 128
s_cbranch_scc1 L_sequential_preLN__sliding_local_dilated__glu_gated_geglu__prompt_kernel_p1_join
s_waitcnt vmcnt(0)
s_nop 4
v_dot2_f32_bf16 v160, v192, s32, v160
v_dot2_f32_bf16 v161, v192, s33, v161
v_dot2_f32_bf16 v162, v193, s32, v162
v_dot2_f32_bf16 v163, v193, s33, v163
v_dot2_f32_bf16 v168, v194, s32, v168
v_dot2_f32_bf16 v169, v194, s33, v169
v_dot2_f32_bf16 v170, v195, s32, v170
v_dot2_f32_bf16 v171, v195, s33, v171
v_dot2_f32_bf16 v176, v196, s32, v176
v_dot2_f32_bf16 v177, v196, s33, v177
v_dot2_f32_bf16 v178, v197, s32, v178
v_dot2_f32_bf16 v179, v197, s33, v179
v_dot2_f32_bf16 v184, v198, s32, v184
v_dot2_f32_bf16 v185, v198, s33, v185
v_dot2_f32_bf16 v186, v199, s32, v186
v_dot2_f32_bf16 v187, v199, s33, v187
v_dot2_f32_bf16 v164, v200, s32, v164
v_dot2_f32_bf16 v165, v200, s33, v165
v_dot2_f32_bf16 v166, v201, s32, v166
v_dot2_f32_bf16 v167, v201, s33, v167
v_dot2_f32_bf16 v172, v202, s32, v172
v_dot2_f32_bf16 v173, v202, s33, v173
v_dot2_f32_bf16 v174, v203, s32, v174
v_dot2_f32_bf16 v175, v203, s33, v175
v_dot2_f32_bf16 v180, v204, s32, v180
v_dot2_f32_bf16 v181, v204, s33, v181
v_dot2_f32_bf16 v182, v205, s32, v182
v_dot2_f32_bf16 v183, v205, s33, v183
v_dot2_f32_bf16 v188, v206, s32, v188
v_dot2_f32_bf16 v189, v206, s33, v189
v_dot2_f32_bf16 v190, v207, s32, v190
v_dot2_f32_bf16 v191, v207, s33, v191
v_add_f32 v240, v240, v241
v_add_f32 v244, v244, v245
v_add_f32 v240, v240, v248
v_add_f32 v244, v244, v249
v_sub_f32 v16, v160, v240
v_sub_f32 v17, v161, v240
v_sub_f32 v18, v162, v240
v_sub_f32 v19, v163, v240
v_sub_f32 v20, v168, v240
v_sub_f32 v21, v169, v240
v_sub_f32 v22, v170, v240
v_sub_f32 v23, v171, v240
v_sub_f32 v24, v176, v240
v_sub_f32 v25, v177, v240
v_sub_f32 v26, v178, v240
v_sub_f32 v27, v179, v240
v_sub_f32 v28, v184, v240
v_sub_f32 v29, v185, v240
v_sub_f32 v30, v186, v240
v_sub_f32 v31, v187, v240
v_sub_f32 v32, v164, v244
v_sub_f32 v33, v165, v244
v_sub_f32 v34, v166, v244
v_sub_f32 v35, v167, v244
v_sub_f32 v36, v172, v244
v_sub_f32 v37, v173, v244
v_sub_f32 v38, v174, v244
v_sub_f32 v39, v175, v244
v_sub_f32 v40, v180, v244
v_sub_f32 v41, v181, v244
v_sub_f32 v42, v182, v244
v_sub_f32 v43, v183, v244
v_sub_f32 v44, v188, v244
v_sub_f32 v45, v189, v244
v_sub_f32 v46, v190, v244
v_sub_f32 v47, v191, v244
s_add_u32 s24, s23, 0
s_mul_i32 s24, s24, 18
s_lshl_b32 s25, s22, 1
s_add_u32 s24, s24, s25
s_lshl_b32 s24, s24, 10
s_add_u32 s39, s24, 0x2900000
v_cvt_pk_bf16_f32 v48, v16, v17
v_cvt_pk_bf16_f32 v49, v18, v19
v_cvt_pk_bf16_f32 v50, v20, v21
v_cvt_pk_bf16_f32 v51, v22, v23
buffer_store_dwordx4 v[48:51], v1, s[8:11], s39 offen offset:0 sc1
v_cvt_pk_bf16_f32 v52, v24, v25
v_cvt_pk_bf16_f32 v53, v26, v27
v_cvt_pk_bf16_f32 v54, v28, v29
v_cvt_pk_bf16_f32 v55, v30, v31
buffer_store_dwordx4 v[52:55], v1, s[8:11], s39 offen offset:1024 sc1
s_add_u32 s24, s23, 1
s_mul_i32 s24, s24, 18
s_lshl_b32 s25, s22, 1
s_add_u32 s24, s24, s25
s_lshl_b32 s24, s24, 10
s_add_u32 s39, s24, 0x2900000
v_cvt_pk_bf16_f32 v56, v32, v33
v_cvt_pk_bf16_f32 v57, v34, v35
v_cvt_pk_bf16_f32 v58, v36, v37
v_cvt_pk_bf16_f32 v59, v38, v39
buffer_store_dwordx4 v[56:59], v1, s[8:11], s39 offen offset:0 sc1
v_cvt_pk_bf16_f32 v60, v40, v41
v_cvt_pk_bf16_f32 v61, v42, v43
v_cvt_pk_bf16_f32 v62, v44, v45
v_cvt_pk_bf16_f32 v63, v46, v47
buffer_store_dwordx4 v[60:63], v1, s[8:11], s39 offen offset:1024 sc1
v_mul_f32 v209, v16, v16
v_fma_f32 v209, v17, v17, v209
v_fma_f32 v209, v18, v18, v209
v_fma_f32 v209, v19, v19, v209
v_fma_f32 v209, v20, v20, v209
v_fma_f32 v209, v21, v21, v209
v_fma_f32 v209, v22, v22, v209
v_fma_f32 v209, v23, v23, v209
v_fma_f32 v209, v24, v24, v209
v_fma_f32 v209, v25, v25, v209
v_fma_f32 v209, v26, v26, v209
v_fma_f32 v209, v27, v27, v209
v_fma_f32 v209, v28, v28, v209
v_fma_f32 v209, v29, v29, v209
v_fma_f32 v209, v30, v30, v209
v_fma_f32 v209, v31, v31, v209
v_mul_f32 v211, v32, v32
v_fma_f32 v211, v33, v33, v211
v_fma_f32 v211, v34, v34, v211
v_fma_f32 v211, v35, v35, v211
v_fma_f32 v211, v36, v36, v211
v_fma_f32 v211, v37, v37, v211
v_fma_f32 v211, v38, v38, v211
v_fma_f32 v211, v39, v39, v211
v_fma_f32 v211, v40, v40, v211
v_fma_f32 v211, v41, v41, v211
v_fma_f32 v211, v42, v42, v211
v_fma_f32 v211, v43, v43, v211
v_fma_f32 v211, v44, v44, v211
v_fma_f32 v211, v45, v45, v211
v_fma_f32 v211, v46, v46, v211
v_fma_f32 v211, v47, v47, v211
v_mov_b32 v213, v209
v_mov_b32 v215, v211
s_nop 1
v_permlane32_swap_b32 v209, v213
v_permlane32_swap_b32 v211, v215
s_nop 1
v_add_f32 v209, v209, v213
v_add_f32 v211, v211, v215
v_mov_b32 v213, v209
v_mov_b32 v215, v211
s_nop 1
v_permlane16_swap_b32 v209, v213
v_permlane16_swap_b32 v211, v215
s_nop 1
v_add_f32 v209, v209, v213
v_add_f32 v211, v211, v215
v_mov_b32 v208, v240
v_mov_b32 v210, v244
v_and_b32 v8, 15, v0
v_lshlrev_b32 v8, 3, v8
s_lshl_b32 s24, s22, 11
s_lshl_b32 s25, s23, 4
s_add_u32 s24, s24, s25
s_lshl_b32 s24, s24, 3
s_add_u32 s24, s24, 0x480000
s_mov_b64 exec, 0xffff
buffer_store_dwordx2 v[208:209], v8, s[8:11], s24 offen offset:0 sc1
buffer_store_dwordx2 v[210:211], v8, s[8:11], s24 offen offset:128 sc1
L_sequential_preLN__sliding_local_dilated__glu_gated_geglu__prompt_kernel_p1_join:
s_mov_b64 exec, -1
s_waitcnt vmcnt(0)
s_barrier
s_cmp_lg_u32 s20, 0
s_cbranch_scc1 L_sequential_preLN__sliding_local_dilated__glu_gated_geglu__prompt_kernel_mlp
s_lshl_b32 s24, s21, 8
s_add_u32 s24, s24, 0x4b2000
v_mov_b32 v8, 1
s_mov_b64 exec, 1
buffer_atomic_add v8, off, s[8:11], s24
s_mov_b64 exec, -1
s_branch L_sequential_preLN__sliding_local_dilated__glu_gated_geglu__prompt_kernel_mlp
L_sequential_preLN__sliding_local_dilated__glu_gated_geglu__prompt_kernel_p1_w3:
s_barrier
s_barrier
s_barrier
s_barrier
s_barrier
L_sequential_preLN__sliding_local_dilated__glu_gated_geglu__prompt_kernel_mlp:
s_mov_b32 s24, s20
s_load_dwordx2 s[56:57], s[0:1], 72
s_load_dwordx4 s[4:7], s[0:1], 32
s_load_dwordx2 s[54:55], s[0:1], 48
v_lshlrev_b32 v30, 4, v0
v_lshrrev_b32 v2, 4, v0
v_and_b32 v1, 15, v0
v_lshl_add_u32 v1, v2, 11, v1
v_lshlrev_b32 v1, 3, v1
s_and_b32 s58, s2, 7
s_lshr_b32 s60, s2, 3
s_and_b32 s59, s60, 1
s_lshr_b32 s60, s60, 1
s_lshl_b32 s41, s60, 2
s_add_u32 s41, s41, s24
s_mul_i32 s48, s41, 36864
s_add_u32 s48, s48, 0x2900000
s_lshl_b32 s53, s41, 8
s_mul_i32 s42, s59, 0
s_sub_u32 s101, s48, s42
s_add_u32 s48, s48, s42
s_waitcnt lgkmcnt(0)
s_mov_b32 s20, s56
s_mov_b32 s21, s57
s_mov_b32 s22, 0x2b40000
s_mov_b32 s23, 0x20000
s_mov_b32 s8, s4
s_mov_b32 s9, s5
s_mov_b32 s10, 0x510000
s_mov_b32 s11, 0x20000
s_mov_b32 s12, s6
s_mov_b32 s13, s7
s_mov_b32 s14, 0x510000
s_mov_b32 s15, 0x20000
s_add_u32 s4, s56, 0x480000
s_addc_u32 s5, s57, 0
s_mov_b32 s6, 147456
s_mov_b32 s7, 0x20000
v_mov_b32 v56, v1
s_mov_b32 s16, s54
s_mov_b32 s17, s55
s_mov_b32 s18, 0x510000
s_mov_b32 s19, 0x20000
v_bfe_u32 v1, v0, 1, 3
v_mul_u32_u24 v1, 9216, v1
v_lshl_add_u32 v1, v2, 5, v1
v_and_b32 v32, 1, v0
v_lshl_add_u32 v9, v32, 4, v1
v_add_u32 v10, 72704, v9
v_add_u32 v11, 145408, v9
s_mul_i32 s41, s58, 576
s_mul_i32 s42, s59, 320
s_add_u32 s61, s41, s42
s_lshl_b32 s42, s59, 5
s_add_u32 s62, s41, s42
s_add_u32 s62, s62, 256
s_mul_i32 s41, s24, 663552
s_lshl_b32 s42, s61, 1
s_add_u32 s25, s41, s42
s_mul_i32 s42, s59, 0
s_add_u32 s100, s25, 2654208
s_sub_u32 s100, s100, s42
s_add_u32 s25, s25, s42
s_mul_i32 s38, s24, 9216
s_mov_b32 s96, 0
s_mov_b32 s97, 1
s_mov_b32 s36, s38
s_mov_b32 s41, s25
s_mov_b32 m0, s36
s_nop 0
buffer_load_dwordx4 v9, s[8:11], s41 offen offset:0  lds
v_bfe_u32 v32, v0, 2, 2
v_lshlrev_b32 v32, 5, v32
buffer_load_dwordx4 v10, s[8:11], s41 offen offset:1024  lds
v_and_b32 v33, 3, v0
v_lshl_add_u32 v32, v33, 3, v32
buffer_load_dwordx4 v11, s[8:11], s41 offen offset:2048  lds
v_lshl_add_u32 v6, v2, 7, v32
v_and_b32 v33, 1, v2
s_add_u32 s41, s25, 0x36000
s_add_u32 m0, s36, 3072
s_nop 0
buffer_load_dwordx4 v9, s[8:11], s41 offen offset:0  lds
v_lshlrev_b32 v33, 7, v33
v_lshrrev_b32 v34, 1, v2
buffer_load_dwordx4 v10, s[8:11], s41 offen offset:1024  lds
v_lshl_add_u32 v34, v34, 10, v32
v_add_u32 v5, v34, v33
buffer_load_dwordx4 v11, s[8:11], s41 offen offset:2048  lds
v_mul_u32_u24 v34, 2304, v2
v_add_u32 v34, v34, v32
s_add_u32 s41, s25, 0x6c000
s_add_u32 m0, s36, 6144
s_nop 0
buffer_load_dwordx4 v9, s[8:11], s41 offen offset:0  lds
v_add_u32 v7, v34, v33
v_sub_u32 v8, v34, v33
buffer_load_dwordx4 v10, s[8:11], s41 offen offset:1024  lds
buffer_load_dwordx4 v11, s[8:11], s41 offen offset:2048  lds
s_add_u32 s96, s96, 1
s_and_b32 s96, s96, 3
s_mul_i32 s36, s96, 36864
s_add_u32 s36, s36, s38
s_cmp_lg_u32 s24, 0
s_cbranch_scc1 L_sequential_preLN__sliding_local_dilated__glu_gated_geglu__prompt_kernel_go
s_lshl_b32 s50, s60, 2
s_mul_i32 s50, s50, 171
s_lshr_b32 s50, s50, 9
s_lshl_b32 s50, s50, 8
s_add_u32 s50, s50, 0x4b2000
s_mov_b32 s52, 0x4000
L_sequential_preLN__sliding_local_dilated__glu_gated_geglu__prompt_kernel_wait:
buffer_load_dword v2, off, s[20:23], s50 sc1
buffer_load_dword v3, off, s[20:23], s50 offset:256 sc1
s_waitcnt vmcnt(0)
v_min_u32 v2, v2, v3
s_nop 0
v_readfirstlane_b32 s51, v2
s_sub_u32 s52, s52, 1
s_cmp_eq_u32 s52, 0
s_cbranch_scc1 L_sequential_preLN__sliding_local_dilated__glu_gated_geglu__prompt_kernel_go
s_cmp_ge_u32 s51, 9
s_cbranch_scc1 L_sequential_preLN__sliding_local_dilated__glu_gated_geglu__prompt_kernel_go
s_sleep 8
s_branch L_sequential_preLN__sliding_local_dilated__glu_gated_geglu__prompt_kernel_wait
L_sequential_preLN__sliding_local_dilated__glu_gated_geglu__prompt_kernel_go:
s_barrier
s_add_u32 s42, s48, 0
buffer_load_dwordx4 v[128:131], v30, s[20:23], s42 offen sc1
s_add_u32 s42, s48, 18432
buffer_load_dwordx4 v[132:135], v30, s[20:23], s42 offen sc1
s_add_u32 s42, s48, 1024
buffer_load_dwordx4 v[136:139], v30, s[20:23], s42 offen sc1
s_add_u32 s42, s48, 19456
buffer_load_dwordx4 v[140:143], v30, s[20:23], s42 offen sc1
s_add_u32 s42, s48, 2048
buffer_load_dwordx4 v[144:147], v30, s[20:23], s42 offen sc1
s_add_u32 s42, s48, 20480
buffer_load_dwordx4 v[148:151], v30, s[20:23], s42 offen sc1
s_add_u32 s42, s48, 3072
buffer_load_dwordx4 v[152:155], v30, s[20:23], s42 offen sc1
s_add_u32 s42, s48, 21504
buffer_load_dwordx4 v[156:159], v30, s[20:23], s42 offen sc1
s_add_u32 s42, s48, 4096
buffer_load_dwordx4 v[160:163], v30, s[20:23], s42 offen sc1
s_add_u32 s42, s48, 22528
buffer_load_dwordx4 v[164:167], v30, s[20:23], s42 offen sc1
s_add_u32 s42, s48, 5120
buffer_load_dwordx4 v[168:171], v30, s[20:23], s42 offen sc1
s_add_u32 s42, s48, 23552
buffer_load_dwordx4 v[172:175], v30, s[20:23], s42 offen sc1
v_mov_b32 v3, v5
v_add_u32 v4, 36864, v5
s_waitcnt vmcnt(10)
s_barrier
ds_read_b64_tr_b16 a[160:161], v3 offset:0
ds_read_b64_tr_b16 a[162:163], v3 offset:2048
ds_read_b64_tr_b16 a[164:165], v3 offset:256
ds_read_b64_tr_b16 a[166:167], v3 offset:2304
ds_read_b64_tr_b16 a[168:169], v3 offset:512
ds_read_b64_tr_b16 a[170:171], v3 offset:2560
ds_read_b64_tr_b16 a[172:173], v3 offset:768
ds_read_b64_tr_b16 a[174:175], v3 offset:2816
ds_read_b64_tr_b16 a[176:177], v3 offset:4096
ds_read_b64_tr_b16 a[178:179], v3 offset:6144
ds_read_b64_tr_b16 a[180:181], v3 offset:4352
ds_read_b64_tr_b16 a[182:183], v3 offset:6400
s_waitcnt lgkmcnt(8)
v_mfma_f32_16x16x32_bf16 v[64:67], a[160:163], v[128:131], 0
s_mov_b32 s41, s100
ds_read_b64_tr_b16 a[184:185], v3 offset:4608
s_add_u32 s42, s48, 6144
buffer_load_dwordx4 v[176:179], v30, s[20:23], s42 offen sc1
s_add_u32 s42, s48, 24576
buffer_load_dwordx4 v[180:183], v30, s[20:23], s42 offen sc1
v_and_b32 v1, 1, v0
v_bfe_u32 v2, v0, 1, 4
v_mul_u32_u24 v2, 9216, v2
s_mul_i32 s50, s24, 1327104
v_mfma_f32_16x16x32_bf16 v[68:71], a[160:163], v[132:135], 0
s_mov_b32 m0, s36
ds_read_b64_tr_b16 a[186:187], v3 offset:6656
v_lshl_add_u32 v2, v1, 4, v2
v_lshrrev_b32 v1, 5, v0
s_lshl_b32 s51, s62, 1
v_mfma_f32_16x16x32_bf16 v[72:75], a[164:167], v[128:131], 0
buffer_load_dwordx4 v9, s[8:11], s41 offen offset:0  lds
v_lshl_add_u32 v12, v1, 5, v2
v_add_u32 v13, 146432, v12
s_add_u32 s26, s50, s51
v_mfma_f32_16x16x32_bf16 v[76:79], a[164:167], v[132:135], 0
s_waitcnt lgkmcnt(6)
ds_read_b64_tr_b16 a[188:189], v3 offset:4864
ds_read_b64_tr_b16 a[190:191], v3 offset:6912
v_add_u32 v14, 292864, v12
v_bfe_u32 v1, v0, 1, 2
s_mul_i32 s63, s59, 576
v_mfma_f32_16x16x32_bf16 v[80:83], a[168:171], v[128:131], 0
buffer_load_dwordx4 v10, s[8:11], s41 offen offset:1024  lds
v_mul_u32_u24 v1, 1152, v1
v_and_b32 v2, 1, v0
v_lshl_add_u32 v1, v2, 4, v1
v_mfma_f32_16x16x32_bf16 v[84:87], a[168:171], v[132:135], 0
ds_read_b64_tr_b16 a[192:193], v3 offset:8192
ds_read_b64_tr_b16 a[194:195], v3 offset:10240
v_lshrrev_b32 v2, 3, v0
v_add_u32 v15, 0, v2
s_lshl_b32 s52, s24, 4
v_mfma_f32_16x16x32_bf16 v[88:91], a[172:175], v[128:131], 0
buffer_load_dwordx4 v11, s[8:11], s41 offen offset:2048  lds
v_mul_u32_u24 v36, 57, v15
v_lshrrev_b32 v36, 10, v36
s_add_u32 s50, s61, s52
v_mfma_f32_16x16x32_bf16 v[92:95], a[172:175], v[132:135], 0
s_waitcnt lgkmcnt(6)
ds_read_b64_tr_b16 a[196:197], v3 offset:8448
ds_read_b64_tr_b16 a[198:199], v3 offset:10496
s_waitcnt vmcnt(13)
v_mul_u32_u24 v37, 18, v36
v_sub_u32 v15, v15, v37
s_mul_i32 s50, s50, 1152
v_mfma_f32_16x16x32_bf16 v[64:67], a[176:179], v[136:139], v[64:67]
s_add_u32 s41, s100, 0x36000
ds_read_b64_tr_b16 a[200:201], v3 offset:8704
s_add_u32 s42, s48, 7168
buffer_load_dwordx4 v[184:187], v30, s[20:23], s42 offen sc1
s_add_u32 s42, s48, 25600
buffer_load_dwordx4 v[188:191], v30, s[20:23], s42 offen sc1
v_and_b32 v37, 1, v36
v_xor_b32 v15, v15, v37
v_mul_u32_u24 v36, 4608, v36
v_mfma_f32_16x16x32_bf16 v[68:71], a[176:179], v[140:143], v[68:71]
s_add_u32 m0, s36, 3072
ds_read_b64_tr_b16 a[202:203], v3 offset:10752
v_lshl_add_u32 v15, v15, 5, v36
v_add_u32 v15, v15, v1
s_add_u32 s27, s50, s63
v_mfma_f32_16x16x32_bf16 v[72:75], a[180:183], v[136:139], v[72:75]
buffer_load_dwordx4 v9, s[8:11], s41 offen offset:0  lds
v_add_u32 v16, 8, v2
v_mul_u32_u24 v36, 57, v16
s_xor_b32 s51, s59, 1
v_mfma_f32_16x16x32_bf16 v[76:79], a[180:183], v[140:143], v[76:79]
s_waitcnt lgkmcnt(6)
ds_read_b64_tr_b16 a[204:205], v3 offset:8960
ds_read_b64_tr_b16 a[206:207], v3 offset:11008
v_lshrrev_b32 v36, 10, v36
v_mul_u32_u24 v37, 18, v36
s_mul_i32 s50, s58, 576
v_mfma_f32_16x16x32_bf16 v[80:83], a[184:187], v[136:139], v[80:83]
buffer_load_dwordx4 v10, s[8:11], s41 offen offset:1024  lds
v_sub_u32 v16, v16, v37
v_and_b32 v37, 1, v36
v_xor_b32 v16, v16, v37
v_mfma_f32_16x16x32_bf16 v[84:87], a[184:187], v[140:143], v[84:87]
ds_read_b64_tr_b16 a[160:161], v3 offset:12288
ds_read_b64_tr_b16 a[162:163], v3 offset:14336
v_mul_u32_u24 v36, 4608, v36
v_lshl_add_u32 v16, v16, 5, v36
s_mul_i32 s54, s51, 320
v_mfma_f32_16x16x32_bf16 v[88:91], a[188:191], v[136:139], v[88:91]
buffer_load_dwordx4 v11, s[8:11], s41 offen offset:2048  lds
v_add_u32 v16, v16, v1
v_add_u32 v17, 16, v2
s_add_u32 s54, s54, s50
v_mfma_f32_16x16x32_bf16 v[92:95], a[188:191], v[140:143], v[92:95]
s_waitcnt lgkmcnt(6)
ds_read_b64_tr_b16 a[164:165], v3 offset:12544
ds_read_b64_tr_b16 a[166:167], v3 offset:14592
s_waitcnt vmcnt(16)
v_mul_u32_u24 v36, 57, v17
v_lshrrev_b32 v36, 10, v36
s_lshl_b32 s55, s51, 5
v_mfma_f32_16x16x32_bf16 v[64:67], a[192:195], v[144:147], v[64:67]
s_add_u32 s41, s100, 0x6c000
ds_read_b64_tr_b16 a[168:169], v3 offset:12800
s_add_u32 s42, s48, 8192
buffer_load_dwordx4 v[192:195], v30, s[20:23], s42 offen sc1
s_add_u32 s42, s48, 26624
buffer_load_dwordx4 v[196:199], v30, s[20:23], s42 offen sc1
v_mul_u32_u24 v37, 18, v36
v_sub_u32 v17, v17, v37
v_and_b32 v37, 1, v36
v_mfma_f32_16x16x32_bf16 v[68:71], a[192:195], v[148:151], v[68:71]
s_add_u32 m0, s36, 6144
ds_read_b64_tr_b16 a[170:171], v3 offset:14848
v_xor_b32 v17, v17, v37
v_mul_u32_u24 v36, 4608, v36
s_add_u32 s55, s55, s50
v_mfma_f32_16x16x32_bf16 v[72:75], a[196:199], v[144:147], v[72:75]
buffer_load_dwordx4 v9, s[8:11], s41 offen offset:0  lds
v_lshl_add_u32 v17, v17, 5, v36
v_add_u32 v17, v17, v1
s_add_u32 s55, s55, 256
v_mfma_f32_16x16x32_bf16 v[76:79], a[196:199], v[148:151], v[76:79]
s_waitcnt lgkmcnt(6)
ds_read_b64_tr_b16 a[172:173], v3 offset:13056
ds_read_b64_tr_b16 a[174:175], v3 offset:15104
v_add_u32 v18, 24, v2
v_mul_u32_u24 v36, 57, v18
s_and_b32 s56, s24, 1
v_mfma_f32_16x16x32_bf16 v[80:83], a[200:203], v[144:147], v[80:83]
buffer_load_dwordx4 v10, s[8:11], s41 offen offset:1024  lds
v_lshrrev_b32 v36, 10, v36
v_mul_u32_u24 v37, 18, v36
v_sub_u32 v18, v18, v37
v_mfma_f32_16x16x32_bf16 v[84:87], a[200:203], v[148:151], v[84:87]
ds_read_b64_tr_b16 a[176:177], v3 offset:16384
ds_read_b64_tr_b16 a[178:179], v3 offset:18432
v_and_b32 v37, 1, v36
v_xor_b32 v18, v18, v37
s_lshl_b32 s56, s56, 4
v_mfma_f32_16x16x32_bf16 v[88:91], a[204:207], v[144:147], v[88:91]
buffer_load_dwordx4 v11, s[8:11], s41 offen offset:2048  lds
v_mul_u32_u24 v36, 4608, v36
v_lshl_add_u32 v18, v18, 5, v36
s_lshr_b32 s57, s24, 1
v_mfma_f32_16x16x32_bf16 v[92:95], a[204:207], v[148:151], v[92:95]
s_waitcnt lgkmcnt(6)
ds_read_b64_tr_b16 a[180:181], v3 offset:16640
ds_read_b64_tr_b16 a[182:183], v3 offset:18688
s_waitcnt vmcnt(19)
v_add_u32 v18, v18, v1
v_add_u32 v19, 32, v2
s_lshl_b32 s28, s57, 5
v_mfma_f32_16x16x32_bf16 v[64:67], a[160:163], v[152:155], v[64:67]
s_add_u32 s96, s96, 1
ds_read_b64_tr_b16 a[184:185], v3 offset:16896
s_add_u32 s42, s101, 9216
buffer_load_dwordx4 v[200:203], v30, s[20:23], s42 offen sc1
s_add_u32 s42, s101, 27648
buffer_load_dwordx4 v[204:207], v30, s[20:23], s42 offen sc1
v_mul_u32_u24 v36, 57, v19
v_lshrrev_b32 v36, 10, v36
v_mul_u32_u24 v37, 18, v36
v_mfma_f32_16x16x32_bf16 v[68:71], a[160:163], v[156:159], v[68:71]
s_and_b32 s96, s96, 3
ds_read_b64_tr_b16 a[186:187], v3 offset:18944
v_sub_u32 v19, v19, v37
v_and_b32 v37, 1, v36
s_add_u32 s28, s28, s54
v_mfma_f32_16x16x32_bf16 v[72:75], a[164:167], v[152:155], v[72:75]
s_mul_i32 s36, s96, 36864
ds_read_b64_tr_b16 a[188:189], v3 offset:17152
v_xor_b32 v19, v19, v37
v_mul_u32_u24 v36, 4608, v36
s_add_u32 s28, s28, 0
v_mfma_f32_16x16x32_bf16 v[76:79], a[164:167], v[156:159], v[76:79]
s_waitcnt lgkmcnt(7)
ds_read_b64_tr_b16 a[190:191], v3 offset:19200
v_lshl_add_u32 v19, v19, 5, v36
v_add_u32 v19, v19, v1
s_add_u32 s28, s28, s56
v_mfma_f32_16x16x32_bf16 v[80:83], a[168:171], v[152:155], v[80:83]
s_add_u32 s36, s36, s38
ds_read_b64_tr_b16 a[192:193], v3 offset:20480
v_add_u32 v20, 40, v2
v_mul_u32_u24 v36, 57, v20
v_lshrrev_b32 v36, 10, v36
v_mfma_f32_16x16x32_bf16 v[84:87], a[168:171], v[156:159], v[84:87]
ds_read_b64_tr_b16 a[194:195], v3 offset:22528
v_mul_u32_u24 v37, 18, v36
v_sub_u32 v20, v20, v37
s_mul_i32 s28, s28, 1152
v_mfma_f32_16x16x32_bf16 v[88:91], a[172:175], v[152:155], v[88:91]
ds_read_b64_tr_b16 a[196:197], v3 offset:20736
s_add_u32 s42, s53, 4
buffer_load_dword v40, v56, s[4:7], s42 offen offset:0 sc1
buffer_load_dword v41, v56, s[4:7], s42 offen offset:128 sc1
s_add_u32 s42, s53, 65540
buffer_load_dword v42, v56, s[4:7], s42 offen offset:0 sc1
buffer_load_dword v43, v56, s[4:7], s42 offen offset:128 sc1
s_add_u32 s42, s53, 131076
buffer_load_dword v44, v56, s[4:7], s42 offen offset:0 sc1
buffer_load_dword v45, v56, s[4:7], s42 offen offset:128 sc1
v_mfma_f32_16x16x32_bf16 v[92:95], a[172:175], v[156:159], v[92:95]
s_waitcnt lgkmcnt(7)
ds_read_b64_tr_b16 a[198:199], v3 offset:22784
s_waitcnt vmcnt(25)
v_and_b32 v37, 1, v36
v_xor_b32 v20, v20, v37
s_add_u32 s28, s28, s63
v_mul_u32_u24 v36, 4608, v36
v_lshl_add_u32 v20, v20, 5, v36
s_lshl_b32 s29, s57, 5
v_mfma_f32_16x16x32_bf16 v[64:67], a[176:179], v[160:163], v[64:67]
ds_read_b64_tr_b16 a[200:201], v3 offset:20992
s_add_u32 s42, s101, 10240
buffer_load_dwordx4 v[208:211], v30, s[20:23], s42 offen sc1
s_add_u32 s42, s101, 28672
buffer_load_dwordx4 v[212:215], v30, s[20:23], s42 offen sc1
v_add_u32 v20, v20, v1
v_add_u32 v21, 48, v2
v_mul_u32_u24 v36, 57, v21
v_mfma_f32_16x16x32_bf16 v[68:71], a[176:179], v[164:167], v[68:71]
ds_read_b64_tr_b16 a[202:203], v3 offset:23040
v_lshrrev_b32 v36, 10, v36
v_mul_u32_u24 v37, 18, v36
s_add_u32 s29, s29, s54
v_mfma_f32_16x16x32_bf16 v[72:75], a[180:183], v[160:163], v[72:75]
ds_read_b64_tr_b16 a[204:205], v3 offset:21248
v_sub_u32 v21, v21, v37
v_and_b32 v37, 1, v36
s_add_u32 s29, s29, 64
v_mfma_f32_16x16x32_bf16 v[76:79], a[180:183], v[164:167], v[76:79]
s_waitcnt lgkmcnt(7)
ds_read_b64_tr_b16 a[206:207], v3 offset:23296
v_xor_b32 v21, v21, v37
v_mul_u32_u24 v36, 4608, v36
s_add_u32 s29, s29, s56
v_mfma_f32_16x16x32_bf16 v[80:83], a[184:187], v[160:163], v[80:83]
ds_read_b64_tr_b16 a[160:161], v3 offset:24576
v_lshl_add_u32 v21, v21, 5, v36
v_add_u32 v21, v21, v1
v_add_u32 v22, 56, v2
v_mfma_f32_16x16x32_bf16 v[84:87], a[184:187], v[164:167], v[84:87]
ds_read_b64_tr_b16 a[162:163], v3 offset:26624
v_mul_u32_u24 v36, 57, v22
v_lshrrev_b32 v36, 10, v36
s_mul_i32 s29, s29, 1152
v_mfma_f32_16x16x32_bf16 v[88:91], a[188:191], v[160:163], v[88:91]
ds_read_b64_tr_b16 a[164:165], v3 offset:24832
v_mul_u32_u24 v37, 18, v36
v_sub_u32 v22, v22, v37
s_add_u32 s29, s29, s63
v_mfma_f32_16x16x32_bf16 v[92:95], a[188:191], v[164:167], v[92:95]
s_waitcnt lgkmcnt(7)
ds_read_b64_tr_b16 a[166:167], v3 offset:26880
s_waitcnt vmcnt(25)
v_and_b32 v37, 1, v36
v_xor_b32 v22, v22, v37
s_lshl_b32 s30, s57, 5
v_mfma_f32_16x16x32_bf16 v[64:67], a[192:195], v[168:171], v[64:67]
ds_read_b64_tr_b16 a[168:169], v3 offset:25088
s_add_u32 s42, s101, 11264
buffer_load_dwordx4 v[216:219], v30, s[20:23], s42 offen sc1
s_add_u32 s42, s101, 29696
buffer_load_dwordx4 v[220:223], v30, s[20:23], s42 offen sc1
v_mul_u32_u24 v36, 4608, v36
v_lshl_add_u32 v22, v22, 5, v36
v_add_u32 v22, v22, v1
v_mfma_f32_16x16x32_bf16 v[68:71], a[192:195], v[172:175], v[68:71]
ds_read_b64_tr_b16 a[170:171], v3 offset:27136
v_add_u32 v23, 64, v2
v_mul_u32_u24 v36, 57, v23
s_add_u32 s30, s30, s54
v_mfma_f32_16x16x32_bf16 v[72:75], a[196:199], v[168:171], v[72:75]
ds_read_b64_tr_b16 a[172:173], v3 offset:25344
v_lshrrev_b32 v36, 10, v36
v_mul_u32_u24 v37, 18, v36
s_add_u32 s30, s30, 128
v_mfma_f32_16x16x32_bf16 v[76:79], a[196:199], v[172:175], v[76:79]
s_waitcnt lgkmcnt(7)
ds_read_b64_tr_b16 a[174:175], v3 offset:27392
v_sub_u32 v23, v23, v37
v_and_b32 v37, 1, v36
s_add_u32 s30, s30, s56
v_mfma_f32_16x16x32_bf16 v[80:83], a[200:203], v[168:171], v[80:83]
ds_read_b64_tr_b16 a[176:177], v3 offset:28672
v_xor_b32 v23, v23, v37
v_mul_u32_u24 v36, 4608, v36
v_lshl_add_u32 v23, v23, 5, v36
v_mfma_f32_16x16x32_bf16 v[84:87], a[200:203], v[172:175], v[84:87]
ds_read_b64_tr_b16 a[178:179], v3 offset:30720
v_add_u32 v23, v23, v1
v_accvgpr_write_b32 a0, 0
s_mul_i32 s30, s30, 1152
v_mfma_f32_16x16x32_bf16 v[88:91], a[204:207], v[168:171], v[88:91]
ds_read_b64_tr_b16 a[180:181], v3 offset:28928
v_accvgpr_write_b32 a1, 0
v_accvgpr_write_b32 a2, 0
s_add_u32 s30, s30, s63
v_mfma_f32_16x16x32_bf16 v[92:95], a[204:207], v[172:175], v[92:95]
s_waitcnt lgkmcnt(7)
ds_read_b64_tr_b16 a[182:183], v3 offset:30976
s_waitcnt vmcnt(25)
v_accvgpr_write_b32 a3, 0
v_accvgpr_write_b32 a4, 0
s_lshl_b32 s31, s57, 5
v_mfma_f32_16x16x32_bf16 v[64:67], a[160:163], v[176:179], v[64:67]
ds_read_b64_tr_b16 a[184:185], v3 offset:29184
s_add_u32 s42, s101, 12288
buffer_load_dwordx4 v[224:227], v30, s[20:23], s42 offen sc1
s_add_u32 s42, s101, 30720
buffer_load_dwordx4 v[228:231], v30, s[20:23], s42 offen sc1
v_accvgpr_write_b32 a5, 0
v_accvgpr_write_b32 a6, 0
v_accvgpr_write_b32 a7, 0
v_mfma_f32_16x16x32_bf16 v[68:71], a[160:163], v[180:183], v[68:71]
ds_read_b64_tr_b16 a[186:187], v3 offset:31232
v_accvgpr_write_b32 a8, 0
v_accvgpr_write_b32 a9, 0
s_add_u32 s31, s31, s54
v_mfma_f32_16x16x32_bf16 v[72:75], a[164:167], v[176:179], v[72:75]
ds_read_b64_tr_b16 a[188:189], v3 offset:29440
v_accvgpr_write_b32 a10, 0
v_accvgpr_write_b32 a11, 0
s_add_u32 s31, s31, 160
v_mfma_f32_16x16x32_bf16 v[76:79], a[164:167], v[180:183], v[76:79]
s_waitcnt lgkmcnt(7)
ds_read_b64_tr_b16 a[190:191], v3 offset:31488
v_accvgpr_write_b32 a12, 0
v_accvgpr_write_b32 a13, 0
s_cmp_eq_u32 s57, 0
s_cselect_b32 s31, s62, s31
v_mfma_f32_16x16x32_bf16 v[80:83], a[168:171], v[176:179], v[80:83]
ds_read_b64_tr_b16 a[192:193], v3 offset:32768
v_accvgpr_write_b32 a14, 0
v_accvgpr_write_b32 a15, 0
v_accvgpr_write_b32 a16, 0
v_mfma_f32_16x16x32_bf16 v[84:87], a[168:171], v[180:183], v[84:87]
ds_read_b64_tr_b16 a[194:195], v3 offset:34816
v_accvgpr_write_b32 a17, 0
v_accvgpr_write_b32 a18, 0
s_add_u32 s31, s31, s56
v_mfma_f32_16x16x32_bf16 v[88:91], a[172:175], v[176:179], v[88:91]
ds_read_b64_tr_b16 a[196:197], v3 offset:33024
v_accvgpr_write_b32 a19, 0
v_accvgpr_write_b32 a20, 0
s_mul_i32 s31, s31, 1152
v_mfma_f32_16x16x32_bf16 v[92:95], a[172:175], v[180:183], v[92:95]
s_waitcnt lgkmcnt(7)
ds_read_b64_tr_b16 a[198:199], v3 offset:35072
s_waitcnt vmcnt(22)
v_accvgpr_write_b32 a21, 0
v_accvgpr_write_b32 a22, 0
s_add_u32 s31, s31, s63
v_mfma_f32_16x16x32_bf16 v[64:67], a[176:179], v[184:187], v[64:67]
ds_read_b64_tr_b16 a[200:201], v3 offset:33280
s_add_u32 s42, s101, 13312
buffer_load_dwordx4 v[232:235], v30, s[20:23], s42 offen sc1
s_add_u32 s42, s101, 31744
buffer_load_dwordx4 v[236:239], v30, s[20:23], s42 offen sc1
v_accvgpr_write_b32 a23, 0
v_accvgpr_write_b32 a24, 0
s_lshl_b32 s32, s57, 5
v_mfma_f32_16x16x32_bf16 v[68:71], a[176:179], v[188:191], v[68:71]
s_mov_b32 s41, s25
ds_read_b64_tr_b16 a[202:203], v3 offset:35328
v_accvgpr_write_b32 a25, 0
v_accvgpr_write_b32 a26, 0
v_accvgpr_write_b32 a27, 0
v_mfma_f32_16x16x32_bf16 v[72:75], a[180:183], v[184:187], v[72:75]
s_waitcnt vmcnt(16)
ds_read_b64_tr_b16 a[204:205], v3 offset:33536
s_barrier
v_accvgpr_write_b32 a28, 0
v_accvgpr_write_b32 a29, 0
s_add_u32 s32, s32, s54
v_mfma_f32_16x16x32_bf16 v[76:79], a[180:183], v[188:191], v[76:79]
s_waitcnt lgkmcnt(7)
ds_read_b64_tr_b16 a[206:207], v3 offset:35584
v_accvgpr_write_b32 a30, 0
v_accvgpr_write_b32 a31, 0
s_add_u32 s32, s32, 224
v_mfma_f32_16x16x32_bf16 v[80:83], a[184:187], v[184:187], v[80:83]
s_mov_b32 m0, s36
ds_read_b64_tr_b16 a[160:161], v4 offset:0
v_accvgpr_write_b32 a32, 0
v_accvgpr_write_b32 a33, 0
s_cmp_eq_u32 s57, 1
s_cselect_b32 s32, s55, s32
v_mfma_f32_16x16x32_bf16 v[84:87], a[184:187], v[188:191], v[84:87]
ds_read_b64_tr_b16 a[162:163], v4 offset:2048
v_accvgpr_write_b32 a34, 0
v_accvgpr_write_b32 a35, 0
v_accvgpr_write_b32 a36, 0
v_mfma_f32_16x16x32_bf16 v[88:91], a[188:191], v[184:187], v[88:91]
buffer_load_dwordx4 v9, s[12:15], s41 offen offset:0  lds
v_accvgpr_write_b32 a37, 0
v_accvgpr_write_b32 a38, 0
s_add_u32 s32, s32, s56
v_mfma_f32_16x16x32_bf16 v[92:95], a[188:191], v[188:191], v[92:95]
s_waitcnt lgkmcnt(6)
ds_read_b64_tr_b16 a[164:165], v4 offset:256
ds_read_b64_tr_b16 a[166:167], v4 offset:2304
v_accvgpr_write_b32 a39, 0
v_accvgpr_write_b32 a40, 0
s_mul_i32 s32, s32, 1152
v_mfma_f32_16x16x32_bf16 v[64:67], a[192:195], v[192:195], v[64:67]
ds_read_b64_tr_b16 a[168:169], v4 offset:512
s_add_u32 s42, s101, 14336
buffer_load_dwordx4 v[240:243], v30, s[20:23], s42 offen sc1
s_add_u32 s42, s101, 32768
buffer_load_dwordx4 v[244:247], v30, s[20:23], s42 offen sc1
v_accvgpr_write_b32 a41, 0
v_accvgpr_write_b32 a42, 0
s_add_u32 s32, s32, s63
v_mfma_f32_16x16x32_bf16 v[68:71], a[192:195], v[196:199], v[68:71]
buffer_load_dwordx4 v10, s[12:15], s41 offen offset:1024  lds
v_accvgpr_write_b32 a43, 0
v_accvgpr_write_b32 a44, 0
v_accvgpr_write_b32 a45, 0
v_mfma_f32_16x16x32_bf16 v[72:75], a[196:199], v[192:195], v[72:75]
ds_read_b64_tr_b16 a[170:171], v4 offset:2560
ds_read_b64_tr_b16 a[172:173], v4 offset:768
v_accvgpr_write_b32 a46, 0
v_accvgpr_write_b32 a47, 0
s_add_u32 s31, s54, 192
v_mfma_f32_16x16x32_bf16 v[76:79], a[196:199], v[196:199], v[76:79]
s_waitcnt lgkmcnt(7)
ds_read_b64_tr_b16 a[174:175], v4 offset:2816
v_accvgpr_write_b32 a48, 0
v_accvgpr_write_b32 a49, 0
s_cmp_eq_u32 s24, 2
s_cselect_b32 s50, 32, 0
v_mfma_f32_16x16x32_bf16 v[80:83], a[200:203], v[192:195], v[80:83]
buffer_load_dwordx4 v11, s[12:15], s41 offen offset:2048  lds
v_accvgpr_write_b32 a50, 0
v_accvgpr_write_b32 a51, 0
s_add_u32 s31, s31, s50
v_mfma_f32_16x16x32_bf16 v[84:87], a[200:203], v[196:199], v[84:87]
s_add_u32 s41, s25, 0x36000
ds_read_b64_tr_b16 a[176:177], v4 offset:4096
ds_read_b64_tr_b16 a[178:179], v4 offset:6144
v_accvgpr_write_b32 a52, 0
v_accvgpr_write_b32 a53, 0
v_accvgpr_write_b32 a54, 0
v_mfma_f32_16x16x32_bf16 v[88:91], a[204:207], v[192:195], v[88:91]
s_add_u32 m0, s36, 3072
ds_read_b64_tr_b16 a[180:181], v4 offset:4352
v_accvgpr_write_b32 a55, 0
v_accvgpr_write_b32 a56, 0
s_cmp_eq_u32 s24, 0
s_cselect_b32 s31, s62, s31
v_mfma_f32_16x16x32_bf16 v[92:95], a[204:207], v[196:199], v[92:95]
s_waitcnt lgkmcnt(7)
buffer_load_dwordx4 v9, s[12:15], s41 offen offset:0  lds
s_waitcnt vmcnt(20)
v_accvgpr_write_b32 a57, 0
v_accvgpr_write_b32 a58, 0
s_cmp_eq_u32 s24, 3
s_cselect_b32 s31, s55, s31
v_mfma_f32_16x16x32_bf16 v[64:67], a[160:163], v[200:203], v[64:67]
ds_read_b64_tr_b16 a[182:183], v4 offset:6400
ds_read_b64_tr_b16 a[184:185], v4 offset:4608
s_add_u32 s42, s101, 15360
buffer_load_dwordx4 v[248:251], v30, s[20:23], s42 offen sc1
s_add_u32 s42, s101, 33792
buffer_load_dwordx4 v[252:255], v30, s[20:23], s42 offen sc1
v_accvgpr_write_b32 a59, 0
v_accvgpr_write_b32 a60, 0
s_mul_i32 s31, s31, 1152
v_mfma_f32_16x16x32_bf16 v[68:71], a[160:163], v[204:207], v[68:71]
ds_read_b64_tr_b16 a[186:187], v4 offset:6656
v_accvgpr_write_b32 a61, 0
v_accvgpr_write_b32 a62, 0
v_accvgpr_write_b32 a63, 0
v_mfma_f32_16x16x32_bf16 v[72:75], a[164:167], v[200:203], v[72:75]
buffer_load_dwordx4 v10, s[12:15], s41 offen offset:1024  lds
v_accvgpr_write_b32 a64, 0
v_accvgpr_write_b32 a65, 0
s_add_u32 s31, s31, s63
v_mfma_f32_16x16x32_bf16 v[76:79], a[164:167], v[204:207], v[76:79]
s_waitcnt lgkmcnt(6)
ds_read_b64_tr_b16 a[188:189], v4 offset:4864
ds_read_b64_tr_b16 a[190:191], v4 offset:6912
v_accvgpr_write_b32 a66, 0
v_accvgpr_write_b32 a67, 0
s_add_u32 s32, s31, 288
v_mfma_f32_16x16x32_bf16 v[80:83], a[168:171], v[200:203], v[80:83]
ds_read_b64_tr_b16 a[192:193], v4 offset:8192
v_accvgpr_write_b32 a68, 0
v_accvgpr_write_b32 a69, 0
s_lshl_b32 s50, s2, 2
v_mfma_f32_16x16x32_bf16 v[84:87], a[168:171], v[204:207], v[84:87]
buffer_load_dwordx4 v11, s[12:15], s41 offen offset:2048  lds
v_accvgpr_write_b32 a70, 0
v_accvgpr_write_b32 a71, 0
v_accvgpr_write_b32 a72, 0
v_mfma_f32_16x16x32_bf16 v[88:91], a[172:175], v[200:203], v[88:91]
s_add_u32 s41, s25, 0x6c000
ds_read_b64_tr_b16 a[194:195], v4 offset:10240
ds_read_b64_tr_b16 a[196:197], v4 offset:8448
v_accvgpr_write_b32 a73, 0
v_accvgpr_write_b32 a74, 0
s_add_u32 s50, s50, s24
v_mfma_f32_16x16x32_bf16 v[92:95], a[172:175], v[204:207], v[92:95]
s_waitcnt lgkmcnt(7)
ds_read_b64_tr_b16 a[198:199], v4 offset:10496
s_waitcnt vmcnt(16)
v_accvgpr_write_b32 a75, 0
v_accvgpr_write_b32 a76, 0
s_lshl_b32 s43, s50, 2
v_mfma_f32_16x16x32_bf16 v[64:67], a[176:179], v[208:211], v[64:67]
s_add_u32 m0, s36, 6144
ds_read_b64_tr_b16 a[200:201], v4 offset:8704
s_add_u32 s42, s101, 16384
buffer_load_dwordx4 a[144:147], v30, s[20:23], s42 offen sc1
s_add_u32 s42, s101, 34816
buffer_load_dwordx4 a[148:151], v30, s[20:23], s42 offen sc1
v_accvgpr_write_b32 a77, 0
v_accvgpr_write_b32 a78, 0
s_add_u32 s43, s43, 0x4b0000
v_mfma_f32_16x16x32_bf16 v[68:71], a[176:179], v[212:215], v[68:71]
buffer_load_dwordx4 v9, s[12:15], s41 offen offset:0  lds
v_accvgpr_write_b32 a79, 0
v_accvgpr_write_b32 a80, 0
v_accvgpr_write_b32 a81, 0
v_mfma_f32_16x16x32_bf16 v[72:75], a[180:183], v[208:211], v[72:75]
ds_read_b64_tr_b16 a[202:203], v4 offset:10752
ds_read_b64_tr_b16 a[204:205], v4 offset:8960
v_accvgpr_write_b32 a82, 0
v_accvgpr_write_b32 a83, 0
s_mul_i32 s33, s50, 18432
v_mfma_f32_16x16x32_bf16 v[76:79], a[180:183], v[212:215], v[76:79]
s_waitcnt lgkmcnt(7)
buffer_load_dwordx4 v10, s[12:15], s41 offen offset:1024  lds
v_accvgpr_write_b32 a84, 0
v_accvgpr_write_b32 a85, 0
s_add_u32 s33, s33, 0x500000
v_mfma_f32_16x16x32_bf16 v[80:83], a[184:187], v[208:211], v[80:83]
ds_read_b64_tr_b16 a[206:207], v4 offset:11008
ds_read_b64_tr_b16 a[160:161], v4 offset:12288
v_accvgpr_write_b32 a86, 0
v_accvgpr_write_b32 a87, 0
s_xor_b32 s50, s2, 8
v_mfma_f32_16x16x32_bf16 v[84:87], a[184:187], v[212:215], v[84:87]
ds_read_b64_tr_b16 a[162:163], v4 offset:14336
v_accvgpr_write_b32 a88, 0
v_accvgpr_write_b32 a89, 0
v_accvgpr_write_b32 a90, 0
v_mfma_f32_16x16x32_bf16 v[88:91], a[188:191], v[208:211], v[88:91]
buffer_load_dwordx4 v11, s[12:15], s41 offen offset:2048  lds
v_accvgpr_write_b32 a91, 0
v_accvgpr_write_b32 a92, 0
s_lshl_b32 s50, s50, 2
v_mfma_f32_16x16x32_bf16 v[92:95], a[188:191], v[212:215], v[92:95]
s_waitcnt lgkmcnt(6)
ds_read_b64_tr_b16 a[164:165], v4 offset:12544
ds_read_b64_tr_b16 a[166:167], v4 offset:14592
s_waitcnt vmcnt(19)
v_accvgpr_write_b32 a93, 0
v_accvgpr_write_b32 a94, 0
s_add_u32 s50, s50, s24
v_mfma_f32_16x16x32_bf16 v[64:67], a[192:195], v[216:219], v[64:67]
s_add_u32 s96, s96, 1
ds_read_b64_tr_b16 a[168:169], v4 offset:12800
s_add_u32 s42, s101, 17408
buffer_load_dwordx4 a[152:155], v30, s[20:23], s42 offen sc1
s_add_u32 s42, s101, 35840
buffer_load_dwordx4 a[156:159], v30, s[20:23], s42 offen sc1
v_accvgpr_write_b32 a95, 0
v_accvgpr_write_b32 a96, 0
s_lshl_b32 s44, s50, 2
v_mfma_f32_16x16x32_bf16 v[68:71], a[192:195], v[220:223], v[68:71]
s_and_b32 s96, s96, 3
ds_read_b64_tr_b16 a[170:171], v4 offset:14848
v_accvgpr_write_b32 a97, 0
v_accvgpr_write_b32 a98, 0
v_accvgpr_write_b32 a99, 0
v_mfma_f32_16x16x32_bf16 v[72:75], a[196:199], v[216:219], v[72:75]
s_mul_i32 s36, s96, 36864
ds_read_b64_tr_b16 a[172:173], v4 offset:13056
v_accvgpr_write_b32 a100, 0
v_accvgpr_write_b32 a101, 0
s_add_u32 s44, s44, 0x4b0000
v_mfma_f32_16x16x32_bf16 v[76:79], a[196:199], v[220:223], v[76:79]
s_waitcnt lgkmcnt(7)
ds_read_b64_tr_b16 a[174:175], v4 offset:15104
v_accvgpr_write_b32 a102, 0
v_accvgpr_write_b32 a103, 0
s_mul_i32 s34, s50, 18432
v_mfma_f32_16x16x32_bf16 v[80:83], a[200:203], v[216:219], v[80:83]
s_add_u32 s36, s36, s38
ds_read_b64_tr_b16 a[176:177], v4 offset:16384
v_accvgpr_write_b32 a104, 0
v_accvgpr_write_b32 a105, 0
s_add_u32 s34, s34, 0x500000
v_mfma_f32_16x16x32_bf16 v[84:87], a[200:203], v[220:223], v[84:87]
ds_read_b64_tr_b16 a[178:179], v4 offset:18432
v_accvgpr_write_b32 a106, 0
v_accvgpr_write_b32 a107, 0
v_accvgpr_write_b32 a108, 0
v_mfma_f32_16x16x32_bf16 v[88:91], a[204:207], v[216:219], v[88:91]
ds_read_b64_tr_b16 a[180:181], v4 offset:16640
v_accvgpr_write_b32 a109, 0
v_accvgpr_write_b32 a110, 0
s_lshl_b32 s50, s60, 1
v_mfma_f32_16x16x32_bf16 v[92:95], a[204:207], v[220:223], v[92:95]
s_waitcnt lgkmcnt(7)
ds_read_b64_tr_b16 a[182:183], v4 offset:18688
s_waitcnt vmcnt(19)
v_accvgpr_write_b32 a111, 0
v_accvgpr_write_b32 a112, 0
s_add_u32 s50, s50, s59
v_mfma_f32_16x16x32_bf16 v[64:67], a[160:163], v[224:227], v[64:67]
s_mov_b32 s41, s100
ds_read_b64_tr_b16 a[184:185], v4 offset:16896
v_accvgpr_write_b32 a113, 0
v_accvgpr_write_b32 a114, 0
s_lshl_b32 s50, s50, 3
v_mfma_f32_16x16x32_bf16 v[68:71], a[160:163], v[228:231], v[68:71]
s_mov_b32 m0, s36
ds_read_b64_tr_b16 a[186:187], v4 offset:18944
v_accvgpr_write_b32 a115, 0
v_accvgpr_write_b32 a116, 0
v_accvgpr_write_b32 a117, 0
v_mfma_f32_16x16x32_bf16 v[72:75], a[164:167], v[224:227], v[72:75]
ds_read_b64_tr_b16 a[188:189], v4 offset:17152
v_accvgpr_write_b32 a118, 0
v_accvgpr_write_b32 a119, 0
s_add_u32 s50, s50, s58
v_mfma_f32_16x16x32_bf16 v[76:79], a[164:167], v[228:231], v[76:79]
s_waitcnt lgkmcnt(7)
ds_read_b64_tr_b16 a[190:191], v4 offset:19200
v_accvgpr_write_b32 a120, 0
v_accvgpr_write_b32 a121, 0
s_lshl_b32 s50, s50, 2
v_mfma_f32_16x16x32_bf16 v[80:83], a[168:171], v[224:227], v[80:83]
buffer_load_dwordx4 v9, s[12:15], s41 offen offset:0  lds
v_add_f32 v40, v40, v42
v_add_f32 v41, v41, v43
v_add_f32 v40, v40, v44
v_add_f32 v41, v41, v45
v_mov_b32 v42, v40
v_mov_b32 v43, v41
s_nop 1
v_permlane32_swap_b32 v40, v42
v_permlane32_swap_b32 v41, v43
s_nop 1
v_add_f32 v40, v40, v42
v_add_f32 v41, v41, v43
v_mov_b32 v42, v40
v_mov_b32 v43, v41
s_nop 1
v_permlane16_swap_b32 v40, v42
v_permlane16_swap_b32 v41, v43
s_nop 1
v_add_f32 v40, v40, v42
v_add_f32 v41, v41, v43
s_mov_b32 s99, 0x3ae38e39
v_mul_f32 v28, s99, v40
v_mul_f32 v29, s99, v41
v_add_f32 v28, 0x3727c5ac, v28
v_add_f32 v29, 0x3727c5ac, v29
v_rsq_f32 v48, v28
v_rsq_f32 v49, v29
s_nop 0
v_mul_f32 v24, 0xc0135761, v48
v_mul_f32 v50, v48, v48
v_mul_f32 v25, 0xc0135761, v49
v_mul_f32 v51, v49, v49
v_mul_f32 v50, 0x3d372713, v50
v_mul_f32 v51, 0x3d372713, v51
v_mul_f32 v26, v24, v50
v_mul_f32 v27, v25, v51
v_mfma_f32_16x16x32_bf16 v[84:87], a[168:171], v[228:231], v[84:87]
ds_read_b64_tr_b16 a[192:193], v4 offset:20480
ds_read_b64_tr_b16 a[194:195], v4 offset:22528
v_accvgpr_write_b32 a122, 0
v_accvgpr_write_b32 a123, 0
s_add_u32 s50, s50, s24
v_accvgpr_write_b32 a124, 0
v_accvgpr_write_b32 a125, 0
v_accvgpr_write_b32 a126, 0
v_mfma_f32_16x16x32_bf16 v[88:91], a[172:175], v[224:227], v[88:91]
ds_read_b64_tr_b16 a[196:197], v4 offset:20736
v_accvgpr_write_b32 a127, 0
v_accvgpr_write_b32 a128, 0
s_mul_i32 s35, s50, 18432
v_mfma_f32_16x16x32_bf16 v[92:95], a[172:175], v[228:231], v[92:95]
s_waitcnt lgkmcnt(7)
buffer_load_dwordx4 v10, s[12:15], s41 offen offset:1024  lds
s_waitcnt vmcnt(19)
v_accvgpr_write_b32 a129, 0
v_accvgpr_write_b32 a130, 0
s_add_u32 s35, s35, 0x1700000
v_mfma_f32_16x16x32_bf16 v[64:67], a[176:179], v[232:235], v[64:67]
ds_read_b64_tr_b16 a[198:199], v4 offset:22784
ds_read_b64_tr_b16 a[200:201], v4 offset:20992
v_accvgpr_write_b32 a131, 0
v_accvgpr_write_b32 a132, 0
s_mov_b32 s46, 0x3f80
v_mfma_f32_16x16x32_bf16 v[68:71], a[176:179], v[236:239], v[68:71]
ds_read_b64_tr_b16 a[202:203], v4 offset:23040
v_accvgpr_write_b32 a133, 0
v_accvgpr_write_b32 a134, 0
v_accvgpr_write_b32 a135, 0
v_mfma_f32_16x16x32_bf16 v[72:75], a[180:183], v[232:235], v[72:75]
buffer_load_dwordx4 v11, s[12:15], s41 offen offset:2048  lds
v_accvgpr_write_b32 a136, 0
v_accvgpr_write_b32 a137, 0
s_mov_b32 s47, 0x3f800000
v_mfma_f32_16x16x32_bf16 v[76:79], a[180:183], v[236:239], v[76:79]
s_waitcnt lgkmcnt(6)
ds_read_b64_tr_b16 a[204:205], v4 offset:21248
ds_read_b64_tr_b16 a[206:207], v4 offset:23296
v_accvgpr_write_b32 a138, 0
v_accvgpr_write_b32 a139, 0
s_mov_b32 s40, 3
v_mfma_f32_16x16x32_bf16 v[80:83], a[184:187], v[232:235], v[80:83]
s_add_u32 s41, s100, 0x36000
ds_read_b64_tr_b16 a[160:161], v4 offset:24576
v_accvgpr_write_b32 a140, 0
v_accvgpr_write_b32 a141, 0
s_mov_b32 s45, 1
v_mfma_f32_16x16x32_bf16 v[84:87], a[184:187], v[236:239], v[84:87]
s_add_u32 m0, s36, 3072
ds_read_b64_tr_b16 a[162:163], v4 offset:26624
v_accvgpr_write_b32 a142, 0
v_accvgpr_write_b32 a143, 0
v_mfma_f32_16x16x32_bf16 v[88:91], a[188:191], v[232:235], v[88:91]
buffer_load_dwordx4 v9, s[12:15], s41 offen offset:0  lds
v_mfma_f32_16x16x32_bf16 v[92:95], a[188:191], v[236:239], v[92:95]
s_waitcnt lgkmcnt(6)
ds_read_b64_tr_b16 a[164:165], v4 offset:24832
ds_read_b64_tr_b16 a[166:167], v4 offset:26880
s_waitcnt vmcnt(18)
v_mfma_f32_16x16x32_bf16 v[64:67], a[192:195], v[240:243], v[64:67]
buffer_load_dwordx4 v10, s[12:15], s41 offen offset:1024  lds
v_mfma_f32_16x16x32_bf16 v[68:71], a[192:195], v[244:247], v[68:71]
ds_read_b64_tr_b16 a[168:169], v4 offset:28672
ds_read_b64_tr_b16 a[170:171], v4 offset:30720
v_mfma_f32_16x16x32_bf16 v[72:75], a[196:199], v[240:243], v[72:75]
ds_read_b64_tr_b16 a[172:173], v4 offset:28928
v_mfma_f32_16x16x32_bf16 v[76:79], a[196:199], v[244:247], v[76:79]
s_waitcnt lgkmcnt(7)
buffer_load_dwordx4 v11, s[12:15], s41 offen offset:2048  lds
s_add_u32 s41, s100, 0x6c000
v_mfma_f32_16x16x32_bf16 v[80:83], a[200:203], v[240:243], v[80:83]
s_add_u32 m0, s36, 6144
ds_read_b64_tr_b16 a[174:175], v4 offset:30976
ds_read_b64_tr_b16 a[176:177], v4 offset:32768
v_mfma_f32_16x16x32_bf16 v[84:87], a[200:203], v[244:247], v[84:87]
ds_read_b64_tr_b16 a[178:179], v4 offset:34816
v_mfma_f32_16x16x32_bf16 v[88:91], a[204:207], v[240:243], v[88:91]
s_add_u32 s97, s97, 1
buffer_load_dwordx4 v9, s[12:15], s41 offen offset:0  lds
v_mfma_f32_16x16x32_bf16 v[92:95], a[204:207], v[244:247], v[92:95]
s_waitcnt lgkmcnt(6)
ds_read_b64_tr_b16 a[180:181], v4 offset:33024
ds_read_b64_tr_b16 a[182:183], v4 offset:35072
s_waitcnt vmcnt(16)
v_mfma_f32_16x16x32_bf16 v[64:67], a[160:163], v[248:251], v[64:67]
s_and_b32 s97, s97, 3
ds_read_b64_tr_b16 a[184:185], v4 offset:25088
s_mul_i32 s39, s97, 36864
v_mfma_f32_16x16x32_bf16 v[68:71], a[160:163], v[252:255], v[68:71]
buffer_load_dwordx4 v10, s[12:15], s41 offen offset:1024  lds
v_mfma_f32_16x16x32_bf16 v[72:75], a[164:167], v[248:251], v[72:75]
ds_read_b64_tr_b16 a[186:187], v4 offset:27136
ds_read_b64_tr_b16 a[188:189], v4 offset:25344
v_mfma_f32_16x16x32_bf16 v[76:79], a[164:167], v[252:255], v[76:79]
s_waitcnt lgkmcnt(7)
ds_read_b64_tr_b16 a[190:191], v4 offset:27392
s_waitcnt vmcnt(13)
v_mfma_f32_16x16x32_bf16 v[64:67], a[168:171], a[144:147], v[64:67]
buffer_load_dwordx4 v11, s[12:15], s41 offen offset:2048  lds
v_mfma_f32_16x16x32_bf16 v[68:71], a[168:171], a[148:151], v[68:71]
s_add_u32 s96, s96, 1
ds_read_b64_tr_b16 a[192:193], v4 offset:29184
ds_read_b64_tr_b16 a[194:195], v4 offset:31232
v_mfma_f32_16x16x32_bf16 v[72:75], a[172:175], a[144:147], v[72:75]
s_and_b32 s96, s96, 3
ds_read_b64_tr_b16 a[196:197], v4 offset:29440
v_mfma_f32_16x16x32_bf16 v[76:79], a[172:175], a[148:151], v[76:79]
s_waitcnt lgkmcnt(7)
ds_read_b64_tr_b16 a[198:199], v4 offset:31488
s_waitcnt vmcnt(9)
s_mul_i32 s36, s96, 36864
s_add_u32 s36, s36, s38
v_mfma_f32_16x16x32_bf16 v[64:67], a[176:179], a[152:155], v[64:67]
ds_read_b64_tr_b16 a[200:201], v4 offset:33280
v_mfma_f32_16x16x32_bf16 v[68:71], a[176:179], a[156:159], v[68:71]
ds_read_b64_tr_b16 a[202:203], v4 offset:35328
v_mfma_f32_16x16x32_bf16 v[72:75], a[180:183], a[152:155], v[72:75]
ds_read_b64_tr_b16 a[204:205], v4 offset:33536
s_barrier
v_mfma_f32_16x16x32_bf16 v[76:79], a[180:183], a[156:159], v[76:79]
s_waitcnt lgkmcnt(7)
ds_read_b64_tr_b16 a[206:207], v4 offset:35584
v_add_u32 v3, s39, v5
v_mfma_f32_16x16x32_bf16 v[80:83], a[184:187], v[248:251], v[80:83]
ds_read_b64_tr_b16 a[160:161], v3 offset:0
v_mfma_f32_16x16x32_bf16 v[84:87], a[184:187], v[252:255], v[84:87]
ds_read_b64_tr_b16 a[162:163], v3 offset:2048
v_mfma_f32_16x16x32_bf16 v[88:91], a[188:191], v[248:251], v[88:91]
ds_read_b64_tr_b16 a[164:165], v3 offset:4096
v_mul_f32 v32, v64, v64
v_mul_f32 v33, v65, v65
v_mul_f32 v34, v66, v66
v_mul_f32 v35, v67, v67
v_fma_f32 v32, v32, v26, v24
v_fma_f32 v33, v33, v26, v24
v_fma_f32 v34, v34, v26, v24
v_fma_f32 v35, v35, v26, v24
v_mfma_f32_16x16x32_bf16 v[92:95], a[188:191], v[252:255], v[92:95]
s_waitcnt lgkmcnt(7)
ds_read_b64_tr_b16 a[166:167], v3 offset:6144
v_mul_f32 v32, v64, v32
v_mul_f32 v33, v65, v33
v_mul_f32 v34, v66, v34
v_mul_f32 v35, v67, v35
v_exp_f32 v32, v32
v_exp_f32 v33, v33
v_mfma_f32_16x16x32_bf16 v[80:83], a[192:195], a[144:147], v[80:83]
s_add_u32 s25, s25, 128
ds_read_b64_tr_b16 a[168:169], v3 offset:8192
v_mul_f32 v36, v72, v72
v_exp_f32 v34, v34
v_exp_f32 v35, v35
v_fma_f32 v32, v32, v28, v28
v_fma_f32 v33, v33, v28, v28
v_fma_f32 v34, v34, v28, v28
v_mfma_f32_16x16x32_bf16 v[84:87], a[192:195], a[148:151], v[84:87]
s_add_u32 s100, s100, 128
ds_read_b64_tr_b16 a[170:171], v3 offset:10240
v_fma_f32 v35, v35, v28, v28
v_mul_f32 v37, v73, v73
v_mul_f32 v38, v74, v74
v_mul_f32 v39, v75, v75
v_fma_f32 v36, v36, v26, v24
v_fma_f32 v37, v37, v26, v24
v_fma_f32 v38, v38, v26, v24
v_fma_f32 v39, v39, v26, v24
v_mfma_f32_16x16x32_bf16 v[88:91], a[196:199], a[144:147], v[88:91]
ds_read_b64_tr_b16 a[172:173], v3 offset:12288
v_mul_f32 v36, v72, v36
v_mul_f32 v37, v73, v37
v_mul_f32 v38, v74, v38
v_mul_f32 v39, v75, v39
v_rcp_f32 v32, v32
v_rcp_f32 v33, v33
v_mfma_f32_16x16x32_bf16 v[92:95], a[196:199], a[148:151], v[92:95]
s_waitcnt lgkmcnt(7)
ds_read_b64_tr_b16 a[174:175], v3 offset:14336
v_rcp_f32 v34, v34
v_rcp_f32 v35, v35
v_mul_f32 v64, v64, v32
v_mul_f32 v65, v65, v33
v_mul_f32 v66, v66, v34
v_mul_f32 v67, v67, v35
v_mfma_f32_16x16x32_bf16 v[80:83], a[200:203], a[152:155], v[80:83]
ds_read_b64_tr_b16 a[176:177], v3 offset:16384
v_mul_f32 v32, v68, v68
v_exp_f32 v36, v36
v_exp_f32 v37, v37
v_exp_f32 v38, v38
v_mul_f32 v33, v69, v69
v_mfma_f32_16x16x32_bf16 v[84:87], a[200:203], a[156:159], v[84:87]
ds_read_b64_tr_b16 a[178:179], v3 offset:18432
v_mul_f32 v34, v70, v70
v_exp_f32 v39, v39
v_fma_f32 v36, v36, v28, v28
v_fma_f32 v37, v37, v28, v28
v_fma_f32 v38, v38, v28, v28
v_fma_f32 v39, v39, v28, v28
v_mul_f32 v35, v71, v71
v_mfma_f32_16x16x32_bf16 v[88:91], a[204:207], a[152:155], v[88:91]
ds_read_b64_tr_b16 a[180:181], v3 offset:20480
v_fma_f32 v32, v32, v27, v25
v_fma_f32 v33, v33, v27, v25
v_fma_f32 v34, v34, v27, v25
v_fma_f32 v35, v35, v27, v25
v_mul_f32 v32, v68, v32
v_mul_f32 v33, v69, v33
v_mul_f32 v34, v70, v34
v_mul_f32 v35, v71, v35
v_mfma_f32_16x16x32_bf16 v[92:95], a[204:207], a[156:159], v[92:95]
ds_read_b64_tr_b16 a[182:183], v3 offset:22528
v_rcp_f32 v36, v36
v_rcp_f32 v37, v37
v_rcp_f32 v38, v38
v_rcp_f32 v39, v39
v_exp_f32 v32, v32
v_mul_f32 v72, v72, v36
v_exp_f32 v33, v33
v_mul_f32 v73, v73, v37
v_exp_f32 v34, v34
v_mul_f32 v74, v74, v38
v_exp_f32 v35, v35
v_mul_f32 v75, v75, v39
v_fma_f32 v32, v32, v29, v29
v_mul_f32 v36, v76, v76
v_fma_f32 v33, v33, v29, v29
v_mul_f32 v37, v77, v77
v_fma_f32 v34, v34, v29, v29
v_mul_f32 v38, v78, v78
v_fma_f32 v35, v35, v29, v29
v_mul_f32 v39, v79, v79
v_rcp_f32 v32, v32
v_fma_f32 v36, v36, v27, v25
v_rcp_f32 v33, v33
v_fma_f32 v37, v37, v27, v25
v_rcp_f32 v34, v34
v_fma_f32 v38, v38, v27, v25
v_rcp_f32 v35, v35
v_fma_f32 v39, v39, v27, v25
v_mul_f32 v68, v68, v32
v_mul_f32 v36, v76, v36
v_mul_f32 v69, v69, v33
v_mul_f32 v37, v77, v37
v_mul_f32 v70, v70, v34
v_mul_f32 v38, v78, v38
v_mul_f32 v71, v71, v35
v_mul_f32 v39, v79, v39
v_exp_f32 v36, v36
v_exp_f32 v37, v37
v_exp_f32 v38, v38
v_exp_f32 v39, v39
v_fma_f32 v36, v36, v29, v29
v_fma_f32 v37, v37, v29, v29
v_fma_f32 v38, v38, v29, v29
v_fma_f32 v39, v39, v29, v29
v_rcp_f32 v36, v36
v_rcp_f32 v37, v37
v_rcp_f32 v38, v38
v_rcp_f32 v39, v39
v_mul_f32 v76, v76, v36
v_mul_f32 v77, v77, v37
v_mul_f32 v78, v78, v38
v_mul_f32 v79, v79, v39
.p2align 6
L_sequential_preLN__sliding_local_dilated__glu_gated_geglu__prompt_kernel_loop:
s_waitcnt lgkmcnt(6)
v_mfma_f32_16x16x32_bf16 v[96:99], a[160:163], v[128:131], 0
s_mov_b32 s41, s25
ds_read_b64_tr_b16 a[184:185], v3 offset:24576
v_mul_f32 v32, v80, v80
v_mfma_f32_16x16x32_bf16 v[96:99], a[164:167], v[136:139], v[96:99]
s_mov_b32 m0, s36
ds_read_b64_tr_b16 a[186:187], v3 offset:26624
v_mul_f32 v33, v81, v81
v_mfma_f32_16x16x32_bf16 v[96:99], a[168:171], v[144:147], v[96:99]
buffer_load_dwordx4 v9, s[8:11], s41 offen offset:0  lds
v_mfma_f32_16x16x32_bf16 v[100:103], a[160:163], v[132:135], 0
ds_read_b64_tr_b16 a[188:189], v3 offset:28672
ds_read_b64_tr_b16 a[190:191], v3 offset:30720
v_mfma_f32_16x16x32_bf16 v[100:103], a[164:167], v[140:143], v[100:103]
ds_read_b64_tr_b16 a[192:193], v3 offset:32768
v_mul_f32 v34, v82, v82
v_mfma_f32_16x16x32_bf16 v[100:103], a[168:171], v[148:151], v[100:103]
s_waitcnt lgkmcnt(5)
ds_read_b64_tr_b16 a[194:195], v3 offset:34816
v_mul_f32 v35, v83, v83
v_mfma_f32_16x16x32_bf16 v[96:99], a[172:175], v[152:155], v[96:99]
ds_read_b64_tr_b16 a[196:197], v3 offset:256
v_fma_f32 v32, v32, v26, v24
v_mfma_f32_16x16x32_bf16 v[96:99], a[176:179], v[160:163], v[96:99]
ds_read_b64_tr_b16 a[198:199], v3 offset:2304
v_fma_f32 v33, v33, v26, v24
v_mfma_f32_16x16x32_bf16 v[96:99], a[180:183], v[168:171], v[96:99]
ds_read_b64_tr_b16 a[200:201], v3 offset:4352
v_fma_f32 v34, v34, v26, v24
v_mfma_f32_16x16x32_bf16 v[100:103], a[172:175], v[156:159], v[100:103]
buffer_load_dwordx4 v10, s[8:11], s41 offen offset:1024  lds
v_mfma_f32_16x16x32_bf16 v[100:103], a[176:179], v[164:167], v[100:103]
ds_read_b64_tr_b16 a[202:203], v3 offset:6400
ds_read_b64_tr_b16 a[204:205], v3 offset:8448
v_mfma_f32_16x16x32_bf16 v[100:103], a[180:183], v[172:175], v[100:103]
s_waitcnt lgkmcnt(5)
ds_read_b64_tr_b16 a[206:207], v3 offset:10496
v_fma_f32 v35, v35, v26, v24
v_mfma_f32_16x16x32_bf16 v[96:99], a[184:187], v[176:179], v[96:99]
ds_read_b64_tr_b16 a[160:161], v3 offset:12544
v_mul_f32 v32, v80, v32
v_mfma_f32_16x16x32_bf16 v[96:99], a[188:191], v[184:187], v[96:99]
ds_read_b64_tr_b16 a[162:163], v3 offset:14592
v_mul_f32 v33, v81, v33
v_mfma_f32_16x16x32_bf16 v[96:99], a[192:195], v[192:195], v[96:99]
ds_read_b64_tr_b16 a[164:165], v3 offset:16640
v_mul_f32 v34, v82, v34
v_mfma_f32_16x16x32_bf16 v[100:103], a[184:187], v[180:183], v[100:103]
ds_read_b64_tr_b16 a[166:167], v3 offset:18688
v_mul_f32 v35, v83, v35
v_mfma_f32_16x16x32_bf16 v[100:103], a[188:191], v[188:191], v[100:103]
buffer_load_dwordx4 v11, s[8:11], s41 offen offset:2048  lds
v_mfma_f32_16x16x32_bf16 v[100:103], a[192:195], v[196:199], v[100:103]
s_waitcnt lgkmcnt(4)
ds_read_b64_tr_b16 a[168:169], v3 offset:20736
ds_read_b64_tr_b16 a[170:171], v3 offset:22784
v_mfma_f32_16x16x32_bf16 v[104:107], a[196:199], v[128:131], 0
s_add_u32 s41, s25, 0x36000
ds_read_b64_tr_b16 a[172:173], v3 offset:24832
v_mul_f32 v36, v88, v88
v_mfma_f32_16x16x32_bf16 v[104:107], a[200:203], v[136:139], v[104:107]
ds_read_b64_tr_b16 a[174:175], v3 offset:26880
v_mul_f32 v37, v89, v89
v_mfma_f32_16x16x32_bf16 v[104:107], a[204:207], v[144:147], v[104:107]
s_add_u32 m0, s36, 3072
ds_read_b64_tr_b16 a[176:177], v3 offset:28928
v_mul_f32 v38, v90, v90
v_mfma_f32_16x16x32_bf16 v[108:111], a[196:199], v[132:135], 0
ds_read_b64_tr_b16 a[178:179], v3 offset:30976
v_mul_f32 v39, v91, v91
v_mfma_f32_16x16x32_bf16 v[108:111], a[200:203], v[140:143], v[108:111]
ds_read_b64_tr_b16 a[180:181], v3 offset:33024
v_fma_f32 v36, v36, v26, v24
v_mfma_f32_16x16x32_bf16 v[108:111], a[204:207], v[148:151], v[108:111]
s_waitcnt lgkmcnt(5)
buffer_load_dwordx4 v9, s[8:11], s41 offen offset:0  lds
v_mfma_f32_16x16x32_bf16 v[104:107], a[160:163], v[152:155], v[104:107]
ds_read_b64_tr_b16 a[182:183], v3 offset:35072
ds_read_b64_tr_b16 a[184:185], v3 offset:512
v_mfma_f32_16x16x32_bf16 v[104:107], a[164:167], v[160:163], v[104:107]
ds_read_b64_tr_b16 a[186:187], v3 offset:2560
v_fma_f32 v37, v37, v26, v24
v_mfma_f32_16x16x32_bf16 v[104:107], a[168:171], v[168:171], v[104:107]
ds_read_b64_tr_b16 a[188:189], v3 offset:4608
v_fma_f32 v38, v38, v26, v24
v_mfma_f32_16x16x32_bf16 v[108:111], a[160:163], v[156:159], v[108:111]
ds_read_b64_tr_b16 a[190:191], v3 offset:6656
v_fma_f32 v39, v39, v26, v24
v_mfma_f32_16x16x32_bf16 v[108:111], a[164:167], v[164:167], v[108:111]
ds_read_b64_tr_b16 a[192:193], v3 offset:8704
v_mul_f32 v36, v88, v36
v_mfma_f32_16x16x32_bf16 v[108:111], a[168:171], v[172:175], v[108:111]
s_waitcnt lgkmcnt(5)
ds_read_b64_tr_b16 a[194:195], v3 offset:10752
v_mul_f32 v37, v89, v37
v_mfma_f32_16x16x32_bf16 v[104:107], a[172:175], v[176:179], v[104:107]
buffer_load_dwordx4 v10, s[8:11], s41 offen offset:1024  lds
v_mfma_f32_16x16x32_bf16 v[104:107], a[176:179], v[184:187], v[104:107]
ds_read_b64_tr_b16 a[196:197], v3 offset:12800
ds_read_b64_tr_b16 a[198:199], v3 offset:14848
v_mfma_f32_16x16x32_bf16 v[104:107], a[180:183], v[192:195], v[104:107]
ds_read_b64_tr_b16 a[200:201], v3 offset:16896
v_mul_f32 v38, v90, v38
v_mfma_f32_16x16x32_bf16 v[108:111], a[172:175], v[180:183], v[108:111]
ds_read_b64_tr_b16 a[202:203], v3 offset:18944
v_mul_f32 v39, v91, v39
v_mfma_f32_16x16x32_bf16 v[108:111], a[176:179], v[188:191], v[108:111]
ds_read_b64_tr_b16 a[204:205], v3 offset:20992
v_exp_f32 v32, v32
v_mfma_f32_16x16x32_bf16 v[108:111], a[180:183], v[196:199], v[108:111]
s_waitcnt lgkmcnt(5)
ds_read_b64_tr_b16 a[206:207], v3 offset:23040
v_exp_f32 v33, v33
v_mfma_f32_16x16x32_bf16 v[112:115], a[184:187], v[128:131], 0
ds_read_b64_tr_b16 a[160:161], v3 offset:25088
v_exp_f32 v34, v34
v_mfma_f32_16x16x32_bf16 v[112:115], a[188:191], v[136:139], v[112:115]
buffer_load_dwordx4 v11, s[8:11], s41 offen offset:2048  lds
v_mfma_f32_16x16x32_bf16 v[112:115], a[192:195], v[144:147], v[112:115]
ds_read_b64_tr_b16 a[162:163], v3 offset:27136
ds_read_b64_tr_b16 a[164:165], v3 offset:29184
v_mfma_f32_16x16x32_bf16 v[116:119], a[184:187], v[132:135], 0
s_add_u32 s41, s25, 0x6c000
ds_read_b64_tr_b16 a[166:167], v3 offset:31232
v_exp_f32 v35, v35
v_mfma_f32_16x16x32_bf16 v[116:119], a[188:191], v[140:143], v[116:119]
ds_read_b64_tr_b16 a[168:169], v3 offset:33280
v_fma_f32 v32, v32, v28, v28
v_fma_f32 v33, v33, v28, v28
v_mfma_f32_16x16x32_bf16 v[116:119], a[192:195], v[148:151], v[116:119]
s_waitcnt lgkmcnt(5)
ds_read_b64_tr_b16 a[170:171], v3 offset:35328
v_fma_f32 v34, v34, v28, v28
v_fma_f32 v35, v35, v28, v28
v_mfma_f32_16x16x32_bf16 v[112:115], a[196:199], v[152:155], v[112:115]
s_add_u32 m0, s36, 6144
ds_read_b64_tr_b16 a[172:173], v3 offset:768
v_rcp_f32 v32, v32
v_mfma_f32_16x16x32_bf16 v[112:115], a[200:203], v[160:163], v[112:115]
ds_read_b64_tr_b16 a[174:175], v3 offset:2816
v_rcp_f32 v33, v33
v_mfma_f32_16x16x32_bf16 v[112:115], a[204:207], v[168:171], v[112:115]
buffer_load_dwordx4 v9, s[8:11], s41 offen offset:0  lds
v_mfma_f32_16x16x32_bf16 v[116:119], a[196:199], v[156:159], v[116:119]
ds_read_b64_tr_b16 a[176:177], v3 offset:4864
ds_read_b64_tr_b16 a[178:179], v3 offset:6912
v_mfma_f32_16x16x32_bf16 v[116:119], a[200:203], v[164:167], v[116:119]
s_add_u32 s97, s97, 1
ds_read_b64_tr_b16 a[180:181], v3 offset:8960
v_rcp_f32 v34, v34
v_mfma_f32_16x16x32_bf16 v[116:119], a[204:207], v[172:175], v[116:119]
s_waitcnt lgkmcnt(5)
ds_read_b64_tr_b16 a[182:183], v3 offset:11008
v_rcp_f32 v35, v35
v_mfma_f32_16x16x32_bf16 v[112:115], a[160:163], v[176:179], v[112:115]
s_and_b32 s97, s97, 3
ds_read_b64_tr_b16 a[184:185], v3 offset:13056
v_mul_f32 v80, v80, v32
v_mul_f32 v81, v81, v33
s_mul_i32 s39, s97, 36864
v_mfma_f32_16x16x32_bf16 v[112:115], a[164:167], v[184:187], v[112:115]
ds_read_b64_tr_b16 a[186:187], v3 offset:15104
v_mul_f32 v82, v82, v34
v_mfma_f32_16x16x32_bf16 v[112:115], a[168:171], v[192:195], v[112:115]
ds_read_b64_tr_b16 a[188:189], v3 offset:17152
v_mul_f32 v83, v83, v35
v_mfma_f32_16x16x32_bf16 v[116:119], a[160:163], v[180:183], v[116:119]
buffer_load_dwordx4 v10, s[8:11], s41 offen offset:1024  lds
v_mul_f32 v32, v84, v84
v_mfma_f32_16x16x32_bf16 v[116:119], a[164:167], v[188:191], v[116:119]
ds_read_b64_tr_b16 a[190:191], v3 offset:19200
ds_read_b64_tr_b16 a[192:193], v3 offset:21248
v_mul_f32 v33, v85, v85
v_mfma_f32_16x16x32_bf16 v[116:119], a[168:171], v[196:199], v[116:119]
s_waitcnt lgkmcnt(5)
ds_read_b64_tr_b16 a[194:195], v3 offset:23296
v_mul_f32 v34, v86, v86
v_mfma_f32_16x16x32_bf16 v[120:123], a[172:175], v[128:131], 0
ds_read_b64_tr_b16 a[196:197], v3 offset:25344
v_mul_f32 v35, v87, v87
v_mfma_f32_16x16x32_bf16 v[120:123], a[176:179], v[136:139], v[120:123]
ds_read_b64_tr_b16 a[198:199], v3 offset:27392
v_fma_f32 v32, v32, v27, v25
v_mfma_f32_16x16x32_bf16 v[120:123], a[180:183], v[144:147], v[120:123]
ds_read_b64_tr_b16 a[200:201], v3 offset:29440
v_fma_f32 v33, v33, v27, v25
v_mfma_f32_16x16x32_bf16 v[124:127], a[172:175], v[132:135], 0
ds_read_b64_tr_b16 a[202:203], v3 offset:31488
v_fma_f32 v34, v34, v27, v25
v_mfma_f32_16x16x32_bf16 v[124:127], a[176:179], v[140:143], v[124:127]
s_waitcnt vmcnt(8)
buffer_load_dwordx4 v11, s[8:11], s41 offen offset:2048  lds
s_barrier
v_mfma_f32_16x16x32_bf16 v[124:127], a[180:183], v[148:151], v[124:127]
s_waitcnt lgkmcnt(4)
ds_read_b64_tr_b16 a[204:205], v3 offset:33536
ds_read_b64_tr_b16 a[206:207], v3 offset:35584
v_add_u32 v3, s39, v5
v_mfma_f32_16x16x32_bf16 v[120:123], a[184:187], v[152:155], v[120:123]
s_add_u32 s96, s96, 1
ds_read_b64_tr_b16 a[160:161], v3 offset:0
v_fma_f32 v35, v35, v27, v25
v_mul_f32 v32, v84, v32
v_mfma_f32_16x16x32_bf16 v[120:123], a[188:191], v[160:163], v[120:123]
s_and_b32 s96, s96, 3
ds_read_b64_tr_b16 a[162:163], v3 offset:2048
v_mul_f32 v33, v85, v33
v_mul_f32 v34, v86, v34
s_mul_i32 s36, s96, 36864
v_mfma_f32_16x16x32_bf16 v[120:123], a[192:195], v[168:171], v[120:123]
s_add_u32 s36, s36, s38
ds_read_b64_tr_b16 a[164:165], v3 offset:4096
v_mul_f32 v35, v87, v35
v_mfma_f32_16x16x32_bf16 v[124:127], a[184:187], v[156:159], v[124:127]
ds_read_b64_tr_b16 a[166:167], v3 offset:6144
v_exp_f32 v32, v32
v_mfma_f32_16x16x32_bf16 v[124:127], a[188:191], v[164:167], v[124:127]
ds_read_b64_tr_b16 a[168:169], v3 offset:8192
v_exp_f32 v33, v33
v_mfma_f32_16x16x32_bf16 v[124:127], a[192:195], v[172:175], v[124:127]
s_waitcnt lgkmcnt(5)
ds_read_b64_tr_b16 a[170:171], v3 offset:10240
v_mfma_f32_16x16x32_bf16 v[120:123], a[196:199], v[176:179], v[120:123]
ds_read_b64_tr_b16 a[172:173], v3 offset:12288
v_exp_f32 v34, v34
v_mfma_f32_16x16x32_bf16 v[120:123], a[200:203], v[184:187], v[120:123]
ds_read_b64_tr_b16 a[174:175], v3 offset:14336
v_exp_f32 v36, v36
v_mfma_f32_16x16x32_bf16 v[120:123], a[204:207], v[192:195], v[120:123]
ds_read_b64_tr_b16 a[176:177], v3 offset:16384
v_exp_f32 v35, v35
v_mfma_f32_16x16x32_bf16 v[124:127], a[196:199], v[180:183], v[124:127]
s_mov_b32 s41, s100
ds_read_b64_tr_b16 a[178:179], v3 offset:18432
v_fma_f32 v32, v32, v29, v29
v_mfma_f32_16x16x32_bf16 v[124:127], a[200:203], v[188:191], v[124:127]
ds_read_b64_tr_b16 a[180:181], v3 offset:20480
v_fma_f32 v33, v33, v29, v29
v_mfma_f32_16x16x32_bf16 v[124:127], a[204:207], v[196:199], v[124:127]
s_waitcnt lgkmcnt(5)
ds_read_b64_tr_b16 a[182:183], v3 offset:22528
v_fma_f32 v34, v34, v29, v29
v_mfma_f32_16x16x32_bf16 v[96:99], a[160:163], v[200:203], v[96:99]
s_mov_b32 m0, s36
ds_read_b64_tr_b16 a[184:185], v3 offset:24576
v_fma_f32 v35, v35, v29, v29
v_mfma_f32_16x16x32_bf16 v[96:99], a[164:167], v[208:211], v[96:99]
ds_read_b64_tr_b16 a[186:187], v3 offset:26624
v_exp_f32 v37, v37
v_mfma_f32_16x16x32_bf16 v[96:99], a[168:171], v[216:219], v[96:99]
buffer_load_dwordx4 v9, s[8:11], s41 offen offset:0  lds
v_mfma_f32_16x16x32_bf16 v[100:103], a[160:163], v[204:207], v[100:103]
ds_read_b64_tr_b16 a[188:189], v3 offset:28672
ds_read_b64_tr_b16 a[190:191], v3 offset:30720
v_mfma_f32_16x16x32_bf16 v[100:103], a[164:167], v[212:215], v[100:103]
ds_read_b64_tr_b16 a[192:193], v3 offset:32768
v_exp_f32 v38, v38
v_mfma_f32_16x16x32_bf16 v[100:103], a[168:171], v[220:223], v[100:103]
s_waitcnt lgkmcnt(5)
ds_read_b64_tr_b16 a[194:195], v3 offset:34816
v_rcp_f32 v32, v32
v_mfma_f32_16x16x32_bf16 v[96:99], a[172:175], v[224:227], v[96:99]
ds_read_b64_tr_b16 a[196:197], v3 offset:256
v_rcp_f32 v33, v33
v_mfma_f32_16x16x32_bf16 v[96:99], a[176:179], v[232:235], v[96:99]
ds_read_b64_tr_b16 a[198:199], v3 offset:2304
v_exp_f32 v39, v39
v_mfma_f32_16x16x32_bf16 v[96:99], a[180:183], v[240:243], v[96:99]
ds_read_b64_tr_b16 a[200:201], v3 offset:4352
v_fma_f32 v36, v36, v28, v28
v_fma_f32 v37, v37, v28, v28
v_mfma_f32_16x16x32_bf16 v[100:103], a[172:175], v[228:231], v[100:103]
buffer_load_dwordx4 v10, s[8:11], s41 offen offset:1024  lds
v_fma_f32 v38, v38, v28, v28
v_mfma_f32_16x16x32_bf16 v[100:103], a[176:179], v[236:239], v[100:103]
ds_read_b64_tr_b16 a[202:203], v3 offset:6400
ds_read_b64_tr_b16 a[204:205], v3 offset:8448
v_fma_f32 v39, v39, v28, v28
v_mfma_f32_16x16x32_bf16 v[100:103], a[180:183], v[244:247], v[100:103]
s_waitcnt lgkmcnt(5)
ds_read_b64_tr_b16 a[206:207], v3 offset:10496
v_rcp_f32 v34, v34
v_mfma_f32_16x16x32_bf16 v[96:99], a[184:187], v[248:251], v[96:99]
ds_read_b64_tr_b16 a[160:161], v3 offset:12544
v_rcp_f32 v35, v35
v_mfma_f32_16x16x32_bf16 v[96:99], a[188:191], a[144:147], v[96:99]
ds_read_b64_tr_b16 a[162:163], v3 offset:14592
v_mul_f32 v84, v84, v32
v_mul_f32 v85, v85, v33
v_mfma_f32_16x16x32_bf16 v[96:99], a[192:195], a[152:155], v[96:99]
ds_read_b64_tr_b16 a[164:165], v3 offset:16640
v_mul_f32 v86, v86, v34
v_mul_f32 v87, v87, v35
v_mfma_f32_16x16x32_bf16 v[100:103], a[184:187], v[252:255], v[100:103]
ds_read_b64_tr_b16 a[166:167], v3 offset:18688
v_rcp_f32 v36, v36
v_mfma_f32_16x16x32_bf16 v[100:103], a[188:191], a[148:151], v[100:103]
buffer_load_dwordx4 v11, s[8:11], s41 offen offset:2048  lds
v_mfma_f32_16x16x32_bf16 v[100:103], a[192:195], a[156:159], v[100:103]
s_waitcnt lgkmcnt(4)
ds_read_b64_tr_b16 a[168:169], v3 offset:20736
ds_read_b64_tr_b16 a[170:171], v3 offset:22784
v_mfma_f32_16x16x32_bf16 v[104:107], a[196:199], v[200:203], v[104:107]
s_add_u32 s41, s100, 0x36000
ds_read_b64_tr_b16 a[172:173], v3 offset:24832
v_rcp_f32 v37, v37
v_mfma_f32_16x16x32_bf16 v[104:107], a[200:203], v[208:211], v[104:107]
ds_read_b64_tr_b16 a[174:175], v3 offset:26880
v_rcp_f32 v38, v38
v_mfma_f32_16x16x32_bf16 v[104:107], a[204:207], v[216:219], v[104:107]
s_add_u32 m0, s36, 3072
ds_read_b64_tr_b16 a[176:177], v3 offset:28928
v_mul_f32 v64, v64, v96
v_mfma_f32_16x16x32_bf16 v[108:111], a[196:199], v[204:207], v[108:111]
ds_read_b64_tr_b16 a[178:179], v3 offset:30976
v_mul_f32 v65, v65, v97
v_mfma_f32_16x16x32_bf16 v[108:111], a[200:203], v[212:215], v[108:111]
ds_read_b64_tr_b16 a[180:181], v3 offset:33024
v_mul_f32 v66, v66, v98
v_mfma_f32_16x16x32_bf16 v[108:111], a[204:207], v[220:223], v[108:111]
s_waitcnt lgkmcnt(5)
buffer_load_dwordx4 v9, s[8:11], s41 offen offset:0  lds
v_mfma_f32_16x16x32_bf16 v[104:107], a[160:163], v[224:227], v[104:107]
ds_read_b64_tr_b16 a[182:183], v3 offset:35072
ds_read_b64_tr_b16 a[184:185], v3 offset:512
v_mfma_f32_16x16x32_bf16 v[104:107], a[164:167], v[232:235], v[104:107]
ds_read_b64_tr_b16 a[186:187], v3 offset:2560
v_mul_f32 v67, v67, v99
v_rcp_f32 v39, v39
v_mfma_f32_16x16x32_bf16 v[104:107], a[168:171], v[240:243], v[104:107]
ds_read_b64_tr_b16 a[188:189], v3 offset:4608
v_mul_f32 v68, v68, v100
v_mul_f32 v88, v88, v36
v_mfma_f32_16x16x32_bf16 v[108:111], a[160:163], v[228:231], v[108:111]
ds_read_b64_tr_b16 a[190:191], v3 offset:6656
v_mul_f32 v69, v69, v101
v_mul_f32 v89, v89, v37
v_mfma_f32_16x16x32_bf16 v[108:111], a[164:167], v[236:239], v[108:111]
ds_read_b64_tr_b16 a[192:193], v3 offset:8704
v_mul_f32 v70, v70, v102
v_mul_f32 v90, v90, v38
v_mfma_f32_16x16x32_bf16 v[108:111], a[168:171], v[244:247], v[108:111]
s_waitcnt lgkmcnt(5)
ds_read_b64_tr_b16 a[194:195], v3 offset:10752
v_mul_f32 v71, v71, v103
v_mul_f32 v91, v91, v39
v_mfma_f32_16x16x32_bf16 v[104:107], a[172:175], v[248:251], v[104:107]
buffer_load_dwordx4 v10, s[8:11], s41 offen offset:1024  lds
v_mul_f32 v36, v92, v92
v_mfma_f32_16x16x32_bf16 v[104:107], a[176:179], a[144:147], v[104:107]
ds_read_b64_tr_b16 a[196:197], v3 offset:12800
ds_read_b64_tr_b16 a[198:199], v3 offset:14848
v_mul_f32 v37, v93, v93
v_mfma_f32_16x16x32_bf16 v[104:107], a[180:183], a[152:155], v[104:107]
ds_read_b64_tr_b16 a[200:201], v3 offset:16896
v_cvt_pk_bf16_f32 v40, v64, v65
v_mul_f32 v38, v94, v94
v_mfma_f32_16x16x32_bf16 v[108:111], a[172:175], v[252:255], v[108:111]
ds_read_b64_tr_b16 a[202:203], v3 offset:18944
v_cvt_pk_bf16_f32 v41, v66, v67
v_mul_f32 v39, v95, v95
v_mfma_f32_16x16x32_bf16 v[108:111], a[176:179], a[148:151], v[108:111]
ds_read_b64_tr_b16 a[204:205], v3 offset:20992
v_cvt_pk_bf16_f32 v44, v68, v69
v_fma_f32 v36, v36, v27, v25
v_mfma_f32_16x16x32_bf16 v[108:111], a[180:183], a[156:159], v[108:111]
s_waitcnt lgkmcnt(5)
ds_read_b64_tr_b16 a[206:207], v3 offset:23040
v_cvt_pk_bf16_f32 v45, v70, v71
v_fma_f32 v37, v37, v27, v25
v_mfma_f32_16x16x32_bf16 v[112:115], a[184:187], v[200:203], v[112:115]
ds_read_b64_tr_b16 a[160:161], v3 offset:25088
v_fma_f32 v38, v38, v27, v25
v_fma_f32 v39, v39, v27, v25
v_mfma_f32_16x16x32_bf16 v[112:115], a[188:191], v[208:211], v[112:115]
buffer_load_dwordx4 v11, s[8:11], s41 offen offset:2048  lds
v_mfma_f32_16x16x32_bf16 v[112:115], a[192:195], v[216:219], v[112:115]
ds_read_b64_tr_b16 a[162:163], v3 offset:27136
ds_read_b64_tr_b16 a[164:165], v3 offset:29184
v_mul_f32 v36, v92, v36
v_mfma_f32_16x16x32_bf16 v[116:119], a[184:187], v[204:207], v[116:119]
s_add_u32 s41, s100, 0x6c000
ds_read_b64_tr_b16 a[166:167], v3 offset:31232
v_mul_f32 v72, v72, v104
v_mul_f32 v37, v93, v37
v_mfma_f32_16x16x32_bf16 v[116:119], a[188:191], v[212:215], v[116:119]
ds_read_b64_tr_b16 a[168:169], v3 offset:33280
v_mul_f32 v73, v73, v105
v_mul_f32 v38, v94, v38
v_mfma_f32_16x16x32_bf16 v[116:119], a[192:195], v[220:223], v[116:119]
s_waitcnt lgkmcnt(5)
ds_read_b64_tr_b16 a[170:171], v3 offset:35328
v_mul_f32 v74, v74, v106
v_mfma_f32_16x16x32_bf16 v[112:115], a[196:199], v[224:227], v[112:115]
s_add_u32 m0, s36, 6144
ds_read_b64_tr_b16 a[172:173], v3 offset:768
v_mul_f32 v75, v75, v107
v_mul_f32 v39, v95, v39
v_mfma_f32_16x16x32_bf16 v[112:115], a[200:203], v[232:235], v[112:115]
ds_read_b64_tr_b16 a[174:175], v3 offset:2816
v_mul_f32 v76, v76, v108
v_mfma_f32_16x16x32_bf16 v[112:115], a[204:207], v[240:243], v[112:115]
buffer_load_dwordx4 v9, s[8:11], s41 offen offset:0  lds
v_mfma_f32_16x16x32_bf16 v[116:119], a[196:199], v[228:231], v[116:119]
ds_read_b64_tr_b16 a[176:177], v3 offset:4864
ds_read_b64_tr_b16 a[178:179], v3 offset:6912
v_mfma_f32_16x16x32_bf16 v[116:119], a[200:203], v[236:239], v[116:119]
s_add_u32 s97, s97, 1
ds_read_b64_tr_b16 a[180:181], v3 offset:8960
v_mul_f32 v77, v77, v109
v_mfma_f32_16x16x32_bf16 v[116:119], a[204:207], v[244:247], v[116:119]
s_waitcnt lgkmcnt(5)
ds_read_b64_tr_b16 a[182:183], v3 offset:11008
v_mul_f32 v78, v78, v110
v_mfma_f32_16x16x32_bf16 v[112:115], a[160:163], v[248:251], v[112:115]
s_and_b32 s97, s97, 3
ds_read_b64_tr_b16 a[184:185], v3 offset:13056
v_mul_f32 v79, v79, v111
s_mul_i32 s39, s97, 36864
v_mfma_f32_16x16x32_bf16 v[112:115], a[164:167], a[144:147], v[112:115]
ds_read_b64_tr_b16 a[186:187], v3 offset:15104
v_cvt_pk_bf16_f32 v42, v72, v73
v_exp_f32 v36, v36
v_mfma_f32_16x16x32_bf16 v[112:115], a[168:171], a[152:155], v[112:115]
ds_read_b64_tr_b16 a[188:189], v3 offset:17152
v_cvt_pk_bf16_f32 v43, v74, v75
v_mfma_f32_16x16x32_bf16 v[116:119], a[160:163], v[252:255], v[116:119]
buffer_load_dwordx4 v10, s[8:11], s41 offen offset:1024  lds
v_mfma_f32_16x16x32_bf16 v[116:119], a[164:167], a[148:151], v[116:119]
ds_read_b64_tr_b16 a[190:191], v3 offset:19200
ds_read_b64_tr_b16 a[192:193], v3 offset:21248
v_exp_f32 v37, v37
v_mfma_f32_16x16x32_bf16 v[116:119], a[168:171], a[156:159], v[116:119]
s_waitcnt lgkmcnt(5)
ds_read_b64_tr_b16 a[194:195], v3 offset:23296
v_cvt_pk_bf16_f32 v46, v76, v77
v_mfma_f32_16x16x32_bf16 v[120:123], a[172:175], v[200:203], v[120:123]
ds_read_b64_tr_b16 a[196:197], v3 offset:25344
v_cvt_pk_bf16_f32 v47, v78, v79
v_mfma_f32_16x16x32_bf16 v[120:123], a[176:179], v[208:211], v[120:123]
ds_read_b64_tr_b16 a[198:199], v3 offset:27392
v_exp_f32 v38, v38
v_mfma_f32_16x16x32_bf16 v[120:123], a[180:183], v[216:219], v[120:123]
ds_read_b64_tr_b16 a[200:201], v3 offset:29440
v_exp_f32 v39, v39
v_mfma_f32_16x16x32_bf16 v[124:127], a[172:175], v[204:207], v[124:127]
ds_read_b64_tr_b16 a[202:203], v3 offset:31488
v_fma_f32 v36, v36, v29, v29
v_fma_f32 v37, v37, v29, v29
v_mfma_f32_16x16x32_bf16 v[124:127], a[176:179], v[212:215], v[124:127]
s_waitcnt vmcnt(8)
buffer_load_dwordx4 v11, s[8:11], s41 offen offset:2048  lds
s_barrier
v_mfma_f32_16x16x32_bf16 v[124:127], a[180:183], v[220:223], v[124:127]
s_waitcnt lgkmcnt(4)
ds_read_b64_tr_b16 a[204:205], v3 offset:33536
ds_read_b64_tr_b16 a[206:207], v3 offset:35584
v_add_u32 v3, s39, v5
v_mfma_f32_16x16x32_bf16 v[120:123], a[184:187], v[224:227], v[120:123]
s_add_u32 s96, s96, 1
ds_read_b64_tr_b16 a[160:161], v3 offset:0
v_fma_f32 v38, v38, v29, v29
v_fma_f32 v39, v39, v29, v29
v_mfma_f32_16x16x32_bf16 v[120:123], a[188:191], v[232:235], v[120:123]
s_and_b32 s96, s96, 3
ds_read_b64_tr_b16 a[162:163], v3 offset:2048
v_rcp_f32 v36, v36
s_mul_i32 s36, s96, 36864
v_mfma_f32_16x16x32_bf16 v[120:123], a[192:195], v[240:243], v[120:123]
s_add_u32 s36, s36, s38
ds_read_b64_tr_b16 a[164:165], v3 offset:4096
v_rcp_f32 v37, v37
v_mfma_f32_16x16x32_bf16 v[124:127], a[184:187], v[228:231], v[124:127]
ds_read_b64_tr_b16 a[166:167], v3 offset:6144
v_mfma_f32_16x16x32_bf16 v[124:127], a[188:191], v[236:239], v[124:127]
ds_read_b64_tr_b16 a[168:169], v3 offset:8192
v_mfma_f32_16x16x32_bf16 v[124:127], a[192:195], v[244:247], v[124:127]
s_waitcnt lgkmcnt(5)
ds_read_b64_tr_b16 a[170:171], v3 offset:10240
v_rcp_f32 v38, v38
v_mfma_f32_16x16x32_bf16 v[120:123], a[196:199], v[248:251], v[120:123]
ds_read_b64_tr_b16 a[172:173], v3 offset:12288
v_mfma_f32_16x16x32_bf16 v[120:123], a[200:203], a[144:147], v[120:123]
ds_read_b64_tr_b16 a[174:175], v3 offset:14336
v_rcp_f32 v39, v39
v_mfma_f32_16x16x32_bf16 v[120:123], a[204:207], a[152:155], v[120:123]
ds_read_b64_tr_b16 a[176:177], v3 offset:16384
v_mul_f32 v92, v92, v36
v_mfma_f32_16x16x32_bf16 v[124:127], a[196:199], v[252:255], v[124:127]
ds_read_b64_tr_b16 a[178:179], v3 offset:18432
v_mul_f32 v93, v93, v37
v_mfma_f32_16x16x32_bf16 v[124:127], a[200:203], a[148:151], v[124:127]
ds_read_b64_tr_b16 a[180:181], v3 offset:20480
v_mul_f32 v94, v94, v38
v_mfma_f32_16x16x32_bf16 v[124:127], a[204:207], a[156:159], v[124:127]
s_waitcnt lgkmcnt(5)
ds_read_b64_tr_b16 a[182:183], v3 offset:22528
v_mul_f32 v95, v95, v39
v_mfma_f32_16x16x32_bf16 v[64:67], a[160:163], v[128:131], 0
s_mov_b32 m0, s36
ds_read_b64_tr_b16 a[184:185], v3 offset:24576
v_mfma_f32_16x16x32_bf16 v[64:67], a[164:167], v[136:139], v[64:67]
ds_read_b64_tr_b16 a[186:187], v3 offset:26624
buffer_store_dwordx4 v[40:43], v30, s[20:23], s33 offen offset:0 sc1
v_mfma_f32_16x16x32_bf16 v[64:67], a[168:171], v[144:147], v[64:67]
buffer_load_dwordx4 v15, s[16:19], s27 offen  lds
v_mfma_f32_16x16x32_bf16 v[68:71], a[160:163], v[132:135], 0
ds_read_b64_tr_b16 a[188:189], v3 offset:28672
ds_read_b64_tr_b16 a[190:191], v3 offset:30720
v_mfma_f32_16x16x32_bf16 v[68:71], a[164:167], v[140:143], v[68:71]
ds_read_b64_tr_b16 a[192:193], v3 offset:32768
buffer_store_dwordx4 v[44:47], v30, s[20:23], s33 offen offset:1024 sc1
v_mfma_f32_16x16x32_bf16 v[68:71], a[168:171], v[148:151], v[68:71]
s_waitcnt lgkmcnt(5)
ds_read_b64_tr_b16 a[194:195], v3 offset:34816
v_mul_f32 v80, v80, v112
v_mfma_f32_16x16x32_bf16 v[64:67], a[172:175], v[152:155], v[64:67]
s_add_u32 m0, s36, 1024
ds_read_b64_tr_b16 a[196:197], v3 offset:256
v_mul_f32 v81, v81, v113
v_mfma_f32_16x16x32_bf16 v[64:67], a[176:179], v[160:163], v[64:67]
ds_read_b64_tr_b16 a[198:199], v3 offset:2304
v_mul_f32 v82, v82, v114
v_mfma_f32_16x16x32_bf16 v[64:67], a[180:183], v[168:171], v[64:67]
ds_read_b64_tr_b16 a[200:201], v3 offset:4352
v_mul_f32 v83, v83, v115
v_mfma_f32_16x16x32_bf16 v[68:71], a[172:175], v[156:159], v[68:71]
buffer_load_dwordx4 v16, s[16:19], s27 offen  lds
v_mfma_f32_16x16x32_bf16 v[68:71], a[176:179], v[164:167], v[68:71]
ds_read_b64_tr_b16 a[202:203], v3 offset:6400
ds_read_b64_tr_b16 a[204:205], v3 offset:8448
v_mfma_f32_16x16x32_bf16 v[68:71], a[180:183], v[172:175], v[68:71]
s_waitcnt lgkmcnt(5)
ds_read_b64_tr_b16 a[206:207], v3 offset:10496
v_mul_f32 v84, v84, v116
v_mfma_f32_16x16x32_bf16 v[64:67], a[184:187], v[176:179], v[64:67]
ds_read_b64_tr_b16 a[160:161], v3 offset:12544
v_mul_f32 v85, v85, v117
v_mfma_f32_16x16x32_bf16 v[64:67], a[188:191], v[184:187], v[64:67]
s_add_u32 m0, s36, 2048
ds_read_b64_tr_b16 a[162:163], v3 offset:14592
v_mul_f32 v86, v86, v118
v_mfma_f32_16x16x32_bf16 v[64:67], a[192:195], v[192:195], v[64:67]
ds_read_b64_tr_b16 a[164:165], v3 offset:16640
v_mul_f32 v87, v87, v119
v_mfma_f32_16x16x32_bf16 v[68:71], a[184:187], v[180:183], v[68:71]
ds_read_b64_tr_b16 a[166:167], v3 offset:18688
v_cvt_pk_bf16_f32 v48, v80, v81
v_mfma_f32_16x16x32_bf16 v[68:71], a[188:191], v[188:191], v[68:71]
buffer_load_dwordx4 v17, s[16:19], s27 offen  lds
v_mfma_f32_16x16x32_bf16 v[68:71], a[192:195], v[196:199], v[68:71]
s_waitcnt lgkmcnt(4)
ds_read_b64_tr_b16 a[168:169], v3 offset:20736
ds_read_b64_tr_b16 a[170:171], v3 offset:22784
v_mfma_f32_16x16x32_bf16 v[72:75], a[196:199], v[128:131], 0
ds_read_b64_tr_b16 a[172:173], v3 offset:24832
v_cvt_pk_bf16_f32 v49, v82, v83
v_mfma_f32_16x16x32_bf16 v[72:75], a[200:203], v[136:139], v[72:75]
ds_read_b64_tr_b16 a[174:175], v3 offset:26880
v_cvt_pk_bf16_f32 v52, v84, v85
v_mfma_f32_16x16x32_bf16 v[72:75], a[204:207], v[144:147], v[72:75]
s_add_u32 m0, s36, 3072
ds_read_b64_tr_b16 a[176:177], v3 offset:28928
v_cvt_pk_bf16_f32 v53, v86, v87
v_mfma_f32_16x16x32_bf16 v[76:79], a[196:199], v[132:135], 0
ds_read_b64_tr_b16 a[178:179], v3 offset:30976
v_mul_f32 v88, v88, v120
v_mfma_f32_16x16x32_bf16 v[76:79], a[200:203], v[140:143], v[76:79]
ds_read_b64_tr_b16 a[180:181], v3 offset:33024
v_mul_f32 v89, v89, v121
v_mfma_f32_16x16x32_bf16 v[76:79], a[204:207], v[148:151], v[76:79]
s_waitcnt lgkmcnt(5)
buffer_load_dwordx4 v18, s[16:19], s27 offen  lds
v_mfma_f32_16x16x32_bf16 v[72:75], a[160:163], v[152:155], v[72:75]
ds_read_b64_tr_b16 a[182:183], v3 offset:35072
ds_read_b64_tr_b16 a[184:185], v3 offset:512
v_mfma_f32_16x16x32_bf16 v[72:75], a[164:167], v[160:163], v[72:75]
ds_read_b64_tr_b16 a[186:187], v3 offset:2560
v_mul_f32 v90, v90, v122
v_mfma_f32_16x16x32_bf16 v[72:75], a[168:171], v[168:171], v[72:75]
ds_read_b64_tr_b16 a[188:189], v3 offset:4608
v_mul_f32 v91, v91, v123
v_mfma_f32_16x16x32_bf16 v[76:79], a[160:163], v[156:159], v[76:79]
s_add_u32 m0, s36, 4096
ds_read_b64_tr_b16 a[190:191], v3 offset:6656
v_mul_f32 v92, v92, v124
v_mfma_f32_16x16x32_bf16 v[76:79], a[164:167], v[164:167], v[76:79]
ds_read_b64_tr_b16 a[192:193], v3 offset:8704
v_mul_f32 v93, v93, v125
v_mfma_f32_16x16x32_bf16 v[76:79], a[168:171], v[172:175], v[76:79]
s_waitcnt lgkmcnt(5)
ds_read_b64_tr_b16 a[194:195], v3 offset:10752
v_mul_f32 v94, v94, v126
v_mfma_f32_16x16x32_bf16 v[72:75], a[172:175], v[176:179], v[72:75]
buffer_load_dwordx4 v19, s[16:19], s27 offen  lds
v_mfma_f32_16x16x32_bf16 v[72:75], a[176:179], v[184:187], v[72:75]
ds_read_b64_tr_b16 a[196:197], v3 offset:12800
ds_read_b64_tr_b16 a[198:199], v3 offset:14848
v_mfma_f32_16x16x32_bf16 v[72:75], a[180:183], v[192:195], v[72:75]
ds_read_b64_tr_b16 a[200:201], v3 offset:16896
v_mul_f32 v95, v95, v127
v_mfma_f32_16x16x32_bf16 v[76:79], a[172:175], v[180:183], v[76:79]
ds_read_b64_tr_b16 a[202:203], v3 offset:18944
v_cvt_pk_bf16_f32 v50, v88, v89
v_mfma_f32_16x16x32_bf16 v[76:79], a[176:179], v[188:191], v[76:79]
s_add_u32 m0, s36, 5120
ds_read_b64_tr_b16 a[204:205], v3 offset:20992
v_cvt_pk_bf16_f32 v51, v90, v91
v_mfma_f32_16x16x32_bf16 v[76:79], a[180:183], v[196:199], v[76:79]
s_waitcnt lgkmcnt(5)
ds_read_b64_tr_b16 a[206:207], v3 offset:23040
v_cvt_pk_bf16_f32 v54, v92, v93
v_mfma_f32_16x16x32_bf16 v[80:83], a[184:187], v[128:131], 0
ds_read_b64_tr_b16 a[160:161], v3 offset:25088
v_cvt_pk_bf16_f32 v55, v94, v95
v_mfma_f32_16x16x32_bf16 v[80:83], a[188:191], v[136:139], v[80:83]
buffer_load_dwordx4 v20, s[16:19], s27 offen  lds
v_mfma_f32_16x16x32_bf16 v[80:83], a[192:195], v[144:147], v[80:83]
ds_read_b64_tr_b16 a[162:163], v3 offset:27136
ds_read_b64_tr_b16 a[164:165], v3 offset:29184
v_mfma_f32_16x16x32_bf16 v[84:87], a[184:187], v[132:135], 0
ds_read_b64_tr_b16 a[166:167], v3 offset:31232
v_mfma_f32_16x16x32_bf16 v[84:87], a[188:191], v[140:143], v[84:87]
ds_read_b64_tr_b16 a[168:169], v3 offset:33280
buffer_store_dwordx4 v[48:51], v30, s[20:23], s33 offen offset:2048 sc1
v_mfma_f32_16x16x32_bf16 v[84:87], a[192:195], v[148:151], v[84:87]
s_waitcnt lgkmcnt(5)
ds_read_b64_tr_b16 a[170:171], v3 offset:35328
v_mfma_f32_16x16x32_bf16 v[80:83], a[196:199], v[152:155], v[80:83]
s_add_u32 m0, s36, 6144
ds_read_b64_tr_b16 a[172:173], v3 offset:768
buffer_store_dwordx4 v[52:55], v30, s[20:23], s33 offen offset:3072 sc1
v_mfma_f32_16x16x32_bf16 v[80:83], a[200:203], v[160:163], v[80:83]
ds_read_b64_tr_b16 a[174:175], v3 offset:2816
v_mfma_f32_16x16x32_bf16 v[80:83], a[204:207], v[168:171], v[80:83]
buffer_load_dwordx4 v21, s[16:19], s27 offen  lds
v_mfma_f32_16x16x32_bf16 v[84:87], a[196:199], v[156:159], v[84:87]
ds_read_b64_tr_b16 a[176:177], v3 offset:4864
ds_read_b64_tr_b16 a[178:179], v3 offset:6912
v_mfma_f32_16x16x32_bf16 v[84:87], a[200:203], v[164:167], v[84:87]
s_add_u32 s97, s97, 1
ds_read_b64_tr_b16 a[180:181], v3 offset:8960
v_mfma_f32_16x16x32_bf16 v[84:87], a[204:207], v[172:175], v[84:87]
s_waitcnt lgkmcnt(5)
ds_read_b64_tr_b16 a[182:183], v3 offset:11008
v_mfma_f32_16x16x32_bf16 v[80:83], a[160:163], v[176:179], v[80:83]
s_add_u32 m0, s36, 7168
ds_read_b64_tr_b16 a[184:185], v3 offset:13056
s_and_b32 s97, s97, 3
s_mul_i32 s39, s97, 36864
v_mfma_f32_16x16x32_bf16 v[80:83], a[164:167], v[184:187], v[80:83]
ds_read_b64_tr_b16 a[186:187], v3 offset:15104
v_mfma_f32_16x16x32_bf16 v[80:83], a[168:171], v[192:195], v[80:83]
ds_read_b64_tr_b16 a[188:189], v3 offset:17152
v_mfma_f32_16x16x32_bf16 v[84:87], a[160:163], v[180:183], v[84:87]
buffer_load_dwordx4 v22, s[16:19], s27 offen  lds
v_mfma_f32_16x16x32_bf16 v[84:87], a[164:167], v[188:191], v[84:87]
ds_read_b64_tr_b16 a[190:191], v3 offset:19200
ds_read_b64_tr_b16 a[192:193], v3 offset:21248
v_mfma_f32_16x16x32_bf16 v[84:87], a[168:171], v[196:199], v[84:87]
s_waitcnt lgkmcnt(5)
ds_read_b64_tr_b16 a[194:195], v3 offset:23296
v_mfma_f32_16x16x32_bf16 v[88:91], a[172:175], v[128:131], 0
ds_read_b64_tr_b16 a[196:197], v3 offset:25344
v_mfma_f32_16x16x32_bf16 v[88:91], a[176:179], v[136:139], v[88:91]
s_add_u32 m0, s36, 8192
ds_read_b64_tr_b16 a[198:199], v3 offset:27392
v_mfma_f32_16x16x32_bf16 v[88:91], a[180:183], v[144:147], v[88:91]
ds_read_b64_tr_b16 a[200:201], v3 offset:29440
v_mfma_f32_16x16x32_bf16 v[92:95], a[172:175], v[132:135], 0
ds_read_b64_tr_b16 a[202:203], v3 offset:31488
v_mfma_f32_16x16x32_bf16 v[92:95], a[176:179], v[140:143], v[92:95]
s_waitcnt vmcnt(12)
buffer_load_dwordx4 v23, s[16:19], s27 offen  lds
s_barrier
v_mfma_f32_16x16x32_bf16 v[92:95], a[180:183], v[148:151], v[92:95]
s_waitcnt lgkmcnt(4)
ds_read_b64_tr_b16 a[204:205], v3 offset:33536
ds_read_b64_tr_b16 a[206:207], v3 offset:35584
v_add_u32 v3, s39, v5
v_mfma_f32_16x16x32_bf16 v[88:91], a[184:187], v[152:155], v[88:91]
s_add_u32 s96, s96, 1
ds_read_b64_tr_b16 a[160:161], v3 offset:0
v_mfma_f32_16x16x32_bf16 v[88:91], a[188:191], v[160:163], v[88:91]
s_and_b32 s96, s96, 3
ds_read_b64_tr_b16 a[162:163], v3 offset:2048
s_mul_i32 s36, s96, 36864
s_add_u32 s36, s36, s38
v_mfma_f32_16x16x32_bf16 v[88:91], a[192:195], v[168:171], v[88:91]
ds_read_b64_tr_b16 a[164:165], v3 offset:4096
v_mfma_f32_16x16x32_bf16 v[92:95], a[184:187], v[156:159], v[92:95]
ds_read_b64_tr_b16 a[166:167], v3 offset:6144
v_mfma_f32_16x16x32_bf16 v[92:95], a[188:191], v[164:167], v[92:95]
ds_read_b64_tr_b16 a[168:169], v3 offset:8192
v_mfma_f32_16x16x32_bf16 v[92:95], a[192:195], v[172:175], v[92:95]
s_waitcnt lgkmcnt(5)
ds_read_b64_tr_b16 a[170:171], v3 offset:10240
v_mfma_f32_16x16x32_bf16 v[88:91], a[196:199], v[176:179], v[88:91]
ds_read_b64_tr_b16 a[172:173], v3 offset:12288
v_mfma_f32_16x16x32_bf16 v[88:91], a[200:203], v[184:187], v[88:91]
ds_read_b64_tr_b16 a[174:175], v3 offset:14336
v_mfma_f32_16x16x32_bf16 v[88:91], a[204:207], v[192:195], v[88:91]
ds_read_b64_tr_b16 a[176:177], v3 offset:16384
v_mfma_f32_16x16x32_bf16 v[92:95], a[196:199], v[180:183], v[92:95]
s_mov_b32 s41, s25
ds_read_b64_tr_b16 a[178:179], v3 offset:18432
v_mfma_f32_16x16x32_bf16 v[92:95], a[200:203], v[188:191], v[92:95]
ds_read_b64_tr_b16 a[180:181], v3 offset:20480
v_mfma_f32_16x16x32_bf16 v[92:95], a[204:207], v[196:199], v[92:95]
s_waitcnt lgkmcnt(5)
ds_read_b64_tr_b16 a[182:183], v3 offset:22528
v_mfma_f32_16x16x32_bf16 v[64:67], a[160:163], v[200:203], v[64:67]
s_mov_b32 m0, s36
ds_read_b64_tr_b16 a[184:185], v3 offset:24576
v_mfma_f32_16x16x32_bf16 v[64:67], a[164:167], v[208:211], v[64:67]
ds_read_b64_tr_b16 a[186:187], v3 offset:26624
v_mfma_f32_16x16x32_bf16 v[64:67], a[168:171], v[216:219], v[64:67]
buffer_load_dwordx4 v9, s[12:15], s41 offen offset:0  lds
v_mfma_f32_16x16x32_bf16 v[68:71], a[160:163], v[204:207], v[68:71]
ds_read_b64_tr_b16 a[188:189], v3 offset:28672
ds_read_b64_tr_b16 a[190:191], v3 offset:30720
v_mfma_f32_16x16x32_bf16 v[68:71], a[164:167], v[212:215], v[68:71]
ds_read_b64_tr_b16 a[192:193], v3 offset:32768
v_mfma_f32_16x16x32_bf16 v[68:71], a[168:171], v[220:223], v[68:71]
s_waitcnt lgkmcnt(5)
ds_read_b64_tr_b16 a[194:195], v3 offset:34816
v_mfma_f32_16x16x32_bf16 v[64:67], a[172:175], v[224:227], v[64:67]
ds_read_b64_tr_b16 a[196:197], v3 offset:256
v_mfma_f32_16x16x32_bf16 v[64:67], a[176:179], v[232:235], v[64:67]
ds_read_b64_tr_b16 a[198:199], v3 offset:2304
v_mfma_f32_16x16x32_bf16 v[64:67], a[180:183], v[240:243], v[64:67]
ds_read_b64_tr_b16 a[200:201], v3 offset:4352
v_mfma_f32_16x16x32_bf16 v[68:71], a[172:175], v[228:231], v[68:71]
buffer_load_dwordx4 v10, s[12:15], s41 offen offset:1024  lds
v_mfma_f32_16x16x32_bf16 v[68:71], a[176:179], v[236:239], v[68:71]
ds_read_b64_tr_b16 a[202:203], v3 offset:6400
ds_read_b64_tr_b16 a[204:205], v3 offset:8448
v_mfma_f32_16x16x32_bf16 v[68:71], a[180:183], v[244:247], v[68:71]
s_waitcnt lgkmcnt(5)
ds_read_b64_tr_b16 a[206:207], v3 offset:10496
v_mfma_f32_16x16x32_bf16 v[64:67], a[184:187], v[248:251], v[64:67]
ds_read_b64_tr_b16 a[160:161], v3 offset:12544
v_mfma_f32_16x16x32_bf16 v[64:67], a[188:191], a[144:147], v[64:67]
ds_read_b64_tr_b16 a[162:163], v3 offset:14592
v_mfma_f32_16x16x32_bf16 v[64:67], a[192:195], a[152:155], v[64:67]
ds_read_b64_tr_b16 a[164:165], v3 offset:16640
v_mfma_f32_16x16x32_bf16 v[68:71], a[184:187], v[252:255], v[68:71]
ds_read_b64_tr_b16 a[166:167], v3 offset:18688
v_mfma_f32_16x16x32_bf16 v[68:71], a[188:191], a[148:151], v[68:71]
buffer_load_dwordx4 v11, s[12:15], s41 offen offset:2048  lds
v_mfma_f32_16x16x32_bf16 v[68:71], a[192:195], a[156:159], v[68:71]
s_waitcnt lgkmcnt(4)
ds_read_b64_tr_b16 a[168:169], v3 offset:20736
ds_read_b64_tr_b16 a[170:171], v3 offset:22784
v_mfma_f32_16x16x32_bf16 v[72:75], a[196:199], v[200:203], v[72:75]
s_add_u32 s41, s25, 0x36000
ds_read_b64_tr_b16 a[172:173], v3 offset:24832
v_mfma_f32_16x16x32_bf16 v[72:75], a[200:203], v[208:211], v[72:75]
ds_read_b64_tr_b16 a[174:175], v3 offset:26880
v_mfma_f32_16x16x32_bf16 v[72:75], a[204:207], v[216:219], v[72:75]
s_add_u32 m0, s36, 3072
ds_read_b64_tr_b16 a[176:177], v3 offset:28928
v_mfma_f32_16x16x32_bf16 v[76:79], a[196:199], v[204:207], v[76:79]
ds_read_b64_tr_b16 a[178:179], v3 offset:30976
v_mul_f32 v32, v64, v64
v_mfma_f32_16x16x32_bf16 v[76:79], a[200:203], v[212:215], v[76:79]
ds_read_b64_tr_b16 a[180:181], v3 offset:33024
v_mul_f32 v33, v65, v65
v_mfma_f32_16x16x32_bf16 v[76:79], a[204:207], v[220:223], v[76:79]
s_waitcnt lgkmcnt(5)
buffer_load_dwordx4 v9, s[12:15], s41 offen offset:0  lds
v_mfma_f32_16x16x32_bf16 v[72:75], a[160:163], v[224:227], v[72:75]
ds_read_b64_tr_b16 a[182:183], v3 offset:35072
ds_read_b64_tr_b16 a[184:185], v3 offset:512
v_mfma_f32_16x16x32_bf16 v[72:75], a[164:167], v[232:235], v[72:75]
ds_read_b64_tr_b16 a[186:187], v3 offset:2560
v_mul_f32 v34, v66, v66
v_mfma_f32_16x16x32_bf16 v[72:75], a[168:171], v[240:243], v[72:75]
ds_read_b64_tr_b16 a[188:189], v3 offset:4608
v_mul_f32 v35, v67, v67
v_mfma_f32_16x16x32_bf16 v[76:79], a[160:163], v[228:231], v[76:79]
ds_read_b64_tr_b16 a[190:191], v3 offset:6656
v_fma_f32 v32, v32, v26, v24
v_mfma_f32_16x16x32_bf16 v[76:79], a[164:167], v[236:239], v[76:79]
ds_read_b64_tr_b16 a[192:193], v3 offset:8704
v_fma_f32 v33, v33, v26, v24
v_mfma_f32_16x16x32_bf16 v[76:79], a[168:171], v[244:247], v[76:79]
s_waitcnt lgkmcnt(5)
ds_read_b64_tr_b16 a[194:195], v3 offset:10752
v_fma_f32 v34, v34, v26, v24
v_mfma_f32_16x16x32_bf16 v[72:75], a[172:175], v[248:251], v[72:75]
buffer_load_dwordx4 v10, s[12:15], s41 offen offset:1024  lds
v_mfma_f32_16x16x32_bf16 v[72:75], a[176:179], a[144:147], v[72:75]
ds_read_b64_tr_b16 a[196:197], v3 offset:12800
ds_read_b64_tr_b16 a[198:199], v3 offset:14848
v_mfma_f32_16x16x32_bf16 v[72:75], a[180:183], a[152:155], v[72:75]
ds_read_b64_tr_b16 a[200:201], v3 offset:16896
v_fma_f32 v35, v35, v26, v24
v_mfma_f32_16x16x32_bf16 v[76:79], a[172:175], v[252:255], v[76:79]
ds_read_b64_tr_b16 a[202:203], v3 offset:18944
v_mul_f32 v32, v64, v32
v_mfma_f32_16x16x32_bf16 v[76:79], a[176:179], a[148:151], v[76:79]
ds_read_b64_tr_b16 a[204:205], v3 offset:20992
v_mul_f32 v33, v65, v33
v_mfma_f32_16x16x32_bf16 v[76:79], a[180:183], a[156:159], v[76:79]
s_waitcnt lgkmcnt(5)
ds_read_b64_tr_b16 a[206:207], v3 offset:23040
v_mul_f32 v34, v66, v34
v_mfma_f32_16x16x32_bf16 v[80:83], a[184:187], v[200:203], v[80:83]
ds_read_b64_tr_b16 a[160:161], v3 offset:25088
v_mul_f32 v35, v67, v35
v_mfma_f32_16x16x32_bf16 v[80:83], a[188:191], v[208:211], v[80:83]
buffer_load_dwordx4 v11, s[12:15], s41 offen offset:2048  lds
v_mfma_f32_16x16x32_bf16 v[80:83], a[192:195], v[216:219], v[80:83]
ds_read_b64_tr_b16 a[162:163], v3 offset:27136
ds_read_b64_tr_b16 a[164:165], v3 offset:29184
v_mfma_f32_16x16x32_bf16 v[84:87], a[184:187], v[204:207], v[84:87]
s_add_u32 s41, s25, 0x6c000
ds_read_b64_tr_b16 a[166:167], v3 offset:31232
v_mul_f32 v36, v72, v72
v_mfma_f32_16x16x32_bf16 v[84:87], a[188:191], v[212:215], v[84:87]
ds_read_b64_tr_b16 a[168:169], v3 offset:33280
v_mul_f32 v37, v73, v73
v_mfma_f32_16x16x32_bf16 v[84:87], a[192:195], v[220:223], v[84:87]
s_waitcnt lgkmcnt(5)
ds_read_b64_tr_b16 a[170:171], v3 offset:35328
v_mul_f32 v38, v74, v74
v_mfma_f32_16x16x32_bf16 v[80:83], a[196:199], v[224:227], v[80:83]
s_add_u32 m0, s36, 6144
ds_read_b64_tr_b16 a[172:173], v3 offset:768
v_mul_f32 v39, v75, v75
v_mfma_f32_16x16x32_bf16 v[80:83], a[200:203], v[232:235], v[80:83]
ds_read_b64_tr_b16 a[174:175], v3 offset:2816
v_fma_f32 v36, v36, v26, v24
v_mfma_f32_16x16x32_bf16 v[80:83], a[204:207], v[240:243], v[80:83]
buffer_load_dwordx4 v9, s[12:15], s41 offen offset:0  lds
v_mfma_f32_16x16x32_bf16 v[84:87], a[196:199], v[228:231], v[84:87]
ds_read_b64_tr_b16 a[176:177], v3 offset:4864
ds_read_b64_tr_b16 a[178:179], v3 offset:6912
v_mfma_f32_16x16x32_bf16 v[84:87], a[200:203], v[236:239], v[84:87]
s_add_u32 s97, s97, 1
ds_read_b64_tr_b16 a[180:181], v3 offset:8960
v_fma_f32 v37, v37, v26, v24
v_mfma_f32_16x16x32_bf16 v[84:87], a[204:207], v[244:247], v[84:87]
s_waitcnt lgkmcnt(5)
ds_read_b64_tr_b16 a[182:183], v3 offset:11008
v_fma_f32 v38, v38, v26, v24
v_mfma_f32_16x16x32_bf16 v[80:83], a[160:163], v[248:251], v[80:83]
s_and_b32 s97, s97, 3
ds_read_b64_tr_b16 a[184:185], v3 offset:13056
v_fma_f32 v39, v39, v26, v24
s_mul_i32 s39, s97, 36864
v_mfma_f32_16x16x32_bf16 v[80:83], a[164:167], a[144:147], v[80:83]
ds_read_b64_tr_b16 a[186:187], v3 offset:15104
v_mul_f32 v36, v72, v36
v_mfma_f32_16x16x32_bf16 v[80:83], a[168:171], a[152:155], v[80:83]
ds_read_b64_tr_b16 a[188:189], v3 offset:17152
v_mul_f32 v37, v73, v37
v_mfma_f32_16x16x32_bf16 v[84:87], a[160:163], v[252:255], v[84:87]
buffer_load_dwordx4 v10, s[12:15], s41 offen offset:1024  lds
v_mfma_f32_16x16x32_bf16 v[84:87], a[164:167], a[148:151], v[84:87]
ds_read_b64_tr_b16 a[190:191], v3 offset:19200
ds_read_b64_tr_b16 a[192:193], v3 offset:21248
v_mfma_f32_16x16x32_bf16 v[84:87], a[168:171], a[156:159], v[84:87]
s_waitcnt lgkmcnt(5)
ds_read_b64_tr_b16 a[194:195], v3 offset:23296
v_mul_f32 v38, v74, v38
v_exp_f32 v32, v32
v_mfma_f32_16x16x32_bf16 v[88:91], a[172:175], v[200:203], v[88:91]
ds_read_b64_tr_b16 a[196:197], v3 offset:25344
v_mul_f32 v39, v75, v39
v_exp_f32 v33, v33
v_mfma_f32_16x16x32_bf16 v[88:91], a[176:179], v[208:211], v[88:91]
ds_read_b64_tr_b16 a[198:199], v3 offset:27392
v_exp_f32 v34, v34
v_mfma_f32_16x16x32_bf16 v[88:91], a[180:183], v[216:219], v[88:91]
ds_read_b64_tr_b16 a[200:201], v3 offset:29440
v_exp_f32 v35, v35
v_mfma_f32_16x16x32_bf16 v[92:95], a[172:175], v[204:207], v[92:95]
ds_read_b64_tr_b16 a[202:203], v3 offset:31488
v_fma_f32 v32, v32, v28, v28
v_fma_f32 v33, v33, v28, v28
v_mfma_f32_16x16x32_bf16 v[92:95], a[176:179], v[212:215], v[92:95]
s_waitcnt vmcnt(8)
buffer_load_dwordx4 v11, s[12:15], s41 offen offset:2048  lds
s_barrier
v_mfma_f32_16x16x32_bf16 v[92:95], a[180:183], v[220:223], v[92:95]
s_waitcnt lgkmcnt(4)
ds_read_b64_tr_b16 a[204:205], v3 offset:33536
ds_read_b64_tr_b16 a[206:207], v3 offset:35584
v_add_u32 v3, s39, v7
v_add_u32 v4, s39, v8
v_mfma_f32_16x16x32_bf16 v[88:91], a[184:187], v[224:227], v[88:91]
s_add_u32 s96, s96, 1
ds_read_b64_tr_b16 a[160:161], v3 offset:0
v_fma_f32 v34, v34, v28, v28
v_fma_f32 v35, v35, v28, v28
v_mfma_f32_16x16x32_bf16 v[88:91], a[188:191], v[232:235], v[88:91]
s_and_b32 s96, s96, 3
ds_read_b64_tr_b16 a[162:163], v3 offset:9216
v_mov_b32 v31, s45
buffer_store_dword v31, off, s[20:23], s43 sc1
v_mfma_f32_16x16x32_bf16 v[88:91], a[192:195], v[240:243], v[88:91]
s_mul_i32 s36, s96, 36864
ds_read_b64_tr_b16 a[164:165], v3 offset:18432
v_rcp_f32 v32, v32
s_add_u32 s36, s36, s38
v_mfma_f32_16x16x32_bf16 v[92:95], a[184:187], v[228:231], v[92:95]
ds_read_b64_tr_b16 a[166:167], v3 offset:27648
v_rcp_f32 v33, v33
v_mfma_f32_16x16x32_bf16 v[92:95], a[188:191], v[236:239], v[92:95]
ds_read_b64_tr_b16 a[168:169], v4 offset:128
v_rcp_f32 v34, v34
v_mfma_f32_16x16x32_bf16 v[92:95], a[192:195], v[244:247], v[92:95]
s_waitcnt lgkmcnt(5)
ds_read_b64_tr_b16 a[170:171], v4 offset:9344
v_rcp_f32 v35, v35
v_mfma_f32_16x16x32_bf16 v[88:91], a[196:199], v[248:251], v[88:91]
ds_read_b64_tr_b16 a[172:173], v4 offset:18560
v_mul_f32 v64, v64, v32
v_mul_f32 v65, v65, v33
v_mfma_f32_16x16x32_bf16 v[88:91], a[200:203], a[144:147], v[88:91]
ds_read_b64_tr_b16 a[174:175], v4 offset:27776
v_mul_f32 v66, v66, v34
v_mfma_f32_16x16x32_bf16 v[88:91], a[204:207], a[152:155], v[88:91]
ds_read_b64_tr_b16 a[176:177], v3 offset:256
v_mul_f32 v67, v67, v35
v_mfma_f32_16x16x32_bf16 v[92:95], a[196:199], v[252:255], v[92:95]
s_mov_b32 s41, s100
ds_read_b64_tr_b16 a[178:179], v3 offset:9472
v_mul_f32 v32, v68, v68
v_mul_f32 v33, v69, v69
v_mfma_f32_16x16x32_bf16 v[92:95], a[200:203], a[148:151], v[92:95]
s_add_u32 s45, s45, 1
ds_read_b64_tr_b16 a[180:181], v3 offset:18688
v_mul_f32 v34, v70, v70
v_mfma_f32_16x16x32_bf16 v[92:95], a[204:207], a[156:159], v[92:95]
s_waitcnt lgkmcnt(3)
ds_read_b64_tr_b16 a[182:183], v3 offset:27904
v_mul_f32 v35, v71, v71
v_mfma_f32_16x16x32_bf16 a[0:3], a[160:163], v[40:43], a[0:3]
s_mov_b32 m0, s36
ds_read_b64_tr_b16 a[184:185], v4 offset:384
v_fma_f32 v32, v32, v27, v25
s_add_u32 s33, s33, 4096
v_mfma_f32_16x16x32_bf16 a[0:3], a[164:167], v[48:51], a[0:3]
s_add_u32 s27, s27, 73728
ds_read_b64_tr_b16 a[186:187], v4 offset:9600
v_fma_f32 v33, v33, v27, v25
v_mfma_f32_16x16x32_bf16 a[4:7], a[160:163], v[44:47], a[4:7]
buffer_load_dwordx4 v9, s[12:15], s41 offen offset:0  lds
v_fma_f32 v34, v34, v27, v25
v_mfma_f32_16x16x32_bf16 a[4:7], a[164:167], v[52:55], a[4:7]
ds_read_b64_tr_b16 a[188:189], v4 offset:18816
ds_read_b64_tr_b16 a[190:191], v4 offset:28032
v_fma_f32 v35, v35, v27, v25
v_mfma_f32_16x16x32_bf16 a[8:11], a[168:171], v[40:43], a[8:11]
ds_read_b64_tr_b16 a[192:193], v3 offset:512
v_mul_f32 v32, v68, v32
v_mfma_f32_16x16x32_bf16 a[8:11], a[172:175], v[48:51], a[8:11]
ds_read_b64_tr_b16 a[194:195], v3 offset:9728
v_mul_f32 v33, v69, v33
v_mfma_f32_16x16x32_bf16 a[12:15], a[168:171], v[44:47], a[12:15]
ds_read_b64_tr_b16 a[196:197], v3 offset:18944
v_mul_f32 v34, v70, v34
v_mfma_f32_16x16x32_bf16 a[12:15], a[172:175], v[52:55], a[12:15]
s_waitcnt lgkmcnt(3)
ds_read_b64_tr_b16 a[198:199], v3 offset:28160
v_mul_f32 v35, v71, v35
v_mfma_f32_16x16x32_bf16 a[16:19], a[176:179], v[40:43], a[16:19]
ds_read_b64_tr_b16 a[200:201], v4 offset:640
v_exp_f32 v32, v32
v_mfma_f32_16x16x32_bf16 a[16:19], a[180:183], v[48:51], a[16:19]
buffer_load_dwordx4 v10, s[12:15], s41 offen offset:1024  lds
v_mfma_f32_16x16x32_bf16 a[20:23], a[176:179], v[44:47], a[20:23]
ds_read_b64_tr_b16 a[202:203], v4 offset:9856
ds_read_b64_tr_b16 a[204:205], v4 offset:19072
v_mfma_f32_16x16x32_bf16 a[20:23], a[180:183], v[52:55], a[20:23]
ds_read_b64_tr_b16 a[206:207], v4 offset:28288
v_exp_f32 v33, v33
v_mfma_f32_16x16x32_bf16 a[24:27], a[184:187], v[40:43], a[24:27]
ds_read_b64_tr_b16 a[160:161], v3 offset:768
v_exp_f32 v34, v34
v_mfma_f32_16x16x32_bf16 a[24:27], a[188:191], v[48:51], a[24:27]
ds_read_b64_tr_b16 a[162:163], v3 offset:9984
v_exp_f32 v35, v35
v_mfma_f32_16x16x32_bf16 a[28:31], a[184:187], v[44:47], a[28:31]
ds_read_b64_tr_b16 a[164:165], v3 offset:19200
v_fma_f32 v32, v32, v29, v29
v_mfma_f32_16x16x32_bf16 a[28:31], a[188:191], v[52:55], a[28:31]
s_waitcnt lgkmcnt(3)
ds_read_b64_tr_b16 a[166:167], v3 offset:28416
v_fma_f32 v33, v33, v29, v29
v_mfma_f32_16x16x32_bf16 a[32:35], a[192:195], v[40:43], a[32:35]
buffer_load_dwordx4 v11, s[12:15], s41 offen offset:2048  lds
v_mfma_f32_16x16x32_bf16 a[32:35], a[196:199], v[48:51], a[32:35]
ds_read_b64_tr_b16 a[168:169], v4 offset:896
ds_read_b64_tr_b16 a[170:171], v4 offset:10112
v_fma_f32 v34, v34, v29, v29
v_mfma_f32_16x16x32_bf16 a[36:39], a[192:195], v[44:47], a[36:39]
s_add_u32 s41, s100, 0x36000
ds_read_b64_tr_b16 a[172:173], v4 offset:19328
v_fma_f32 v35, v35, v29, v29
v_mfma_f32_16x16x32_bf16 a[36:39], a[196:199], v[52:55], a[36:39]
ds_read_b64_tr_b16 a[174:175], v4 offset:28544
v_exp_f32 v36, v36
v_mfma_f32_16x16x32_bf16 a[40:43], a[200:203], v[40:43], a[40:43]
s_add_u32 m0, s36, 3072
ds_read_b64_tr_b16 a[176:177], v3 offset:1024
v_rcp_f32 v32, v32
v_mfma_f32_16x16x32_bf16 a[40:43], a[204:207], v[48:51], a[40:43]
ds_read_b64_tr_b16 a[178:179], v3 offset:10240
v_exp_f32 v37, v37
v_mfma_f32_16x16x32_bf16 a[44:47], a[200:203], v[44:47], a[44:47]
ds_read_b64_tr_b16 a[180:181], v3 offset:19456
v_rcp_f32 v33, v33
v_mfma_f32_16x16x32_bf16 a[44:47], a[204:207], v[52:55], a[44:47]
s_waitcnt lgkmcnt(3)
buffer_load_dwordx4 v9, s[12:15], s41 offen offset:0  lds
v_mfma_f32_16x16x32_bf16 a[48:51], a[160:163], v[40:43], a[48:51]
ds_read_b64_tr_b16 a[182:183], v3 offset:28672
ds_read_b64_tr_b16 a[184:185], v4 offset:1152
v_mfma_f32_16x16x32_bf16 a[48:51], a[164:167], v[48:51], a[48:51]
ds_read_b64_tr_b16 a[186:187], v4 offset:10368
v_exp_f32 v38, v38
v_mfma_f32_16x16x32_bf16 a[52:55], a[160:163], v[44:47], a[52:55]
ds_read_b64_tr_b16 a[188:189], v4 offset:19584
v_rcp_f32 v34, v34
v_mfma_f32_16x16x32_bf16 a[52:55], a[164:167], v[52:55], a[52:55]
ds_read_b64_tr_b16 a[190:191], v4 offset:28800
v_exp_f32 v39, v39
v_mfma_f32_16x16x32_bf16 a[56:59], a[168:171], v[40:43], a[56:59]
ds_read_b64_tr_b16 a[192:193], v3 offset:1280
v_fma_f32 v36, v36, v28, v28
v_fma_f32 v37, v37, v28, v28
v_mfma_f32_16x16x32_bf16 a[56:59], a[172:175], v[48:51], a[56:59]
ds_read_b64_tr_b16 a[194:195], v3 offset:10496
v_fma_f32 v38, v38, v28, v28
v_fma_f32 v39, v39, v28, v28
v_mfma_f32_16x16x32_bf16 a[60:63], a[168:171], v[44:47], a[60:63]
buffer_load_dwordx4 v10, s[12:15], s41 offen offset:1024  lds
v_rcp_f32 v35, v35
v_mfma_f32_16x16x32_bf16 a[60:63], a[172:175], v[52:55], a[60:63]
s_waitcnt lgkmcnt(2)
ds_read_b64_tr_b16 a[196:197], v3 offset:19712
ds_read_b64_tr_b16 a[198:199], v3 offset:28928
v_mul_f32 v68, v68, v32
v_mfma_f32_16x16x32_bf16 a[64:67], a[176:179], v[40:43], a[64:67]
ds_read_b64_tr_b16 a[200:201], v4 offset:1408
v_mul_f32 v69, v69, v33
v_mul_f32 v70, v70, v34
v_mfma_f32_16x16x32_bf16 a[64:67], a[180:183], v[48:51], a[64:67]
ds_read_b64_tr_b16 a[202:203], v4 offset:10624
v_mul_f32 v71, v71, v35
v_mfma_f32_16x16x32_bf16 a[68:71], a[176:179], v[44:47], a[68:71]
ds_read_b64_tr_b16 a[204:205], v4 offset:19840
v_rcp_f32 v36, v36
v_mfma_f32_16x16x32_bf16 a[68:71], a[180:183], v[52:55], a[68:71]
ds_read_b64_tr_b16 a[206:207], v4 offset:29056
v_rcp_f32 v37, v37
v_mfma_f32_16x16x32_bf16 a[72:75], a[184:187], v[40:43], a[72:75]
ds_read_b64_tr_b16 a[160:161], v3 offset:1536
v_rcp_f32 v38, v38
v_mfma_f32_16x16x32_bf16 a[72:75], a[188:191], v[48:51], a[72:75]
buffer_load_dwordx4 v11, s[12:15], s41 offen offset:2048  lds
v_mfma_f32_16x16x32_bf16 a[76:79], a[184:187], v[44:47], a[76:79]
ds_read_b64_tr_b16 a[162:163], v3 offset:10752
ds_read_b64_tr_b16 a[164:165], v3 offset:19968
v_mfma_f32_16x16x32_bf16 a[76:79], a[188:191], v[52:55], a[76:79]
s_waitcnt lgkmcnt(3)
ds_read_b64_tr_b16 a[166:167], v3 offset:29184
v_rcp_f32 v39, v39
v_mfma_f32_16x16x32_bf16 a[80:83], a[192:195], v[40:43], a[80:83]
s_add_u32 s41, s100, 0x6c000
ds_read_b64_tr_b16 a[168:169], v4 offset:1664
v_mul_f32 v72, v72, v36
v_mul_f32 v73, v73, v37
v_mfma_f32_16x16x32_bf16 a[80:83], a[196:199], v[48:51], a[80:83]
s_add_u32 m0, s36, 6144
ds_read_b64_tr_b16 a[170:171], v4 offset:10880
v_mul_f32 v74, v74, v38
v_mul_f32 v75, v75, v39
v_mfma_f32_16x16x32_bf16 a[84:87], a[192:195], v[44:47], a[84:87]
ds_read_b64_tr_b16 a[172:173], v4 offset:20096
v_mul_f32 v36, v76, v76
v_mul_f32 v37, v77, v77
v_mfma_f32_16x16x32_bf16 a[84:87], a[196:199], v[52:55], a[84:87]
ds_read_b64_tr_b16 a[174:175], v4 offset:29312
v_mul_f32 v38, v78, v78
v_mul_f32 v39, v79, v79
v_mfma_f32_16x16x32_bf16 a[88:91], a[200:203], v[40:43], a[88:91]
buffer_load_dwordx4 v9, s[12:15], s41 offen offset:0  lds
v_fma_f32 v36, v36, v27, v25
v_mfma_f32_16x16x32_bf16 a[88:91], a[204:207], v[48:51], a[88:91]
ds_read_b64_tr_b16 a[176:177], v3 offset:1792
ds_read_b64_tr_b16 a[178:179], v3 offset:11008
v_fma_f32 v37, v37, v27, v25
v_mfma_f32_16x16x32_bf16 a[92:95], a[200:203], v[44:47], a[92:95]
s_add_u32 s97, s97, 1
ds_read_b64_tr_b16 a[180:181], v3 offset:20224
v_fma_f32 v38, v38, v27, v25
v_fma_f32 v39, v39, v27, v25
v_mfma_f32_16x16x32_bf16 a[92:95], a[204:207], v[52:55], a[92:95]
s_waitcnt lgkmcnt(3)
ds_read_b64_tr_b16 a[182:183], v3 offset:29440
v_mul_f32 v36, v76, v36
v_mul_f32 v37, v77, v37
v_mfma_f32_16x16x32_bf16 a[96:99], a[160:163], v[40:43], a[96:99]
s_and_b32 s97, s97, 3
ds_read_b64_tr_b16 a[184:185], v4 offset:1920
v_mul_f32 v38, v78, v38
v_mul_f32 v39, v79, v39
s_mul_i32 s39, s97, 36864
v_mfma_f32_16x16x32_bf16 a[96:99], a[164:167], v[48:51], a[96:99]
ds_read_b64_tr_b16 a[186:187], v4 offset:11136
v_exp_f32 v36, v36
v_mfma_f32_16x16x32_bf16 a[100:103], a[160:163], v[44:47], a[100:103]
ds_read_b64_tr_b16 a[188:189], v4 offset:20352
v_mfma_f32_16x16x32_bf16 a[100:103], a[164:167], v[52:55], a[100:103]
buffer_load_dwordx4 v10, s[12:15], s41 offen offset:1024  lds
v_mfma_f32_16x16x32_bf16 a[104:107], a[168:171], v[40:43], a[104:107]
ds_read_b64_tr_b16 a[190:191], v4 offset:29568
ds_read_b64_tr_b16 a[192:193], v3 offset:2048
v_mfma_f32_16x16x32_bf16 a[104:107], a[172:175], v[48:51], a[104:107]
ds_read_b64_tr_b16 a[194:195], v3 offset:11264
v_exp_f32 v37, v37
v_mfma_f32_16x16x32_bf16 a[108:111], a[168:171], v[44:47], a[108:111]
ds_read_b64_tr_b16 a[196:197], v3 offset:20480
v_exp_f32 v38, v38
v_mfma_f32_16x16x32_bf16 a[108:111], a[172:175], v[52:55], a[108:111]
s_waitcnt lgkmcnt(3)
ds_read_b64_tr_b16 a[198:199], v3 offset:29696
v_exp_f32 v39, v39
v_mfma_f32_16x16x32_bf16 a[112:115], a[176:179], v[40:43], a[112:115]
ds_read_b64_tr_b16 a[200:201], v4 offset:2176
v_fma_f32 v36, v36, v29, v29
v_mfma_f32_16x16x32_bf16 a[112:115], a[180:183], v[48:51], a[112:115]
ds_read_b64_tr_b16 a[202:203], v4 offset:11392
v_fma_f32 v37, v37, v29, v29
v_mfma_f32_16x16x32_bf16 a[116:119], a[176:179], v[44:47], a[116:119]
s_waitcnt vmcnt(9)
buffer_load_dwordx4 v11, s[12:15], s41 offen offset:2048  lds
s_barrier
v_mfma_f32_16x16x32_bf16 a[116:119], a[180:183], v[52:55], a[116:119]
s_add_u32 s96, s96, 1
ds_read_b64_tr_b16 a[204:205], v4 offset:20608
ds_read_b64_tr_b16 a[206:207], v4 offset:29824
v_add_u32 v3, s39, v5
v_mfma_f32_16x16x32_bf16 a[120:123], a[184:187], v[40:43], a[120:123]
s_and_b32 s96, s96, 3
ds_read_b64_tr_b16 a[160:161], v3 offset:0
v_fma_f32 v38, v38, v29, v29
v_fma_f32 v39, v39, v29, v29
v_mfma_f32_16x16x32_bf16 a[120:123], a[188:191], v[48:51], a[120:123]
s_mul_i32 s36, s96, 36864
ds_read_b64_tr_b16 a[162:163], v3 offset:2048
v_rcp_f32 v36, v36
s_add_u32 s36, s36, s38
v_mfma_f32_16x16x32_bf16 a[124:127], a[184:187], v[44:47], a[124:127]
ds_read_b64_tr_b16 a[164:165], v3 offset:4096
v_rcp_f32 v37, v37
v_mfma_f32_16x16x32_bf16 a[124:127], a[188:191], v[52:55], a[124:127]
s_waitcnt lgkmcnt(3)
ds_read_b64_tr_b16 a[166:167], v3 offset:6144
v_rcp_f32 v38, v38
v_mfma_f32_16x16x32_bf16 a[128:131], a[192:195], v[40:43], a[128:131]
ds_read_b64_tr_b16 a[168:169], v3 offset:8192
v_mfma_f32_16x16x32_bf16 a[128:131], a[196:199], v[48:51], a[128:131]
ds_read_b64_tr_b16 a[170:171], v3 offset:10240
v_rcp_f32 v39, v39
v_mfma_f32_16x16x32_bf16 a[132:135], a[192:195], v[44:47], a[132:135]
ds_read_b64_tr_b16 a[172:173], v3 offset:12288
v_mul_f32 v76, v76, v36
v_mfma_f32_16x16x32_bf16 a[132:135], a[196:199], v[52:55], a[132:135]
ds_read_b64_tr_b16 a[174:175], v3 offset:14336
v_mul_f32 v77, v77, v37
v_mfma_f32_16x16x32_bf16 a[136:139], a[200:203], v[40:43], a[136:139]
ds_read_b64_tr_b16 a[176:177], v3 offset:16384
v_mul_f32 v78, v78, v38
v_mfma_f32_16x16x32_bf16 a[136:139], a[204:207], v[48:51], a[136:139]
ds_read_b64_tr_b16 a[178:179], v3 offset:18432
v_mul_f32 v79, v79, v39
v_mfma_f32_16x16x32_bf16 a[140:143], a[200:203], v[44:47], a[140:143]
ds_read_b64_tr_b16 a[180:181], v3 offset:20480
v_mfma_f32_16x16x32_bf16 a[140:143], a[204:207], v[52:55], a[140:143]
ds_read_b64_tr_b16 a[182:183], v3 offset:22528
s_add_u32 s25, s25, 128
s_add_u32 s100, s100, 128
s_sub_u32 s40, s40, 1
s_cmp_lg_u32 s40, 0
s_cbranch_scc1 L_sequential_preLN__sliding_local_dilated__glu_gated_geglu__prompt_kernel_loop
L_sequential_preLN__sliding_local_dilated__glu_gated_geglu__prompt_kernel_tail:
s_waitcnt lgkmcnt(6)
v_mfma_f32_16x16x32_bf16 v[96:99], a[160:163], v[128:131], 0
s_mov_b32 s41, s26
ds_read_b64_tr_b16 a[184:185], v3 offset:24576
v_mul_f32 v32, v80, v80
v_mfma_f32_16x16x32_bf16 v[96:99], a[164:167], v[136:139], v[96:99]
s_mov_b32 m0, s36
ds_read_b64_tr_b16 a[186:187], v3 offset:26624
v_mul_f32 v33, v81, v81
v_mfma_f32_16x16x32_bf16 v[96:99], a[168:171], v[144:147], v[96:99]
buffer_load_dwordx4 v12, s[8:11], s41 offen offset:0  lds
v_mfma_f32_16x16x32_bf16 v[100:103], a[160:163], v[132:135], 0
ds_read_b64_tr_b16 a[188:189], v3 offset:28672
ds_read_b64_tr_b16 a[190:191], v3 offset:30720
v_mfma_f32_16x16x32_bf16 v[100:103], a[164:167], v[140:143], v[100:103]
ds_read_b64_tr_b16 a[192:193], v3 offset:32768
v_mul_f32 v34, v82, v82
v_mfma_f32_16x16x32_bf16 v[100:103], a[168:171], v[148:151], v[100:103]
s_waitcnt lgkmcnt(5)
ds_read_b64_tr_b16 a[194:195], v3 offset:34816
v_mul_f32 v35, v83, v83
v_mfma_f32_16x16x32_bf16 v[96:99], a[172:175], v[152:155], v[96:99]
ds_read_b64_tr_b16 a[196:197], v3 offset:256
v_fma_f32 v32, v32, v26, v24
v_mfma_f32_16x16x32_bf16 v[96:99], a[176:179], v[160:163], v[96:99]
ds_read_b64_tr_b16 a[198:199], v3 offset:2304
v_fma_f32 v33, v33, v26, v24
v_mfma_f32_16x16x32_bf16 v[96:99], a[180:183], v[168:171], v[96:99]
ds_read_b64_tr_b16 a[200:201], v3 offset:4352
v_fma_f32 v34, v34, v26, v24
v_mfma_f32_16x16x32_bf16 v[100:103], a[172:175], v[156:159], v[100:103]
buffer_load_dwordx4 v13, s[8:11], s41 offen offset:1024  lds
v_mfma_f32_16x16x32_bf16 v[100:103], a[176:179], v[164:167], v[100:103]
ds_read_b64_tr_b16 a[202:203], v3 offset:6400
ds_read_b64_tr_b16 a[204:205], v3 offset:8448
v_mfma_f32_16x16x32_bf16 v[100:103], a[180:183], v[172:175], v[100:103]
s_waitcnt lgkmcnt(5)
ds_read_b64_tr_b16 a[206:207], v3 offset:10496
v_fma_f32 v35, v35, v26, v24
v_mfma_f32_16x16x32_bf16 v[96:99], a[184:187], v[176:179], v[96:99]
ds_read_b64_tr_b16 a[160:161], v3 offset:12544
v_mul_f32 v32, v80, v32
v_mfma_f32_16x16x32_bf16 v[96:99], a[188:191], v[184:187], v[96:99]
ds_read_b64_tr_b16 a[162:163], v3 offset:14592
v_mul_f32 v33, v81, v33
v_mfma_f32_16x16x32_bf16 v[96:99], a[192:195], v[192:195], v[96:99]
ds_read_b64_tr_b16 a[164:165], v3 offset:16640
v_mul_f32 v34, v82, v34
v_mfma_f32_16x16x32_bf16 v[100:103], a[184:187], v[180:183], v[100:103]
ds_read_b64_tr_b16 a[166:167], v3 offset:18688
v_mul_f32 v35, v83, v35
v_mfma_f32_16x16x32_bf16 v[100:103], a[188:191], v[188:191], v[100:103]
buffer_load_dwordx4 v14, s[8:11], s41 offen offset:2048  lds
v_mfma_f32_16x16x32_bf16 v[100:103], a[192:195], v[196:199], v[100:103]
s_waitcnt lgkmcnt(4)
ds_read_b64_tr_b16 a[168:169], v3 offset:20736
ds_read_b64_tr_b16 a[170:171], v3 offset:22784
v_mfma_f32_16x16x32_bf16 v[104:107], a[196:199], v[128:131], 0
s_add_u32 s41, s26, 0x6c000
ds_read_b64_tr_b16 a[172:173], v3 offset:24832
v_mul_f32 v36, v88, v88
v_mfma_f32_16x16x32_bf16 v[104:107], a[200:203], v[136:139], v[104:107]
ds_read_b64_tr_b16 a[174:175], v3 offset:26880
v_mul_f32 v37, v89, v89
v_mfma_f32_16x16x32_bf16 v[104:107], a[204:207], v[144:147], v[104:107]
s_add_u32 m0, s36, 3072
ds_read_b64_tr_b16 a[176:177], v3 offset:28928
v_mul_f32 v38, v90, v90
v_mfma_f32_16x16x32_bf16 v[108:111], a[196:199], v[132:135], 0
ds_read_b64_tr_b16 a[178:179], v3 offset:30976
v_mul_f32 v39, v91, v91
v_mfma_f32_16x16x32_bf16 v[108:111], a[200:203], v[140:143], v[108:111]
ds_read_b64_tr_b16 a[180:181], v3 offset:33024
v_fma_f32 v36, v36, v26, v24
v_mfma_f32_16x16x32_bf16 v[108:111], a[204:207], v[148:151], v[108:111]
s_waitcnt lgkmcnt(5)
buffer_load_dwordx4 v12, s[8:11], s41 offen offset:0  lds
v_mfma_f32_16x16x32_bf16 v[104:107], a[160:163], v[152:155], v[104:107]
ds_read_b64_tr_b16 a[182:183], v3 offset:35072
ds_read_b64_tr_b16 a[184:185], v3 offset:512
v_mfma_f32_16x16x32_bf16 v[104:107], a[164:167], v[160:163], v[104:107]
ds_read_b64_tr_b16 a[186:187], v3 offset:2560
v_fma_f32 v37, v37, v26, v24
v_mfma_f32_16x16x32_bf16 v[104:107], a[168:171], v[168:171], v[104:107]
ds_read_b64_tr_b16 a[188:189], v3 offset:4608
v_fma_f32 v38, v38, v26, v24
v_mfma_f32_16x16x32_bf16 v[108:111], a[160:163], v[156:159], v[108:111]
ds_read_b64_tr_b16 a[190:191], v3 offset:6656
v_fma_f32 v39, v39, v26, v24
v_mfma_f32_16x16x32_bf16 v[108:111], a[164:167], v[164:167], v[108:111]
ds_read_b64_tr_b16 a[192:193], v3 offset:8704
v_mul_f32 v36, v88, v36
v_mfma_f32_16x16x32_bf16 v[108:111], a[168:171], v[172:175], v[108:111]
s_waitcnt lgkmcnt(5)
ds_read_b64_tr_b16 a[194:195], v3 offset:10752
v_mul_f32 v37, v89, v37
v_mfma_f32_16x16x32_bf16 v[104:107], a[172:175], v[176:179], v[104:107]
buffer_load_dwordx4 v13, s[8:11], s41 offen offset:1024  lds
v_mfma_f32_16x16x32_bf16 v[104:107], a[176:179], v[184:187], v[104:107]
ds_read_b64_tr_b16 a[196:197], v3 offset:12800
ds_read_b64_tr_b16 a[198:199], v3 offset:14848
v_mfma_f32_16x16x32_bf16 v[104:107], a[180:183], v[192:195], v[104:107]
ds_read_b64_tr_b16 a[200:201], v3 offset:16896
v_mul_f32 v38, v90, v38
v_mfma_f32_16x16x32_bf16 v[108:111], a[172:175], v[180:183], v[108:111]
ds_read_b64_tr_b16 a[202:203], v3 offset:18944
v_mul_f32 v39, v91, v39
v_mfma_f32_16x16x32_bf16 v[108:111], a[176:179], v[188:191], v[108:111]
ds_read_b64_tr_b16 a[204:205], v3 offset:20992
v_exp_f32 v32, v32
v_mfma_f32_16x16x32_bf16 v[108:111], a[180:183], v[196:199], v[108:111]
s_waitcnt lgkmcnt(5)
ds_read_b64_tr_b16 a[206:207], v3 offset:23040
v_exp_f32 v33, v33
v_mfma_f32_16x16x32_bf16 v[112:115], a[184:187], v[128:131], 0
ds_read_b64_tr_b16 a[160:161], v3 offset:25088
v_exp_f32 v34, v34
v_mfma_f32_16x16x32_bf16 v[112:115], a[188:191], v[136:139], v[112:115]
buffer_load_dwordx4 v14, s[8:11], s41 offen offset:2048  lds
v_mfma_f32_16x16x32_bf16 v[112:115], a[192:195], v[144:147], v[112:115]
ds_read_b64_tr_b16 a[162:163], v3 offset:27136
ds_read_b64_tr_b16 a[164:165], v3 offset:29184
v_mfma_f32_16x16x32_bf16 v[116:119], a[184:187], v[132:135], 0
s_add_u32 s41, s26, 0xd8000
ds_read_b64_tr_b16 a[166:167], v3 offset:31232
v_exp_f32 v35, v35
v_mfma_f32_16x16x32_bf16 v[116:119], a[188:191], v[140:143], v[116:119]
ds_read_b64_tr_b16 a[168:169], v3 offset:33280
v_fma_f32 v32, v32, v28, v28
v_fma_f32 v33, v33, v28, v28
v_mfma_f32_16x16x32_bf16 v[116:119], a[192:195], v[148:151], v[116:119]
s_waitcnt lgkmcnt(5)
ds_read_b64_tr_b16 a[170:171], v3 offset:35328
v_fma_f32 v34, v34, v28, v28
v_fma_f32 v35, v35, v28, v28
v_mfma_f32_16x16x32_bf16 v[112:115], a[196:199], v[152:155], v[112:115]
s_add_u32 m0, s36, 6144
ds_read_b64_tr_b16 a[172:173], v3 offset:768
v_rcp_f32 v32, v32
v_mfma_f32_16x16x32_bf16 v[112:115], a[200:203], v[160:163], v[112:115]
ds_read_b64_tr_b16 a[174:175], v3 offset:2816
v_rcp_f32 v33, v33
v_mfma_f32_16x16x32_bf16 v[112:115], a[204:207], v[168:171], v[112:115]
buffer_load_dwordx4 v12, s[8:11], s41 offen offset:0  lds
v_mfma_f32_16x16x32_bf16 v[116:119], a[196:199], v[156:159], v[116:119]
ds_read_b64_tr_b16 a[176:177], v3 offset:4864
ds_read_b64_tr_b16 a[178:179], v3 offset:6912
v_mfma_f32_16x16x32_bf16 v[116:119], a[200:203], v[164:167], v[116:119]
s_add_u32 s97, s97, 1
ds_read_b64_tr_b16 a[180:181], v3 offset:8960
v_rcp_f32 v34, v34
v_mfma_f32_16x16x32_bf16 v[116:119], a[204:207], v[172:175], v[116:119]
s_waitcnt lgkmcnt(5)
ds_read_b64_tr_b16 a[182:183], v3 offset:11008
v_rcp_f32 v35, v35
v_mfma_f32_16x16x32_bf16 v[112:115], a[160:163], v[176:179], v[112:115]
s_and_b32 s97, s97, 3
ds_read_b64_tr_b16 a[184:185], v3 offset:13056
v_mul_f32 v80, v80, v32
v_mul_f32 v81, v81, v33
s_mul_i32 s39, s97, 36864
v_mfma_f32_16x16x32_bf16 v[112:115], a[164:167], v[184:187], v[112:115]
ds_read_b64_tr_b16 a[186:187], v3 offset:15104
v_mul_f32 v82, v82, v34
v_mfma_f32_16x16x32_bf16 v[112:115], a[168:171], v[192:195], v[112:115]
ds_read_b64_tr_b16 a[188:189], v3 offset:17152
v_mul_f32 v83, v83, v35
v_mfma_f32_16x16x32_bf16 v[116:119], a[160:163], v[180:183], v[116:119]
buffer_load_dwordx4 v13, s[8:11], s41 offen offset:1024  lds
v_mul_f32 v32, v84, v84
v_mfma_f32_16x16x32_bf16 v[116:119], a[164:167], v[188:191], v[116:119]
ds_read_b64_tr_b16 a[190:191], v3 offset:19200
ds_read_b64_tr_b16 a[192:193], v3 offset:21248
v_mul_f32 v33, v85, v85
v_mfma_f32_16x16x32_bf16 v[116:119], a[168:171], v[196:199], v[116:119]
s_waitcnt lgkmcnt(5)
ds_read_b64_tr_b16 a[194:195], v3 offset:23296
v_mul_f32 v34, v86, v86
v_mfma_f32_16x16x32_bf16 v[120:123], a[172:175], v[128:131], 0
ds_read_b64_tr_b16 a[196:197], v3 offset:25344
v_mul_f32 v35, v87, v87
v_mfma_f32_16x16x32_bf16 v[120:123], a[176:179], v[136:139], v[120:123]
ds_read_b64_tr_b16 a[198:199], v3 offset:27392
v_fma_f32 v32, v32, v27, v25
v_mfma_f32_16x16x32_bf16 v[120:123], a[180:183], v[144:147], v[120:123]
ds_read_b64_tr_b16 a[200:201], v3 offset:29440
v_fma_f32 v33, v33, v27, v25
v_mfma_f32_16x16x32_bf16 v[124:127], a[172:175], v[132:135], 0
ds_read_b64_tr_b16 a[202:203], v3 offset:31488
v_fma_f32 v34, v34, v27, v25
v_mfma_f32_16x16x32_bf16 v[124:127], a[176:179], v[140:143], v[124:127]
s_waitcnt vmcnt(8)
buffer_load_dwordx4 v14, s[8:11], s41 offen offset:2048  lds
s_barrier
v_mfma_f32_16x16x32_bf16 v[124:127], a[180:183], v[148:151], v[124:127]
s_waitcnt lgkmcnt(4)
ds_read_b64_tr_b16 a[204:205], v3 offset:33536
ds_read_b64_tr_b16 a[206:207], v3 offset:35584
v_add_u32 v3, s39, v5
v_mfma_f32_16x16x32_bf16 v[120:123], a[184:187], v[152:155], v[120:123]
s_add_u32 s96, s96, 1
ds_read_b64_tr_b16 a[160:161], v3 offset:0
v_fma_f32 v35, v35, v27, v25
v_mul_f32 v32, v84, v32
v_mfma_f32_16x16x32_bf16 v[120:123], a[188:191], v[160:163], v[120:123]
s_and_b32 s96, s96, 3
ds_read_b64_tr_b16 a[162:163], v3 offset:2048
v_mul_f32 v33, v85, v33
v_mul_f32 v34, v86, v34
s_mul_i32 s36, s96, 36864
v_mfma_f32_16x16x32_bf16 v[120:123], a[192:195], v[168:171], v[120:123]
s_add_u32 s36, s36, s38
ds_read_b64_tr_b16 a[164:165], v3 offset:4096
v_mul_f32 v35, v87, v35
v_mfma_f32_16x16x32_bf16 v[124:127], a[184:187], v[156:159], v[124:127]
ds_read_b64_tr_b16 a[166:167], v3 offset:6144
v_exp_f32 v32, v32
v_mfma_f32_16x16x32_bf16 v[124:127], a[188:191], v[164:167], v[124:127]
ds_read_b64_tr_b16 a[168:169], v3 offset:8192
v_exp_f32 v33, v33
v_mfma_f32_16x16x32_bf16 v[124:127], a[192:195], v[172:175], v[124:127]
s_waitcnt lgkmcnt(5)
ds_read_b64_tr_b16 a[170:171], v3 offset:10240
v_mfma_f32_16x16x32_bf16 v[120:123], a[196:199], v[176:179], v[120:123]
ds_read_b64_tr_b16 a[172:173], v3 offset:12288
v_exp_f32 v34, v34
v_mfma_f32_16x16x32_bf16 v[120:123], a[200:203], v[184:187], v[120:123]
ds_read_b64_tr_b16 a[174:175], v3 offset:14336
v_exp_f32 v36, v36
v_mfma_f32_16x16x32_bf16 v[120:123], a[204:207], v[192:195], v[120:123]
ds_read_b64_tr_b16 a[176:177], v3 offset:16384
v_exp_f32 v35, v35
v_mfma_f32_16x16x32_bf16 v[124:127], a[196:199], v[180:183], v[124:127]
ds_read_b64_tr_b16 a[178:179], v3 offset:18432
v_fma_f32 v32, v32, v29, v29
v_mfma_f32_16x16x32_bf16 v[124:127], a[200:203], v[188:191], v[124:127]
ds_read_b64_tr_b16 a[180:181], v3 offset:20480
v_fma_f32 v33, v33, v29, v29
v_mfma_f32_16x16x32_bf16 v[124:127], a[204:207], v[196:199], v[124:127]
s_waitcnt lgkmcnt(5)
ds_read_b64_tr_b16 a[182:183], v3 offset:22528
v_fma_f32 v34, v34, v29, v29
v_mfma_f32_16x16x32_bf16 v[96:99], a[160:163], v[200:203], v[96:99]
s_mov_b32 m0, s36
ds_read_b64_tr_b16 a[184:185], v3 offset:24576
v_fma_f32 v35, v35, v29, v29
v_mfma_f32_16x16x32_bf16 v[96:99], a[164:167], v[208:211], v[96:99]
ds_read_b64_tr_b16 a[186:187], v3 offset:26624
v_exp_f32 v37, v37
v_mfma_f32_16x16x32_bf16 v[96:99], a[168:171], v[216:219], v[96:99]
buffer_load_dwordx4 v15, s[16:19], s27 offen  lds
v_mfma_f32_16x16x32_bf16 v[100:103], a[160:163], v[204:207], v[100:103]
ds_read_b64_tr_b16 a[188:189], v3 offset:28672
ds_read_b64_tr_b16 a[190:191], v3 offset:30720
v_mfma_f32_16x16x32_bf16 v[100:103], a[164:167], v[212:215], v[100:103]
ds_read_b64_tr_b16 a[192:193], v3 offset:32768
v_exp_f32 v38, v38
v_mfma_f32_16x16x32_bf16 v[100:103], a[168:171], v[220:223], v[100:103]
s_waitcnt lgkmcnt(5)
ds_read_b64_tr_b16 a[194:195], v3 offset:34816
v_rcp_f32 v32, v32
v_mfma_f32_16x16x32_bf16 v[96:99], a[172:175], v[224:227], v[96:99]
s_add_u32 m0, s36, 1024
ds_read_b64_tr_b16 a[196:197], v3 offset:256
v_rcp_f32 v33, v33
v_mfma_f32_16x16x32_bf16 v[96:99], a[176:179], v[232:235], v[96:99]
ds_read_b64_tr_b16 a[198:199], v3 offset:2304
v_exp_f32 v39, v39
v_mfma_f32_16x16x32_bf16 v[96:99], a[180:183], v[240:243], v[96:99]
ds_read_b64_tr_b16 a[200:201], v3 offset:4352
v_fma_f32 v36, v36, v28, v28
v_fma_f32 v37, v37, v28, v28
v_mfma_f32_16x16x32_bf16 v[100:103], a[172:175], v[228:231], v[100:103]
buffer_load_dwordx4 v16, s[16:19], s27 offen  lds
v_fma_f32 v38, v38, v28, v28
v_mfma_f32_16x16x32_bf16 v[100:103], a[176:179], v[236:239], v[100:103]
ds_read_b64_tr_b16 a[202:203], v3 offset:6400
ds_read_b64_tr_b16 a[204:205], v3 offset:8448
v_fma_f32 v39, v39, v28, v28
v_mfma_f32_16x16x32_bf16 v[100:103], a[180:183], v[244:247], v[100:103]
s_waitcnt lgkmcnt(5)
ds_read_b64_tr_b16 a[206:207], v3 offset:10496
v_rcp_f32 v34, v34
v_mfma_f32_16x16x32_bf16 v[96:99], a[184:187], v[248:251], v[96:99]
ds_read_b64_tr_b16 a[160:161], v3 offset:12544
v_rcp_f32 v35, v35
v_mfma_f32_16x16x32_bf16 v[96:99], a[188:191], a[144:147], v[96:99]
s_add_u32 m0, s36, 2048
ds_read_b64_tr_b16 a[162:163], v3 offset:14592
v_mul_f32 v84, v84, v32
v_mul_f32 v85, v85, v33
v_mfma_f32_16x16x32_bf16 v[96:99], a[192:195], a[152:155], v[96:99]
ds_read_b64_tr_b16 a[164:165], v3 offset:16640
v_mul_f32 v86, v86, v34
v_mul_f32 v87, v87, v35
v_mfma_f32_16x16x32_bf16 v[100:103], a[184:187], v[252:255], v[100:103]
ds_read_b64_tr_b16 a[166:167], v3 offset:18688
v_rcp_f32 v36, v36
v_mfma_f32_16x16x32_bf16 v[100:103], a[188:191], a[148:151], v[100:103]
buffer_load_dwordx4 v17, s[16:19], s27 offen  lds
v_mfma_f32_16x16x32_bf16 v[100:103], a[192:195], a[156:159], v[100:103]
s_waitcnt lgkmcnt(4)
ds_read_b64_tr_b16 a[168:169], v3 offset:20736
ds_read_b64_tr_b16 a[170:171], v3 offset:22784
v_mfma_f32_16x16x32_bf16 v[104:107], a[196:199], v[200:203], v[104:107]
ds_read_b64_tr_b16 a[172:173], v3 offset:24832
v_rcp_f32 v37, v37
v_mfma_f32_16x16x32_bf16 v[104:107], a[200:203], v[208:211], v[104:107]
ds_read_b64_tr_b16 a[174:175], v3 offset:26880
v_rcp_f32 v38, v38
v_mfma_f32_16x16x32_bf16 v[104:107], a[204:207], v[216:219], v[104:107]
s_add_u32 m0, s36, 3072
ds_read_b64_tr_b16 a[176:177], v3 offset:28928
v_mul_f32 v64, v64, v96
v_mfma_f32_16x16x32_bf16 v[108:111], a[196:199], v[204:207], v[108:111]
ds_read_b64_tr_b16 a[178:179], v3 offset:30976
v_mul_f32 v65, v65, v97
v_mfma_f32_16x16x32_bf16 v[108:111], a[200:203], v[212:215], v[108:111]
ds_read_b64_tr_b16 a[180:181], v3 offset:33024
v_mul_f32 v66, v66, v98
v_mfma_f32_16x16x32_bf16 v[108:111], a[204:207], v[220:223], v[108:111]
s_waitcnt lgkmcnt(5)
buffer_load_dwordx4 v18, s[16:19], s27 offen  lds
v_mfma_f32_16x16x32_bf16 v[104:107], a[160:163], v[224:227], v[104:107]
ds_read_b64_tr_b16 a[182:183], v3 offset:35072
ds_read_b64_tr_b16 a[184:185], v3 offset:512
v_mfma_f32_16x16x32_bf16 v[104:107], a[164:167], v[232:235], v[104:107]
ds_read_b64_tr_b16 a[186:187], v3 offset:2560
v_mul_f32 v67, v67, v99
v_rcp_f32 v39, v39
v_mfma_f32_16x16x32_bf16 v[104:107], a[168:171], v[240:243], v[104:107]
ds_read_b64_tr_b16 a[188:189], v3 offset:4608
v_mul_f32 v68, v68, v100
v_mul_f32 v88, v88, v36
v_mfma_f32_16x16x32_bf16 v[108:111], a[160:163], v[228:231], v[108:111]
s_add_u32 m0, s36, 4096
ds_read_b64_tr_b16 a[190:191], v3 offset:6656
v_mul_f32 v69, v69, v101
v_mul_f32 v89, v89, v37
v_mfma_f32_16x16x32_bf16 v[108:111], a[164:167], v[236:239], v[108:111]
ds_read_b64_tr_b16 a[192:193], v3 offset:8704
v_mul_f32 v70, v70, v102
v_mul_f32 v90, v90, v38
v_mfma_f32_16x16x32_bf16 v[108:111], a[168:171], v[244:247], v[108:111]
s_waitcnt lgkmcnt(5)
ds_read_b64_tr_b16 a[194:195], v3 offset:10752
v_mul_f32 v71, v71, v103
v_mul_f32 v91, v91, v39
v_mfma_f32_16x16x32_bf16 v[104:107], a[172:175], v[248:251], v[104:107]
buffer_load_dwordx4 v19, s[16:19], s27 offen  lds
v_mul_f32 v36, v92, v92
v_mfma_f32_16x16x32_bf16 v[104:107], a[176:179], a[144:147], v[104:107]
ds_read_b64_tr_b16 a[196:197], v3 offset:12800
ds_read_b64_tr_b16 a[198:199], v3 offset:14848
v_mul_f32 v37, v93, v93
v_mfma_f32_16x16x32_bf16 v[104:107], a[180:183], a[152:155], v[104:107]
ds_read_b64_tr_b16 a[200:201], v3 offset:16896
v_cvt_pk_bf16_f32 v40, v64, v65
v_mul_f32 v38, v94, v94
v_mfma_f32_16x16x32_bf16 v[108:111], a[172:175], v[252:255], v[108:111]
ds_read_b64_tr_b16 a[202:203], v3 offset:18944
v_cvt_pk_bf16_f32 v41, v66, v67
v_mul_f32 v39, v95, v95
v_mfma_f32_16x16x32_bf16 v[108:111], a[176:179], a[148:151], v[108:111]
s_add_u32 m0, s36, 5120
ds_read_b64_tr_b16 a[204:205], v3 offset:20992
v_cvt_pk_bf16_f32 v44, v68, v69
v_fma_f32 v36, v36, v27, v25
v_mfma_f32_16x16x32_bf16 v[108:111], a[180:183], a[156:159], v[108:111]
s_waitcnt lgkmcnt(5)
ds_read_b64_tr_b16 a[206:207], v3 offset:23040
v_cvt_pk_bf16_f32 v45, v70, v71
v_fma_f32 v37, v37, v27, v25
v_mfma_f32_16x16x32_bf16 v[112:115], a[184:187], v[200:203], v[112:115]
ds_read_b64_tr_b16 a[160:161], v3 offset:25088
v_fma_f32 v38, v38, v27, v25
v_fma_f32 v39, v39, v27, v25
v_mfma_f32_16x16x32_bf16 v[112:115], a[188:191], v[208:211], v[112:115]
buffer_load_dwordx4 v20, s[16:19], s27 offen  lds
v_mfma_f32_16x16x32_bf16 v[112:115], a[192:195], v[216:219], v[112:115]
ds_read_b64_tr_b16 a[162:163], v3 offset:27136
ds_read_b64_tr_b16 a[164:165], v3 offset:29184
v_mul_f32 v36, v92, v36
v_mfma_f32_16x16x32_bf16 v[116:119], a[184:187], v[204:207], v[116:119]
ds_read_b64_tr_b16 a[166:167], v3 offset:31232
v_mul_f32 v72, v72, v104
v_mul_f32 v37, v93, v37
v_mfma_f32_16x16x32_bf16 v[116:119], a[188:191], v[212:215], v[116:119]
ds_read_b64_tr_b16 a[168:169], v3 offset:33280
v_mul_f32 v73, v73, v105
v_mul_f32 v38, v94, v38
v_mfma_f32_16x16x32_bf16 v[116:119], a[192:195], v[220:223], v[116:119]
s_waitcnt lgkmcnt(5)
ds_read_b64_tr_b16 a[170:171], v3 offset:35328
v_mul_f32 v74, v74, v106
v_mfma_f32_16x16x32_bf16 v[112:115], a[196:199], v[224:227], v[112:115]
s_add_u32 m0, s36, 6144
ds_read_b64_tr_b16 a[172:173], v3 offset:768
v_mul_f32 v75, v75, v107
v_mul_f32 v39, v95, v39
v_mfma_f32_16x16x32_bf16 v[112:115], a[200:203], v[232:235], v[112:115]
ds_read_b64_tr_b16 a[174:175], v3 offset:2816
v_mul_f32 v76, v76, v108
v_mfma_f32_16x16x32_bf16 v[112:115], a[204:207], v[240:243], v[112:115]
buffer_load_dwordx4 v21, s[16:19], s27 offen  lds
v_mfma_f32_16x16x32_bf16 v[116:119], a[196:199], v[228:231], v[116:119]
ds_read_b64_tr_b16 a[176:177], v3 offset:4864
ds_read_b64_tr_b16 a[178:179], v3 offset:6912
v_mfma_f32_16x16x32_bf16 v[116:119], a[200:203], v[236:239], v[116:119]
s_add_u32 s97, s97, 1
ds_read_b64_tr_b16 a[180:181], v3 offset:8960
v_mul_f32 v77, v77, v109
v_mfma_f32_16x16x32_bf16 v[116:119], a[204:207], v[244:247], v[116:119]
s_waitcnt lgkmcnt(5)
ds_read_b64_tr_b16 a[182:183], v3 offset:11008
v_mul_f32 v78, v78, v110
v_mfma_f32_16x16x32_bf16 v[112:115], a[160:163], v[248:251], v[112:115]
s_and_b32 s97, s97, 3
ds_read_b64_tr_b16 a[184:185], v3 offset:13056
v_mul_f32 v79, v79, v111
s_mul_i32 s39, s97, 36864
v_mfma_f32_16x16x32_bf16 v[112:115], a[164:167], a[144:147], v[112:115]
s_add_u32 m0, s36, 7168
ds_read_b64_tr_b16 a[186:187], v3 offset:15104
v_cvt_pk_bf16_f32 v42, v72, v73
v_exp_f32 v36, v36
v_mfma_f32_16x16x32_bf16 v[112:115], a[168:171], a[152:155], v[112:115]
ds_read_b64_tr_b16 a[188:189], v3 offset:17152
v_cvt_pk_bf16_f32 v43, v74, v75
v_mfma_f32_16x16x32_bf16 v[116:119], a[160:163], v[252:255], v[116:119]
buffer_load_dwordx4 v22, s[16:19], s27 offen  lds
v_mfma_f32_16x16x32_bf16 v[116:119], a[164:167], a[148:151], v[116:119]
ds_read_b64_tr_b16 a[190:191], v3 offset:19200
ds_read_b64_tr_b16 a[192:193], v3 offset:21248
v_exp_f32 v37, v37
v_mfma_f32_16x16x32_bf16 v[116:119], a[168:171], a[156:159], v[116:119]
s_waitcnt lgkmcnt(5)
ds_read_b64_tr_b16 a[194:195], v3 offset:23296
v_cvt_pk_bf16_f32 v46, v76, v77
v_mfma_f32_16x16x32_bf16 v[120:123], a[172:175], v[200:203], v[120:123]
ds_read_b64_tr_b16 a[196:197], v3 offset:25344
v_cvt_pk_bf16_f32 v47, v78, v79
v_mfma_f32_16x16x32_bf16 v[120:123], a[176:179], v[208:211], v[120:123]
s_add_u32 m0, s36, 8192
ds_read_b64_tr_b16 a[198:199], v3 offset:27392
v_exp_f32 v38, v38
v_mfma_f32_16x16x32_bf16 v[120:123], a[180:183], v[216:219], v[120:123]
ds_read_b64_tr_b16 a[200:201], v3 offset:29440
v_exp_f32 v39, v39
v_mfma_f32_16x16x32_bf16 v[124:127], a[172:175], v[204:207], v[124:127]
ds_read_b64_tr_b16 a[202:203], v3 offset:31488
v_fma_f32 v36, v36, v29, v29
v_fma_f32 v37, v37, v29, v29
v_mfma_f32_16x16x32_bf16 v[124:127], a[176:179], v[212:215], v[124:127]
s_waitcnt vmcnt(8)
buffer_load_dwordx4 v23, s[16:19], s27 offen  lds
s_barrier
v_mfma_f32_16x16x32_bf16 v[124:127], a[180:183], v[220:223], v[124:127]
s_waitcnt lgkmcnt(4)
ds_read_b64_tr_b16 a[204:205], v3 offset:33536
ds_read_b64_tr_b16 a[206:207], v3 offset:35584
v_add_u32 v3, s39, v6
v_mfma_f32_16x16x32_bf16 v[120:123], a[184:187], v[224:227], v[120:123]
s_add_u32 s96, s96, 1
ds_read_b64_tr_b16 a[160:161], v3 offset:0
v_fma_f32 v38, v38, v29, v29
v_fma_f32 v39, v39, v29, v29
v_mfma_f32_16x16x32_bf16 v[120:123], a[188:191], v[232:235], v[120:123]
s_and_b32 s96, s96, 3
ds_read_b64_tr_b16 a[162:163], v3 offset:1024
v_rcp_f32 v36, v36
s_mul_i32 s36, s96, 36864
v_mfma_f32_16x16x32_bf16 v[120:123], a[192:195], v[240:243], v[120:123]
s_add_u32 s36, s36, s38
ds_read_b64_tr_b16 a[164:165], v3 offset:2048
v_rcp_f32 v37, v37
v_mfma_f32_16x16x32_bf16 v[124:127], a[184:187], v[228:231], v[124:127]
ds_read_b64_tr_b16 a[166:167], v3 offset:3072
v_mfma_f32_16x16x32_bf16 v[124:127], a[188:191], v[236:239], v[124:127]
ds_read_b64_tr_b16 a[168:169], v3 offset:4096
v_mfma_f32_16x16x32_bf16 v[124:127], a[192:195], v[244:247], v[124:127]
s_waitcnt lgkmcnt(5)
ds_read_b64_tr_b16 a[170:171], v3 offset:5120
v_rcp_f32 v38, v38
v_mfma_f32_16x16x32_bf16 v[120:123], a[196:199], v[248:251], v[120:123]
ds_read_b64_tr_b16 a[172:173], v3 offset:6144
v_mfma_f32_16x16x32_bf16 v[120:123], a[200:203], a[144:147], v[120:123]
ds_read_b64_tr_b16 a[174:175], v3 offset:7168
v_rcp_f32 v39, v39
v_mfma_f32_16x16x32_bf16 v[120:123], a[204:207], a[152:155], v[120:123]
ds_read_b64_tr_b16 a[176:177], v3 offset:8192
v_mul_f32 v92, v92, v36
v_mfma_f32_16x16x32_bf16 v[124:127], a[196:199], v[252:255], v[124:127]
s_mov_b32 s41, s26
ds_read_b64_tr_b16 a[178:179], v3 offset:9216
v_mul_f32 v93, v93, v37
v_mfma_f32_16x16x32_bf16 v[124:127], a[200:203], a[148:151], v[124:127]
ds_read_b64_tr_b16 a[180:181], v3 offset:10240
v_mul_f32 v94, v94, v38
v_mfma_f32_16x16x32_bf16 v[124:127], a[204:207], a[156:159], v[124:127]
s_waitcnt lgkmcnt(5)
ds_read_b64_tr_b16 a[182:183], v3 offset:11264
v_mul_f32 v95, v95, v39
v_mfma_f32_16x16x32_bf16 v[64:67], a[160:163], v[128:131], 0
s_mov_b32 m0, s36
ds_read_b64_tr_b16 a[184:185], v3 offset:12288
buffer_load_dword v1, off, s[20:23], s44 sc1
v_mfma_f32_16x16x32_bf16 v[64:67], a[164:167], v[136:139], v[64:67]
ds_read_b64_tr_b16 a[186:187], v3 offset:13312
buffer_store_dwordx4 v[40:43], v30, s[20:23], s33 offen offset:0 sc1
v_mfma_f32_16x16x32_bf16 v[64:67], a[168:171], v[144:147], v[64:67]
buffer_load_dwordx4 v12, s[12:15], s41 offen offset:0  lds
v_mfma_f32_16x16x32_bf16 v[68:71], a[160:163], v[132:135], 0
ds_read_b64_tr_b16 a[188:189], v3 offset:14336
ds_read_b64_tr_b16 a[190:191], v3 offset:15360
v_mfma_f32_16x16x32_bf16 v[68:71], a[164:167], v[140:143], v[68:71]
ds_read_b64_tr_b16 a[192:193], v3 offset:16384
buffer_store_dwordx4 v[44:47], v30, s[20:23], s33 offen offset:1024 sc1
v_mfma_f32_16x16x32_bf16 v[68:71], a[168:171], v[148:151], v[68:71]
s_waitcnt lgkmcnt(5)
ds_read_b64_tr_b16 a[194:195], v3 offset:17408
v_mul_f32 v80, v80, v112
v_mfma_f32_16x16x32_bf16 v[64:67], a[172:175], v[152:155], v[64:67]
ds_read_b64_tr_b16 a[196:197], v3 offset:18432
v_mul_f32 v81, v81, v113
v_mfma_f32_16x16x32_bf16 v[64:67], a[176:179], v[160:163], v[64:67]
ds_read_b64_tr_b16 a[198:199], v3 offset:19456
v_mul_f32 v82, v82, v114
v_mfma_f32_16x16x32_bf16 v[64:67], a[180:183], v[168:171], v[64:67]
ds_read_b64_tr_b16 a[200:201], v3 offset:20480
v_mul_f32 v83, v83, v115
v_mfma_f32_16x16x32_bf16 v[68:71], a[172:175], v[156:159], v[68:71]
buffer_load_dwordx4 v13, s[12:15], s41 offen offset:1024  lds
v_mfma_f32_16x16x32_bf16 v[68:71], a[176:179], v[164:167], v[68:71]
ds_read_b64_tr_b16 a[202:203], v3 offset:21504
ds_read_b64_tr_b16 a[204:205], v3 offset:22528
v_mfma_f32_16x16x32_bf16 v[68:71], a[180:183], v[172:175], v[68:71]
s_waitcnt lgkmcnt(5)
ds_read_b64_tr_b16 a[206:207], v3 offset:23552
v_mul_f32 v84, v84, v116
v_mfma_f32_16x16x32_bf16 v[64:67], a[184:187], v[176:179], v[64:67]
ds_read_b64_tr_b16 a[160:161], v3 offset:24576
v_mul_f32 v85, v85, v117
v_mfma_f32_16x16x32_bf16 v[64:67], a[188:191], v[184:187], v[64:67]
ds_read_b64_tr_b16 a[162:163], v3 offset:25600
v_mul_f32 v86, v86, v118
v_mfma_f32_16x16x32_bf16 v[64:67], a[192:195], v[192:195], v[64:67]
ds_read_b64_tr_b16 a[164:165], v3 offset:26624
v_mul_f32 v87, v87, v119
v_mfma_f32_16x16x32_bf16 v[68:71], a[184:187], v[180:183], v[68:71]
ds_read_b64_tr_b16 a[166:167], v3 offset:27648
v_cvt_pk_bf16_f32 v48, v80, v81
v_mfma_f32_16x16x32_bf16 v[68:71], a[188:191], v[188:191], v[68:71]
buffer_load_dwordx4 v14, s[12:15], s41 offen offset:2048  lds
v_mfma_f32_16x16x32_bf16 v[68:71], a[192:195], v[196:199], v[68:71]
s_waitcnt lgkmcnt(4)
ds_read_b64_tr_b16 a[168:169], v3 offset:28672
ds_read_b64_tr_b16 a[170:171], v3 offset:29696
v_mfma_f32_16x16x32_bf16 v[64:67], a[196:199], v[200:203], v[64:67]
s_add_u32 s41, s26, 0x6c000
ds_read_b64_tr_b16 a[172:173], v3 offset:30720
v_cvt_pk_bf16_f32 v49, v82, v83
v_mfma_f32_16x16x32_bf16 v[64:67], a[200:203], v[208:211], v[64:67]
ds_read_b64_tr_b16 a[174:175], v3 offset:31744
v_cvt_pk_bf16_f32 v52, v84, v85
v_mfma_f32_16x16x32_bf16 v[64:67], a[204:207], v[216:219], v[64:67]
s_add_u32 m0, s36, 3072
ds_read_b64_tr_b16 a[176:177], v3 offset:32768
v_cvt_pk_bf16_f32 v53, v86, v87
v_mfma_f32_16x16x32_bf16 v[68:71], a[196:199], v[204:207], v[68:71]
ds_read_b64_tr_b16 a[178:179], v3 offset:33792
v_mul_f32 v88, v88, v120
v_mfma_f32_16x16x32_bf16 v[68:71], a[200:203], v[212:215], v[68:71]
ds_read_b64_tr_b16 a[180:181], v3 offset:34816
v_mul_f32 v89, v89, v121
v_mfma_f32_16x16x32_bf16 v[68:71], a[204:207], v[220:223], v[68:71]
s_waitcnt lgkmcnt(5)
buffer_load_dwordx4 v12, s[12:15], s41 offen offset:0  lds
v_mfma_f32_16x16x32_bf16 v[64:67], a[160:163], v[224:227], v[64:67]
ds_read_b64_tr_b16 a[182:183], v3 offset:35840
ds_read_b64_tr_b16 a[184:185], v3 offset:512
v_mfma_f32_16x16x32_bf16 v[64:67], a[164:167], v[232:235], v[64:67]
ds_read_b64_tr_b16 a[186:187], v3 offset:1536
v_mul_f32 v90, v90, v122
v_mfma_f32_16x16x32_bf16 v[64:67], a[168:171], v[240:243], v[64:67]
ds_read_b64_tr_b16 a[188:189], v3 offset:2560
v_mul_f32 v91, v91, v123
v_mfma_f32_16x16x32_bf16 v[68:71], a[160:163], v[228:231], v[68:71]
ds_read_b64_tr_b16 a[190:191], v3 offset:3584
v_mul_f32 v92, v92, v124
v_mfma_f32_16x16x32_bf16 v[68:71], a[164:167], v[236:239], v[68:71]
ds_read_b64_tr_b16 a[192:193], v3 offset:4608
v_mul_f32 v93, v93, v125
v_mfma_f32_16x16x32_bf16 v[68:71], a[168:171], v[244:247], v[68:71]
s_waitcnt lgkmcnt(5)
ds_read_b64_tr_b16 a[194:195], v3 offset:5632
v_mul_f32 v94, v94, v126
v_mfma_f32_16x16x32_bf16 v[64:67], a[172:175], v[248:251], v[64:67]
buffer_load_dwordx4 v13, s[12:15], s41 offen offset:1024  lds
v_mfma_f32_16x16x32_bf16 v[64:67], a[176:179], a[144:147], v[64:67]
ds_read_b64_tr_b16 a[196:197], v3 offset:6656
ds_read_b64_tr_b16 a[198:199], v3 offset:7680
v_mfma_f32_16x16x32_bf16 v[64:67], a[180:183], a[152:155], v[64:67]
ds_read_b64_tr_b16 a[200:201], v3 offset:8704
v_mul_f32 v95, v95, v127
v_mfma_f32_16x16x32_bf16 v[68:71], a[172:175], v[252:255], v[68:71]
ds_read_b64_tr_b16 a[202:203], v3 offset:9728
v_cvt_pk_bf16_f32 v50, v88, v89
v_mfma_f32_16x16x32_bf16 v[68:71], a[176:179], a[148:151], v[68:71]
ds_read_b64_tr_b16 a[204:205], v3 offset:10752
v_cvt_pk_bf16_f32 v51, v90, v91
v_mfma_f32_16x16x32_bf16 v[68:71], a[180:183], a[156:159], v[68:71]
s_waitcnt lgkmcnt(5)
ds_read_b64_tr_b16 a[206:207], v3 offset:11776
v_cvt_pk_bf16_f32 v54, v92, v93
v_mfma_f32_16x16x32_bf16 v[72:75], a[184:187], v[128:131], 0
ds_read_b64_tr_b16 a[160:161], v3 offset:12800
v_cvt_pk_bf16_f32 v55, v94, v95
v_mfma_f32_16x16x32_bf16 v[72:75], a[188:191], v[136:139], v[72:75]
buffer_load_dwordx4 v14, s[12:15], s41 offen offset:2048  lds
v_mfma_f32_16x16x32_bf16 v[72:75], a[192:195], v[144:147], v[72:75]
ds_read_b64_tr_b16 a[162:163], v3 offset:13824
ds_read_b64_tr_b16 a[164:165], v3 offset:14848
v_mfma_f32_16x16x32_bf16 v[76:79], a[184:187], v[132:135], 0
s_add_u32 s41, s26, 0xd8000
ds_read_b64_tr_b16 a[166:167], v3 offset:15872
v_mfma_f32_16x16x32_bf16 v[76:79], a[188:191], v[140:143], v[76:79]
ds_read_b64_tr_b16 a[168:169], v3 offset:16896
buffer_store_dwordx4 v[48:51], v30, s[20:23], s33 offen offset:2048 sc1
v_mfma_f32_16x16x32_bf16 v[76:79], a[192:195], v[148:151], v[76:79]
s_waitcnt lgkmcnt(5)
ds_read_b64_tr_b16 a[170:171], v3 offset:17920
v_mfma_f32_16x16x32_bf16 v[72:75], a[196:199], v[152:155], v[72:75]
s_add_u32 m0, s36, 6144
ds_read_b64_tr_b16 a[172:173], v3 offset:18944
buffer_store_dwordx4 v[52:55], v30, s[20:23], s33 offen offset:3072 sc1
v_mfma_f32_16x16x32_bf16 v[72:75], a[200:203], v[160:163], v[72:75]
ds_read_b64_tr_b16 a[174:175], v3 offset:19968
v_mul_f32 v32, v64, v64
v_mfma_f32_16x16x32_bf16 v[72:75], a[204:207], v[168:171], v[72:75]
buffer_load_dwordx4 v12, s[12:15], s41 offen offset:0  lds
v_mfma_f32_16x16x32_bf16 v[76:79], a[196:199], v[156:159], v[76:79]
ds_read_b64_tr_b16 a[176:177], v3 offset:20992
ds_read_b64_tr_b16 a[178:179], v3 offset:22016
v_mfma_f32_16x16x32_bf16 v[76:79], a[200:203], v[164:167], v[76:79]
s_add_u32 s97, s97, 1
ds_read_b64_tr_b16 a[180:181], v3 offset:23040
v_mul_f32 v33, v65, v65
v_mfma_f32_16x16x32_bf16 v[76:79], a[204:207], v[172:175], v[76:79]
s_waitcnt lgkmcnt(5)
ds_read_b64_tr_b16 a[182:183], v3 offset:24064
v_mul_f32 v34, v66, v66
v_mfma_f32_16x16x32_bf16 v[72:75], a[160:163], v[176:179], v[72:75]
s_and_b32 s97, s97, 3
ds_read_b64_tr_b16 a[184:185], v3 offset:25088
v_mul_f32 v35, v67, v67
s_mul_i32 s39, s97, 36864
v_mfma_f32_16x16x32_bf16 v[72:75], a[164:167], v[184:187], v[72:75]
ds_read_b64_tr_b16 a[186:187], v3 offset:26112
v_fma_f32 v32, v32, v26, v24
v_mfma_f32_16x16x32_bf16 v[72:75], a[168:171], v[192:195], v[72:75]
ds_read_b64_tr_b16 a[188:189], v3 offset:27136
v_fma_f32 v33, v33, v26, v24
v_mfma_f32_16x16x32_bf16 v[76:79], a[160:163], v[180:183], v[76:79]
buffer_load_dwordx4 v13, s[12:15], s41 offen offset:1024  lds
v_mfma_f32_16x16x32_bf16 v[76:79], a[164:167], v[188:191], v[76:79]
ds_read_b64_tr_b16 a[190:191], v3 offset:28160
ds_read_b64_tr_b16 a[192:193], v3 offset:29184
v_mfma_f32_16x16x32_bf16 v[76:79], a[168:171], v[196:199], v[76:79]
s_waitcnt lgkmcnt(5)
ds_read_b64_tr_b16 a[194:195], v3 offset:30208
v_fma_f32 v34, v34, v26, v24
v_mfma_f32_16x16x32_bf16 v[72:75], a[172:175], v[200:203], v[72:75]
ds_read_b64_tr_b16 a[196:197], v3 offset:31232
v_fma_f32 v35, v35, v26, v24
v_mfma_f32_16x16x32_bf16 v[72:75], a[176:179], v[208:211], v[72:75]
ds_read_b64_tr_b16 a[198:199], v3 offset:32256
v_mul_f32 v32, v64, v32
v_mfma_f32_16x16x32_bf16 v[72:75], a[180:183], v[216:219], v[72:75]
ds_read_b64_tr_b16 a[200:201], v3 offset:33280
v_mul_f32 v33, v65, v33
v_mfma_f32_16x16x32_bf16 v[76:79], a[172:175], v[204:207], v[76:79]
ds_read_b64_tr_b16 a[202:203], v3 offset:34304
v_mul_f32 v34, v66, v34
v_mfma_f32_16x16x32_bf16 v[76:79], a[176:179], v[212:215], v[76:79]
s_waitcnt vmcnt(13)
buffer_load_dwordx4 v14, s[12:15], s41 offen offset:2048  lds
s_barrier
v_mfma_f32_16x16x32_bf16 v[76:79], a[180:183], v[220:223], v[76:79]
s_waitcnt lgkmcnt(4)
ds_read_b64_tr_b16 a[204:205], v3 offset:35328
ds_read_b64_tr_b16 a[206:207], v3 offset:36352
v_add_u32 v3, s39, v7
v_add_u32 v4, s39, v8
v_mfma_f32_16x16x32_bf16 v[72:75], a[184:187], v[224:227], v[72:75]
s_add_u32 s96, s96, 1
ds_read_b64_tr_b16 a[160:161], v3 offset:0
v_mul_f32 v35, v67, v35
v_mfma_f32_16x16x32_bf16 v[72:75], a[188:191], v[232:235], v[72:75]
s_and_b32 s96, s96, 3
ds_read_b64_tr_b16 a[162:163], v3 offset:9216
s_mul_i32 s36, s96, 36864
s_add_u32 s36, s36, s38
v_mfma_f32_16x16x32_bf16 v[72:75], a[192:195], v[240:243], v[72:75]
ds_read_b64_tr_b16 a[164:165], v3 offset:18432
v_exp_f32 v32, v32
v_mfma_f32_16x16x32_bf16 v[76:79], a[184:187], v[228:231], v[76:79]
ds_read_b64_tr_b16 a[166:167], v3 offset:27648
v_mfma_f32_16x16x32_bf16 v[76:79], a[188:191], v[236:239], v[76:79]
ds_read_b64_tr_b16 a[168:169], v4 offset:128
v_exp_f32 v33, v33
v_mfma_f32_16x16x32_bf16 v[76:79], a[192:195], v[244:247], v[76:79]
s_waitcnt lgkmcnt(5)
ds_read_b64_tr_b16 a[170:171], v4 offset:9344
v_mfma_f32_16x16x32_bf16 v[72:75], a[196:199], v[248:251], v[72:75]
ds_read_b64_tr_b16 a[172:173], v4 offset:18560
v_exp_f32 v34, v34
v_mfma_f32_16x16x32_bf16 v[72:75], a[200:203], a[144:147], v[72:75]
ds_read_b64_tr_b16 a[174:175], v4 offset:27776
v_mfma_f32_16x16x32_bf16 v[72:75], a[204:207], a[152:155], v[72:75]
ds_read_b64_tr_b16 a[176:177], v3 offset:256
v_exp_f32 v35, v35
v_mfma_f32_16x16x32_bf16 v[76:79], a[196:199], v[252:255], v[76:79]
ds_read_b64_tr_b16 a[178:179], v3 offset:9472
v_fma_f32 v32, v32, v28, v28
v_mfma_f32_16x16x32_bf16 v[76:79], a[200:203], a[148:151], v[76:79]
ds_read_b64_tr_b16 a[180:181], v3 offset:18688
v_fma_f32 v33, v33, v28, v28
v_mfma_f32_16x16x32_bf16 v[76:79], a[204:207], a[156:159], v[76:79]
s_waitcnt lgkmcnt(3)
ds_read_b64_tr_b16 a[182:183], v3 offset:27904
v_fma_f32 v34, v34, v28, v28
v_mfma_f32_16x16x32_bf16 a[0:3], a[160:163], v[40:43], a[0:3]
s_mov_b32 m0, s36
ds_read_b64_tr_b16 a[184:185], v4 offset:384
v_fma_f32 v35, v35, v28, v28
v_mfma_f32_16x16x32_bf16 a[0:3], a[164:167], v[48:51], a[0:3]
ds_read_b64_tr_b16 a[186:187], v4 offset:9600
v_mfma_f32_16x16x32_bf16 a[4:7], a[160:163], v[44:47], a[4:7]
buffer_load_dwordx4 v15, s[16:19], s28 offen  lds
v_mfma_f32_16x16x32_bf16 a[4:7], a[164:167], v[52:55], a[4:7]
ds_read_b64_tr_b16 a[188:189], v4 offset:18816
ds_read_b64_tr_b16 a[190:191], v4 offset:28032
v_mfma_f32_16x16x32_bf16 a[8:11], a[168:171], v[40:43], a[8:11]
ds_read_b64_tr_b16 a[192:193], v3 offset:512
v_mul_f32 v36, v72, v72
v_mfma_f32_16x16x32_bf16 a[8:11], a[172:175], v[48:51], a[8:11]
ds_read_b64_tr_b16 a[194:195], v3 offset:9728
v_mul_f32 v37, v73, v73
v_mfma_f32_16x16x32_bf16 a[12:15], a[168:171], v[44:47], a[12:15]
s_add_u32 m0, s36, 1024
ds_read_b64_tr_b16 a[196:197], v3 offset:18944
v_mul_f32 v38, v74, v74
v_mfma_f32_16x16x32_bf16 a[12:15], a[172:175], v[52:55], a[12:15]
s_waitcnt lgkmcnt(3)
ds_read_b64_tr_b16 a[198:199], v3 offset:28160
v_mul_f32 v39, v75, v75
v_mfma_f32_16x16x32_bf16 a[16:19], a[176:179], v[40:43], a[16:19]
ds_read_b64_tr_b16 a[200:201], v4 offset:640
v_fma_f32 v36, v36, v26, v24
v_rcp_f32 v32, v32
v_mfma_f32_16x16x32_bf16 a[16:19], a[180:183], v[48:51], a[16:19]
buffer_load_dwordx4 v16, s[16:19], s28 offen  lds
v_mfma_f32_16x16x32_bf16 a[20:23], a[176:179], v[44:47], a[20:23]
ds_read_b64_tr_b16 a[202:203], v4 offset:9856
ds_read_b64_tr_b16 a[204:205], v4 offset:19072
v_rcp_f32 v33, v33
v_mfma_f32_16x16x32_bf16 a[20:23], a[180:183], v[52:55], a[20:23]
ds_read_b64_tr_b16 a[206:207], v4 offset:28288
v_fma_f32 v37, v37, v26, v24
v_mfma_f32_16x16x32_bf16 a[24:27], a[184:187], v[40:43], a[24:27]
ds_read_b64_tr_b16 a[160:161], v3 offset:768
v_fma_f32 v38, v38, v26, v24
v_rcp_f32 v34, v34
v_mfma_f32_16x16x32_bf16 a[24:27], a[188:191], v[48:51], a[24:27]
s_add_u32 m0, s36, 2048
ds_read_b64_tr_b16 a[162:163], v3 offset:9984
v_fma_f32 v39, v39, v26, v24
v_mfma_f32_16x16x32_bf16 a[28:31], a[184:187], v[44:47], a[28:31]
ds_read_b64_tr_b16 a[164:165], v3 offset:19200
v_mul_f32 v36, v72, v36
v_rcp_f32 v35, v35
v_mfma_f32_16x16x32_bf16 a[28:31], a[188:191], v[52:55], a[28:31]
s_waitcnt lgkmcnt(3)
ds_read_b64_tr_b16 a[166:167], v3 offset:28416
v_mul_f32 v64, v64, v32
v_mul_f32 v65, v65, v33
v_mfma_f32_16x16x32_bf16 a[32:35], a[192:195], v[40:43], a[32:35]
buffer_load_dwordx4 v17, s[16:19], s28 offen  lds
v_mul_f32 v66, v66, v34
v_mfma_f32_16x16x32_bf16 a[32:35], a[196:199], v[48:51], a[32:35]
ds_read_b64_tr_b16 a[168:169], v4 offset:896
ds_read_b64_tr_b16 a[170:171], v4 offset:10112
v_mul_f32 v67, v67, v35
v_mfma_f32_16x16x32_bf16 a[36:39], a[192:195], v[44:47], a[36:39]
ds_read_b64_tr_b16 a[172:173], v4 offset:19328
v_mul_f32 v32, v68, v68
v_mul_f32 v33, v69, v69
v_mfma_f32_16x16x32_bf16 a[36:39], a[196:199], v[52:55], a[36:39]
ds_read_b64_tr_b16 a[174:175], v4 offset:28544
v_mul_f32 v34, v70, v70
v_mul_f32 v35, v71, v71
v_mfma_f32_16x16x32_bf16 a[40:43], a[200:203], v[40:43], a[40:43]
s_add_u32 m0, s36, 3072
ds_read_b64_tr_b16 a[176:177], v3 offset:1024
v_fma_f32 v32, v32, v27, v25
v_fma_f32 v33, v33, v27, v25
v_mfma_f32_16x16x32_bf16 a[40:43], a[204:207], v[48:51], a[40:43]
ds_read_b64_tr_b16 a[178:179], v3 offset:10240
v_fma_f32 v34, v34, v27, v25
v_fma_f32 v35, v35, v27, v25
v_mfma_f32_16x16x32_bf16 a[44:47], a[200:203], v[44:47], a[44:47]
ds_read_b64_tr_b16 a[180:181], v3 offset:19456
v_mul_f32 v32, v68, v32
v_mul_f32 v33, v69, v33
v_mfma_f32_16x16x32_bf16 a[44:47], a[204:207], v[52:55], a[44:47]
s_waitcnt lgkmcnt(3)
buffer_load_dwordx4 v18, s[16:19], s28 offen  lds
v_mul_f32 v34, v70, v34
v_mfma_f32_16x16x32_bf16 a[48:51], a[160:163], v[40:43], a[48:51]
ds_read_b64_tr_b16 a[182:183], v3 offset:28672
ds_read_b64_tr_b16 a[184:185], v4 offset:1152
v_mul_f32 v35, v71, v35
v_mfma_f32_16x16x32_bf16 a[48:51], a[164:167], v[48:51], a[48:51]
ds_read_b64_tr_b16 a[186:187], v4 offset:10368
v_mul_f32 v37, v73, v37
v_mfma_f32_16x16x32_bf16 a[52:55], a[160:163], v[44:47], a[52:55]
ds_read_b64_tr_b16 a[188:189], v4 offset:19584
v_mul_f32 v38, v74, v38
v_mfma_f32_16x16x32_bf16 a[52:55], a[164:167], v[52:55], a[52:55]
s_add_u32 m0, s36, 4096
ds_read_b64_tr_b16 a[190:191], v4 offset:28800
v_mul_f32 v39, v75, v39
v_mfma_f32_16x16x32_bf16 a[56:59], a[168:171], v[40:43], a[56:59]
ds_read_b64_tr_b16 a[192:193], v3 offset:1280
v_exp_f32 v32, v32
v_mfma_f32_16x16x32_bf16 a[56:59], a[172:175], v[48:51], a[56:59]
ds_read_b64_tr_b16 a[194:195], v3 offset:10496
v_exp_f32 v33, v33
v_mfma_f32_16x16x32_bf16 a[60:63], a[168:171], v[44:47], a[60:63]
buffer_load_dwordx4 v19, s[16:19], s28 offen  lds
v_mfma_f32_16x16x32_bf16 a[60:63], a[172:175], v[52:55], a[60:63]
s_waitcnt lgkmcnt(2)
ds_read_b64_tr_b16 a[196:197], v3 offset:19712
ds_read_b64_tr_b16 a[198:199], v3 offset:28928
v_mfma_f32_16x16x32_bf16 a[64:67], a[176:179], v[40:43], a[64:67]
ds_read_b64_tr_b16 a[200:201], v4 offset:1408
v_exp_f32 v34, v34
v_mfma_f32_16x16x32_bf16 a[64:67], a[180:183], v[48:51], a[64:67]
ds_read_b64_tr_b16 a[202:203], v4 offset:10624
v_exp_f32 v35, v35
v_mfma_f32_16x16x32_bf16 a[68:71], a[176:179], v[44:47], a[68:71]
s_add_u32 m0, s36, 5120
ds_read_b64_tr_b16 a[204:205], v4 offset:19840
v_fma_f32 v32, v32, v29, v29
v_fma_f32 v33, v33, v29, v29
v_mfma_f32_16x16x32_bf16 a[68:71], a[180:183], v[52:55], a[68:71]
ds_read_b64_tr_b16 a[206:207], v4 offset:29056
v_fma_f32 v34, v34, v29, v29
v_mfma_f32_16x16x32_bf16 a[72:75], a[184:187], v[40:43], a[72:75]
ds_read_b64_tr_b16 a[160:161], v3 offset:1536
v_fma_f32 v35, v35, v29, v29
v_mfma_f32_16x16x32_bf16 a[72:75], a[188:191], v[48:51], a[72:75]
buffer_load_dwordx4 v20, s[16:19], s28 offen  lds
v_mfma_f32_16x16x32_bf16 a[76:79], a[184:187], v[44:47], a[76:79]
ds_read_b64_tr_b16 a[162:163], v3 offset:10752
ds_read_b64_tr_b16 a[164:165], v3 offset:19968
v_mfma_f32_16x16x32_bf16 a[76:79], a[188:191], v[52:55], a[76:79]
s_waitcnt lgkmcnt(3)
ds_read_b64_tr_b16 a[166:167], v3 offset:29184
v_rcp_f32 v32, v32
v_mfma_f32_16x16x32_bf16 a[80:83], a[192:195], v[40:43], a[80:83]
ds_read_b64_tr_b16 a[168:169], v4 offset:1664
v_rcp_f32 v33, v33
v_mfma_f32_16x16x32_bf16 a[80:83], a[196:199], v[48:51], a[80:83]
s_add_u32 m0, s36, 6144
ds_read_b64_tr_b16 a[170:171], v4 offset:10880
v_rcp_f32 v34, v34
v_mfma_f32_16x16x32_bf16 a[84:87], a[192:195], v[44:47], a[84:87]
ds_read_b64_tr_b16 a[172:173], v4 offset:20096
v_mfma_f32_16x16x32_bf16 a[84:87], a[196:199], v[52:55], a[84:87]
ds_read_b64_tr_b16 a[174:175], v4 offset:29312
v_rcp_f32 v35, v35
v_mfma_f32_16x16x32_bf16 a[88:91], a[200:203], v[40:43], a[88:91]
buffer_load_dwordx4 v21, s[16:19], s28 offen  lds
v_mfma_f32_16x16x32_bf16 a[88:91], a[204:207], v[48:51], a[88:91]
ds_read_b64_tr_b16 a[176:177], v3 offset:1792
ds_read_b64_tr_b16 a[178:179], v3 offset:11008
v_mul_f32 v68, v68, v32
v_mfma_f32_16x16x32_bf16 a[92:95], a[200:203], v[44:47], a[92:95]
s_add_u32 s97, s97, 1
ds_read_b64_tr_b16 a[180:181], v3 offset:20224
v_mul_f32 v69, v69, v33
v_mfma_f32_16x16x32_bf16 a[92:95], a[204:207], v[52:55], a[92:95]
s_waitcnt lgkmcnt(3)
ds_read_b64_tr_b16 a[182:183], v3 offset:29440
v_mul_f32 v70, v70, v34
v_mfma_f32_16x16x32_bf16 a[96:99], a[160:163], v[40:43], a[96:99]
s_add_u32 m0, s36, 7168
ds_read_b64_tr_b16 a[184:185], v4 offset:1920
v_mul_f32 v71, v71, v35
s_and_b32 s97, s97, 3
s_mul_i32 s39, s97, 36864
v_mfma_f32_16x16x32_bf16 a[96:99], a[164:167], v[48:51], a[96:99]
ds_read_b64_tr_b16 a[186:187], v4 offset:11136
v_mfma_f32_16x16x32_bf16 a[100:103], a[160:163], v[44:47], a[100:103]
ds_read_b64_tr_b16 a[188:189], v4 offset:20352
v_mfma_f32_16x16x32_bf16 a[100:103], a[164:167], v[52:55], a[100:103]
buffer_load_dwordx4 v22, s[16:19], s28 offen  lds
v_mfma_f32_16x16x32_bf16 a[104:107], a[168:171], v[40:43], a[104:107]
ds_read_b64_tr_b16 a[190:191], v4 offset:29568
ds_read_b64_tr_b16 a[192:193], v3 offset:2048
v_mfma_f32_16x16x32_bf16 a[104:107], a[172:175], v[48:51], a[104:107]
ds_read_b64_tr_b16 a[194:195], v3 offset:11264
v_exp_f32 v36, v36
v_mfma_f32_16x16x32_bf16 a[108:111], a[168:171], v[44:47], a[108:111]
ds_read_b64_tr_b16 a[196:197], v3 offset:20480
v_exp_f32 v37, v37
v_mfma_f32_16x16x32_bf16 a[108:111], a[172:175], v[52:55], a[108:111]
s_waitcnt lgkmcnt(3)
ds_read_b64_tr_b16 a[198:199], v3 offset:29696
v_exp_f32 v38, v38
v_mfma_f32_16x16x32_bf16 a[112:115], a[176:179], v[40:43], a[112:115]
s_add_u32 m0, s36, 8192
ds_read_b64_tr_b16 a[200:201], v4 offset:2176
v_mfma_f32_16x16x32_bf16 a[112:115], a[180:183], v[48:51], a[112:115]
ds_read_b64_tr_b16 a[202:203], v4 offset:11392
v_exp_f32 v39, v39
v_mfma_f32_16x16x32_bf16 a[116:119], a[176:179], v[44:47], a[116:119]
s_waitcnt vmcnt(8)
buffer_load_dwordx4 v23, s[16:19], s28 offen  lds
s_barrier
v_mfma_f32_16x16x32_bf16 a[116:119], a[180:183], v[52:55], a[116:119]
s_add_u32 s96, s96, 1
ds_read_b64_tr_b16 a[204:205], v4 offset:20608
ds_read_b64_tr_b16 a[206:207], v4 offset:29824
v_add_u32 v3, s39, v6
v_mfma_f32_16x16x32_bf16 a[120:123], a[184:187], v[40:43], a[120:123]
s_and_b32 s96, s96, 3
ds_read_b64_tr_b16 a[160:161], v3 offset:0
v_fma_f32 v36, v36, v28, v28
v_fma_f32 v37, v37, v28, v28
v_mfma_f32_16x16x32_bf16 a[120:123], a[188:191], v[48:51], a[120:123]
s_mul_i32 s36, s96, 36864
ds_read_b64_tr_b16 a[162:163], v3 offset:1024
v_readfirstlane_b32 s50, v1
s_nop 0
s_cmp_ge_u32 s50, 3
s_cbranch_scc0 L_sequential_preLN__sliding_local_dilated__glu_gated_geglu__prompt_kernel_slowa
L_sequential_preLN__sliding_local_dilated__glu_gated_geglu__prompt_kernel_backa:
v_mfma_f32_16x16x32_bf16 a[124:127], a[184:187], v[44:47], a[124:127]
s_add_u32 s36, s36, s38
ds_read_b64_tr_b16 a[164:165], v3 offset:2048
v_fma_f32 v38, v38, v28, v28
v_fma_f32 v39, v39, v28, v28
v_mfma_f32_16x16x32_bf16 a[124:127], a[188:191], v[52:55], a[124:127]
s_waitcnt lgkmcnt(3)
ds_read_b64_tr_b16 a[166:167], v3 offset:3072
s_add_u32 s51, s34, 0
buffer_load_dwordx4 a[208:211], v30, s[20:23], s51 offen offset:0 sc1
v_mov_b32 v31, 4
buffer_store_dword v31, off, s[20:23], s43 sc1
v_mfma_f32_16x16x32_bf16 a[128:131], a[192:195], v[40:43], a[128:131]
ds_read_b64_tr_b16 a[168:169], v3 offset:4096
v_rcp_f32 v36, v36
v_mfma_f32_16x16x32_bf16 a[128:131], a[196:199], v[48:51], a[128:131]
ds_read_b64_tr_b16 a[170:171], v3 offset:5120
buffer_load_dwordx4 a[212:215], v30, s[20:23], s51 offen offset:1024 sc1
v_mfma_f32_16x16x32_bf16 a[132:135], a[192:195], v[44:47], a[132:135]
ds_read_b64_tr_b16 a[172:173], v3 offset:6144
v_rcp_f32 v37, v37
v_mfma_f32_16x16x32_bf16 a[132:135], a[196:199], v[52:55], a[132:135]
ds_read_b64_tr_b16 a[174:175], v3 offset:7168
buffer_load_dwordx4 a[216:219], v30, s[20:23], s51 offen offset:2048 sc1
v_mfma_f32_16x16x32_bf16 a[136:139], a[200:203], v[40:43], a[136:139]
ds_read_b64_tr_b16 a[176:177], v3 offset:8192
v_rcp_f32 v38, v38
v_mfma_f32_16x16x32_bf16 a[136:139], a[204:207], v[48:51], a[136:139]
ds_read_b64_tr_b16 a[178:179], v3 offset:9216
buffer_load_dwordx4 a[220:223], v30, s[20:23], s51 offen offset:3072 sc1
v_mfma_f32_16x16x32_bf16 a[140:143], a[200:203], v[44:47], a[140:143]
ds_read_b64_tr_b16 a[180:181], v3 offset:10240
v_rcp_f32 v39, v39
v_mfma_f32_16x16x32_bf16 a[140:143], a[204:207], v[52:55], a[140:143]
s_waitcnt lgkmcnt(5)
ds_read_b64_tr_b16 a[182:183], v3 offset:11264
v_mul_f32 v72, v72, v36
v_mfma_f32_16x16x32_bf16 v[96:99], a[160:163], v[128:131], 0
s_mov_b32 m0, s36
ds_read_b64_tr_b16 a[184:185], v3 offset:12288
v_mul_f32 v73, v73, v37
v_mfma_f32_16x16x32_bf16 v[96:99], a[164:167], v[136:139], v[96:99]
ds_read_b64_tr_b16 a[186:187], v3 offset:13312
v_mul_f32 v74, v74, v38
v_mfma_f32_16x16x32_bf16 v[96:99], a[168:171], v[144:147], v[96:99]
buffer_load_dwordx4 v15, s[16:19], s29 offen  lds
v_mfma_f32_16x16x32_bf16 v[100:103], a[160:163], v[132:135], 0
ds_read_b64_tr_b16 a[188:189], v3 offset:14336
ds_read_b64_tr_b16 a[190:191], v3 offset:15360
v_mul_f32 v75, v75, v39
v_mfma_f32_16x16x32_bf16 v[100:103], a[164:167], v[140:143], v[100:103]
ds_read_b64_tr_b16 a[192:193], v3 offset:16384
v_mul_f32 v36, v76, v76
v_mfma_f32_16x16x32_bf16 v[100:103], a[168:171], v[148:151], v[100:103]
s_waitcnt lgkmcnt(5)
ds_read_b64_tr_b16 a[194:195], v3 offset:17408
v_mul_f32 v37, v77, v77
v_mfma_f32_16x16x32_bf16 v[96:99], a[172:175], v[152:155], v[96:99]
s_add_u32 m0, s36, 1024
ds_read_b64_tr_b16 a[196:197], v3 offset:18432
v_mul_f32 v38, v78, v78
v_mfma_f32_16x16x32_bf16 v[96:99], a[176:179], v[160:163], v[96:99]
ds_read_b64_tr_b16 a[198:199], v3 offset:19456
v_mul_f32 v39, v79, v79
v_mfma_f32_16x16x32_bf16 v[96:99], a[180:183], v[168:171], v[96:99]
ds_read_b64_tr_b16 a[200:201], v3 offset:20480
v_fma_f32 v36, v36, v27, v25
v_mfma_f32_16x16x32_bf16 v[100:103], a[172:175], v[156:159], v[100:103]
buffer_load_dwordx4 v16, s[16:19], s29 offen  lds
v_fma_f32 v37, v37, v27, v25
v_mfma_f32_16x16x32_bf16 v[100:103], a[176:179], v[164:167], v[100:103]
ds_read_b64_tr_b16 a[202:203], v3 offset:21504
ds_read_b64_tr_b16 a[204:205], v3 offset:22528
v_fma_f32 v38, v38, v27, v25
v_mfma_f32_16x16x32_bf16 v[100:103], a[180:183], v[172:175], v[100:103]
s_waitcnt lgkmcnt(5)
ds_read_b64_tr_b16 a[206:207], v3 offset:23552
v_fma_f32 v39, v39, v27, v25
v_mfma_f32_16x16x32_bf16 v[96:99], a[184:187], v[176:179], v[96:99]
ds_read_b64_tr_b16 a[160:161], v3 offset:24576
v_mul_f32 v36, v76, v36
v_mfma_f32_16x16x32_bf16 v[96:99], a[188:191], v[184:187], v[96:99]
s_add_u32 m0, s36, 2048
ds_read_b64_tr_b16 a[162:163], v3 offset:25600
v_mul_f32 v37, v77, v37
v_mfma_f32_16x16x32_bf16 v[96:99], a[192:195], v[192:195], v[96:99]
ds_read_b64_tr_b16 a[164:165], v3 offset:26624
v_mul_f32 v38, v78, v38
v_mfma_f32_16x16x32_bf16 v[100:103], a[184:187], v[180:183], v[100:103]
ds_read_b64_tr_b16 a[166:167], v3 offset:27648
v_mul_f32 v39, v79, v39
v_mfma_f32_16x16x32_bf16 v[100:103], a[188:191], v[188:191], v[100:103]
buffer_load_dwordx4 v17, s[16:19], s29 offen  lds
v_mfma_f32_16x16x32_bf16 v[100:103], a[192:195], v[196:199], v[100:103]
s_waitcnt lgkmcnt(4)
ds_read_b64_tr_b16 a[168:169], v3 offset:28672
ds_read_b64_tr_b16 a[170:171], v3 offset:29696
v_mfma_f32_16x16x32_bf16 v[96:99], a[196:199], v[200:203], v[96:99]
ds_read_b64_tr_b16 a[172:173], v3 offset:30720
v_exp_f32 v36, v36
v_mfma_f32_16x16x32_bf16 v[96:99], a[200:203], v[208:211], v[96:99]
ds_read_b64_tr_b16 a[174:175], v3 offset:31744
v_exp_f32 v37, v37
v_mfma_f32_16x16x32_bf16 v[96:99], a[204:207], v[216:219], v[96:99]
s_add_u32 m0, s36, 3072
ds_read_b64_tr_b16 a[176:177], v3 offset:32768
v_mfma_f32_16x16x32_bf16 v[100:103], a[196:199], v[204:207], v[100:103]
ds_read_b64_tr_b16 a[178:179], v3 offset:33792
v_exp_f32 v38, v38
v_mfma_f32_16x16x32_bf16 v[100:103], a[200:203], v[212:215], v[100:103]
ds_read_b64_tr_b16 a[180:181], v3 offset:34816
v_mfma_f32_16x16x32_bf16 v[100:103], a[204:207], v[220:223], v[100:103]
s_waitcnt lgkmcnt(5)
buffer_load_dwordx4 v18, s[16:19], s29 offen  lds
v_mfma_f32_16x16x32_bf16 v[96:99], a[160:163], v[224:227], v[96:99]
ds_read_b64_tr_b16 a[182:183], v3 offset:35840
ds_read_b64_tr_b16 a[184:185], v3 offset:512
v_mfma_f32_16x16x32_bf16 v[96:99], a[164:167], v[232:235], v[96:99]
ds_read_b64_tr_b16 a[186:187], v3 offset:1536
v_exp_f32 v39, v39
v_mfma_f32_16x16x32_bf16 v[96:99], a[168:171], v[240:243], v[96:99]
ds_read_b64_tr_b16 a[188:189], v3 offset:2560
v_fma_f32 v36, v36, v29, v29
v_fma_f32 v37, v37, v29, v29
v_mfma_f32_16x16x32_bf16 v[100:103], a[160:163], v[228:231], v[100:103]
s_add_u32 m0, s36, 4096
ds_read_b64_tr_b16 a[190:191], v3 offset:3584
v_fma_f32 v38, v38, v29, v29
v_mfma_f32_16x16x32_bf16 v[100:103], a[164:167], v[236:239], v[100:103]
ds_read_b64_tr_b16 a[192:193], v3 offset:4608
v_fma_f32 v39, v39, v29, v29
v_mfma_f32_16x16x32_bf16 v[100:103], a[168:171], v[244:247], v[100:103]
s_waitcnt lgkmcnt(5)
ds_read_b64_tr_b16 a[194:195], v3 offset:5632
v_rcp_f32 v36, v36
v_mfma_f32_16x16x32_bf16 v[96:99], a[172:175], v[248:251], v[96:99]
buffer_load_dwordx4 v19, s[16:19], s29 offen  lds
v_mfma_f32_16x16x32_bf16 v[96:99], a[176:179], a[144:147], v[96:99]
ds_read_b64_tr_b16 a[196:197], v3 offset:6656
ds_read_b64_tr_b16 a[198:199], v3 offset:7680
v_mfma_f32_16x16x32_bf16 v[96:99], a[180:183], a[152:155], v[96:99]
ds_read_b64_tr_b16 a[200:201], v3 offset:8704
v_rcp_f32 v37, v37
v_mfma_f32_16x16x32_bf16 v[100:103], a[172:175], v[252:255], v[100:103]
ds_read_b64_tr_b16 a[202:203], v3 offset:9728
v_rcp_f32 v38, v38
v_mfma_f32_16x16x32_bf16 v[100:103], a[176:179], a[148:151], v[100:103]
s_add_u32 m0, s36, 5120
ds_read_b64_tr_b16 a[204:205], v3 offset:10752
v_mfma_f32_16x16x32_bf16 v[100:103], a[180:183], a[156:159], v[100:103]
s_waitcnt lgkmcnt(5)
ds_read_b64_tr_b16 a[206:207], v3 offset:11776
v_rcp_f32 v39, v39
v_mfma_f32_16x16x32_bf16 v[104:107], a[184:187], v[128:131], 0
ds_read_b64_tr_b16 a[160:161], v3 offset:12800
v_mul_f32 v76, v76, v36
v_mfma_f32_16x16x32_bf16 v[104:107], a[188:191], v[136:139], v[104:107]
buffer_load_dwordx4 v20, s[16:19], s29 offen  lds
v_mfma_f32_16x16x32_bf16 v[104:107], a[192:195], v[144:147], v[104:107]
ds_read_b64_tr_b16 a[162:163], v3 offset:13824
ds_read_b64_tr_b16 a[164:165], v3 offset:14848
v_mul_f32 v77, v77, v37
v_mfma_f32_16x16x32_bf16 v[108:111], a[184:187], v[132:135], 0
ds_read_b64_tr_b16 a[166:167], v3 offset:15872
v_mul_f32 v64, v64, v96
v_mul_f32 v78, v78, v38
v_mfma_f32_16x16x32_bf16 v[108:111], a[188:191], v[140:143], v[108:111]
ds_read_b64_tr_b16 a[168:169], v3 offset:16896
v_mul_f32 v65, v65, v97
v_mul_f32 v79, v79, v39
v_mfma_f32_16x16x32_bf16 v[108:111], a[192:195], v[148:151], v[108:111]
s_waitcnt lgkmcnt(5)
ds_read_b64_tr_b16 a[170:171], v3 offset:17920
v_mul_f32 v66, v66, v98
v_mfma_f32_16x16x32_bf16 v[104:107], a[196:199], v[152:155], v[104:107]
s_add_u32 m0, s36, 6144
ds_read_b64_tr_b16 a[172:173], v3 offset:18944
v_mul_f32 v67, v67, v99
v_mfma_f32_16x16x32_bf16 v[104:107], a[200:203], v[160:163], v[104:107]
ds_read_b64_tr_b16 a[174:175], v3 offset:19968
v_mul_f32 v68, v68, v100
v_mfma_f32_16x16x32_bf16 v[104:107], a[204:207], v[168:171], v[104:107]
buffer_load_dwordx4 v21, s[16:19], s29 offen  lds
v_mfma_f32_16x16x32_bf16 v[108:111], a[196:199], v[156:159], v[108:111]
ds_read_b64_tr_b16 a[176:177], v3 offset:20992
ds_read_b64_tr_b16 a[178:179], v3 offset:22016
v_mfma_f32_16x16x32_bf16 v[108:111], a[200:203], v[164:167], v[108:111]
s_add_u32 s97, s97, 1
ds_read_b64_tr_b16 a[180:181], v3 offset:23040
v_mul_f32 v69, v69, v101
v_mfma_f32_16x16x32_bf16 v[108:111], a[204:207], v[172:175], v[108:111]
s_waitcnt lgkmcnt(5)
ds_read_b64_tr_b16 a[182:183], v3 offset:24064
v_mul_f32 v70, v70, v102
v_mfma_f32_16x16x32_bf16 v[104:107], a[160:163], v[176:179], v[104:107]
s_add_u32 m0, s36, 7168
ds_read_b64_tr_b16 a[184:185], v3 offset:25088
v_mul_f32 v71, v71, v103
s_and_b32 s97, s97, 3
s_mul_i32 s39, s97, 36864
v_mfma_f32_16x16x32_bf16 v[104:107], a[164:167], v[184:187], v[104:107]
ds_read_b64_tr_b16 a[186:187], v3 offset:26112
v_cvt_pk_bf16_f32 v56, v64, v65
v_mfma_f32_16x16x32_bf16 v[104:107], a[168:171], v[192:195], v[104:107]
ds_read_b64_tr_b16 a[188:189], v3 offset:27136
v_cvt_pk_bf16_f32 v57, v66, v67
v_mfma_f32_16x16x32_bf16 v[108:111], a[160:163], v[180:183], v[108:111]
buffer_load_dwordx4 v22, s[16:19], s29 offen  lds
v_mfma_f32_16x16x32_bf16 v[108:111], a[164:167], v[188:191], v[108:111]
s_add_u32 s42, s33, 4096
ds_read_b64_tr_b16 a[190:191], v3 offset:28160
ds_read_b64_tr_b16 a[192:193], v3 offset:29184
v_mfma_f32_16x16x32_bf16 v[108:111], a[168:171], v[196:199], v[108:111]
s_waitcnt lgkmcnt(5)
ds_read_b64_tr_b16 a[194:195], v3 offset:30208
v_cvt_pk_bf16_f32 v60, v68, v69
v_mfma_f32_16x16x32_bf16 v[104:107], a[172:175], v[200:203], v[104:107]
ds_read_b64_tr_b16 a[196:197], v3 offset:31232
v_cvt_pk_bf16_f32 v61, v70, v71
v_mfma_f32_16x16x32_bf16 v[104:107], a[176:179], v[208:211], v[104:107]
s_add_u32 m0, s36, 8192
ds_read_b64_tr_b16 a[198:199], v3 offset:32256
v_mfma_f32_16x16x32_bf16 v[104:107], a[180:183], v[216:219], v[104:107]
ds_read_b64_tr_b16 a[200:201], v3 offset:33280
v_mfma_f32_16x16x32_bf16 v[108:111], a[172:175], v[204:207], v[108:111]
ds_read_b64_tr_b16 a[202:203], v3 offset:34304
v_mfma_f32_16x16x32_bf16 v[108:111], a[176:179], v[212:215], v[108:111]
s_waitcnt vmcnt(13)
buffer_load_dwordx4 v23, s[16:19], s29 offen  lds
s_barrier
v_mfma_f32_16x16x32_bf16 v[108:111], a[180:183], v[220:223], v[108:111]
s_waitcnt lgkmcnt(4)
ds_read_b64_tr_b16 a[204:205], v3 offset:35328
ds_read_b64_tr_b16 a[206:207], v3 offset:36352
v_add_u32 v3, s39, v7
v_add_u32 v4, s39, v8
v_mfma_f32_16x16x32_bf16 v[104:107], a[184:187], v[224:227], v[104:107]
s_add_u32 s96, s96, 1
ds_read_b64_tr_b16 a[160:161], v3 offset:0
v_mfma_f32_16x16x32_bf16 v[104:107], a[188:191], v[232:235], v[104:107]
s_and_b32 s96, s96, 3
ds_read_b64_tr_b16 a[162:163], v3 offset:9216
s_mul_i32 s36, s96, 36864
s_add_u32 s36, s36, s38
v_mfma_f32_16x16x32_bf16 v[104:107], a[192:195], v[240:243], v[104:107]
ds_read_b64_tr_b16 a[164:165], v3 offset:18432
s_add_u32 s51, s34, 4096
buffer_load_dwordx4 a[224:227], v30, s[20:23], s51 offen offset:0 sc1
v_mfma_f32_16x16x32_bf16 v[108:111], a[184:187], v[228:231], v[108:111]
ds_read_b64_tr_b16 a[166:167], v3 offset:27648
v_mfma_f32_16x16x32_bf16 v[108:111], a[188:191], v[236:239], v[108:111]
ds_read_b64_tr_b16 a[168:169], v4 offset:128
buffer_load_dwordx4 a[228:231], v30, s[20:23], s51 offen offset:1024 sc1
v_mfma_f32_16x16x32_bf16 v[108:111], a[192:195], v[244:247], v[108:111]
s_waitcnt lgkmcnt(5)
ds_read_b64_tr_b16 a[170:171], v4 offset:9344
v_mfma_f32_16x16x32_bf16 v[104:107], a[196:199], v[248:251], v[104:107]
ds_read_b64_tr_b16 a[172:173], v4 offset:18560
buffer_load_dwordx4 a[232:235], v30, s[20:23], s51 offen offset:2048 sc1
v_mfma_f32_16x16x32_bf16 v[104:107], a[200:203], a[144:147], v[104:107]
ds_read_b64_tr_b16 a[174:175], v4 offset:27776
v_mfma_f32_16x16x32_bf16 v[104:107], a[204:207], a[152:155], v[104:107]
ds_read_b64_tr_b16 a[176:177], v3 offset:256
buffer_load_dwordx4 a[236:239], v30, s[20:23], s51 offen offset:3072 sc1
s_waitcnt vmcnt(13)
v_mfma_f32_16x16x32_bf16 v[108:111], a[196:199], v[252:255], v[108:111]
ds_read_b64_tr_b16 a[178:179], v3 offset:9472
v_mfma_f32_16x16x32_bf16 v[108:111], a[200:203], a[148:151], v[108:111]
ds_read_b64_tr_b16 a[180:181], v3 offset:18688
v_mfma_f32_16x16x32_bf16 v[108:111], a[204:207], a[156:159], v[108:111]
s_waitcnt lgkmcnt(3)
ds_read_b64_tr_b16 a[182:183], v3 offset:27904
v_mfma_f32_16x16x32_bf16 a[0:3], a[160:163], a[208:211], a[0:3]
s_mov_b32 m0, s36
ds_read_b64_tr_b16 a[184:185], v4 offset:384
v_mfma_f32_16x16x32_bf16 a[0:3], a[164:167], a[216:219], a[0:3]
ds_read_b64_tr_b16 a[186:187], v4 offset:9600
v_mfma_f32_16x16x32_bf16 a[4:7], a[160:163], a[212:215], a[4:7]
buffer_load_dwordx4 v15, s[16:19], s30 offen  lds
v_bfe_u32 v170, v0, 1, 2
v_mfma_f32_16x16x32_bf16 a[4:7], a[164:167], a[220:223], a[4:7]
ds_read_b64_tr_b16 a[188:189], v4 offset:18816
ds_read_b64_tr_b16 a[190:191], v4 offset:28032
v_mul_u32_u24 v170, 1152, v170
v_mfma_f32_16x16x32_bf16 a[8:11], a[168:171], a[208:211], a[8:11]
ds_read_b64_tr_b16 a[192:193], v3 offset:512
v_mul_f32 v72, v72, v104
v_and_b32 v171, 1, v0
v_mfma_f32_16x16x32_bf16 a[8:11], a[172:175], a[216:219], a[8:11]
ds_read_b64_tr_b16 a[194:195], v3 offset:9728
v_mul_f32 v73, v73, v105
v_lshl_add_u32 v170, v171, 4, v170
v_mfma_f32_16x16x32_bf16 a[12:15], a[168:171], a[212:215], a[12:15]
s_add_u32 m0, s36, 1024
ds_read_b64_tr_b16 a[196:197], v3 offset:18944
v_mul_f32 v74, v74, v106
v_lshrrev_b32 v171, 3, v0
v_mfma_f32_16x16x32_bf16 a[12:15], a[172:175], a[220:223], a[12:15]
s_waitcnt lgkmcnt(3)
ds_read_b64_tr_b16 a[198:199], v3 offset:28160
v_mul_f32 v75, v75, v107
v_add_u32 v160, 0, v171
v_mfma_f32_16x16x32_bf16 a[16:19], a[176:179], a[208:211], a[16:19]
ds_read_b64_tr_b16 a[200:201], v4 offset:640
v_mul_f32 v76, v76, v108
v_mul_u32_u24 v172, 57, v160
v_mfma_f32_16x16x32_bf16 a[16:19], a[180:183], a[216:219], a[16:19]
buffer_load_dwordx4 v16, s[16:19], s30 offen  lds
v_lshrrev_b32 v172, 9, v172
v_mfma_f32_16x16x32_bf16 a[20:23], a[176:179], a[212:215], a[20:23]
ds_read_b64_tr_b16 a[202:203], v4 offset:9856
ds_read_b64_tr_b16 a[204:205], v4 offset:19072
v_mul_f32 v77, v77, v109
v_mfma_f32_16x16x32_bf16 a[20:23], a[180:183], a[220:223], a[20:23]
ds_read_b64_tr_b16 a[206:207], v4 offset:28288
v_mul_f32 v78, v78, v110
v_mul_u32_u24 v173, 9, v172
v_mfma_f32_16x16x32_bf16 a[24:27], a[184:187], a[208:211], a[24:27]
ds_read_b64_tr_b16 a[160:161], v3 offset:768
v_mul_f32 v79, v79, v111
v_sub_u32 v160, v160, v173
v_mfma_f32_16x16x32_bf16 a[24:27], a[188:191], a[216:219], a[24:27]
s_add_u32 m0, s36, 2048
ds_read_b64_tr_b16 a[162:163], v3 offset:9984
v_cvt_pk_bf16_f32 v58, v72, v73
v_mul_u32_u24 v172, 4608, v172
v_mfma_f32_16x16x32_bf16 a[28:31], a[184:187], a[212:215], a[28:31]
ds_read_b64_tr_b16 a[164:165], v3 offset:19200
v_cvt_pk_bf16_f32 v59, v74, v75
v_lshl_add_u32 v160, v160, 5, v172
v_mfma_f32_16x16x32_bf16 a[28:31], a[188:191], a[220:223], a[28:31]
s_waitcnt lgkmcnt(3)
ds_read_b64_tr_b16 a[166:167], v3 offset:28416
v_cvt_pk_bf16_f32 v62, v76, v77
v_add_u32 v160, v160, v170
v_mfma_f32_16x16x32_bf16 a[32:35], a[192:195], a[208:211], a[32:35]
buffer_load_dwordx4 v17, s[16:19], s30 offen  lds
v_add_u32 v161, 8, v171
v_mfma_f32_16x16x32_bf16 a[32:35], a[196:199], a[216:219], a[32:35]
ds_read_b64_tr_b16 a[168:169], v4 offset:896
ds_read_b64_tr_b16 a[170:171], v4 offset:10112
v_cvt_pk_bf16_f32 v63, v78, v79
v_mfma_f32_16x16x32_bf16 a[36:39], a[192:195], a[212:215], a[36:39]
ds_read_b64_tr_b16 a[172:173], v4 offset:19328
v_mul_u32_u24 v172, 57, v161
v_lshrrev_b32 v172, 9, v172
v_mfma_f32_16x16x32_bf16 a[36:39], a[196:199], a[220:223], a[36:39]
ds_read_b64_tr_b16 a[174:175], v4 offset:28544
v_mul_u32_u24 v173, 9, v172
v_sub_u32 v161, v161, v173
v_mfma_f32_16x16x32_bf16 a[40:43], a[200:203], a[208:211], a[40:43]
s_add_u32 m0, s36, 3072
ds_read_b64_tr_b16 a[176:177], v3 offset:1024
v_mul_u32_u24 v172, 4608, v172
v_lshl_add_u32 v161, v161, 5, v172
v_mfma_f32_16x16x32_bf16 a[40:43], a[204:207], a[216:219], a[40:43]
ds_read_b64_tr_b16 a[178:179], v3 offset:10240
v_add_u32 v161, v161, v170
v_add_u32 v162, 16, v171
v_mfma_f32_16x16x32_bf16 a[44:47], a[200:203], a[212:215], a[44:47]
ds_read_b64_tr_b16 a[180:181], v3 offset:19456
v_mul_u32_u24 v172, 57, v162
v_lshrrev_b32 v172, 9, v172
v_mfma_f32_16x16x32_bf16 a[44:47], a[204:207], a[220:223], a[44:47]
s_waitcnt lgkmcnt(3)
buffer_load_dwordx4 v18, s[16:19], s30 offen  lds
v_mul_u32_u24 v173, 9, v172
v_mfma_f32_16x16x32_bf16 a[48:51], a[160:163], a[208:211], a[48:51]
ds_read_b64_tr_b16 a[182:183], v3 offset:28672
ds_read_b64_tr_b16 a[184:185], v4 offset:1152
v_sub_u32 v162, v162, v173
v_mfma_f32_16x16x32_bf16 a[48:51], a[164:167], a[216:219], a[48:51]
ds_read_b64_tr_b16 a[186:187], v4 offset:10368
v_mul_u32_u24 v172, 4608, v172
buffer_store_dwordx4 v[56:59], v30, s[20:23], s42 offen offset:0 sc1
v_mfma_f32_16x16x32_bf16 a[52:55], a[160:163], a[212:215], a[52:55]
ds_read_b64_tr_b16 a[188:189], v4 offset:19584
v_lshl_add_u32 v162, v162, 5, v172
v_add_u32 v162, v162, v170
v_mfma_f32_16x16x32_bf16 a[52:55], a[164:167], a[220:223], a[52:55]
s_add_u32 m0, s36, 4096
ds_read_b64_tr_b16 a[190:191], v4 offset:28800
v_add_u32 v163, 24, v171
buffer_store_dwordx4 v[60:63], v30, s[20:23], s42 offen offset:1024 sc1
v_mfma_f32_16x16x32_bf16 a[56:59], a[168:171], a[208:211], a[56:59]
ds_read_b64_tr_b16 a[192:193], v3 offset:1280
v_mul_u32_u24 v172, 57, v163
v_lshrrev_b32 v172, 9, v172
v_mfma_f32_16x16x32_bf16 a[56:59], a[172:175], a[216:219], a[56:59]
ds_read_b64_tr_b16 a[194:195], v3 offset:10496
v_mul_u32_u24 v173, 9, v172
v_sub_u32 v163, v163, v173
v_mfma_f32_16x16x32_bf16 a[60:63], a[168:171], a[212:215], a[60:63]
buffer_load_dwordx4 v19, s[16:19], s30 offen  lds
v_mul_u32_u24 v172, 4608, v172
v_mfma_f32_16x16x32_bf16 a[60:63], a[172:175], a[220:223], a[60:63]
s_waitcnt lgkmcnt(2)
ds_read_b64_tr_b16 a[196:197], v3 offset:19712
ds_read_b64_tr_b16 a[198:199], v3 offset:28928
v_lshl_add_u32 v163, v163, 5, v172
v_mfma_f32_16x16x32_bf16 a[64:67], a[176:179], a[208:211], a[64:67]
ds_read_b64_tr_b16 a[200:201], v4 offset:1408
v_add_u32 v163, v163, v170
v_add_u32 v164, 32, v171
v_mfma_f32_16x16x32_bf16 a[64:67], a[180:183], a[216:219], a[64:67]
ds_read_b64_tr_b16 a[202:203], v4 offset:10624
v_mul_u32_u24 v172, 57, v164
v_lshrrev_b32 v172, 9, v172
v_mfma_f32_16x16x32_bf16 a[68:71], a[176:179], a[212:215], a[68:71]
s_add_u32 m0, s36, 5120
ds_read_b64_tr_b16 a[204:205], v4 offset:19840
v_mul_u32_u24 v173, 9, v172
v_sub_u32 v164, v164, v173
v_mfma_f32_16x16x32_bf16 a[68:71], a[180:183], a[220:223], a[68:71]
ds_read_b64_tr_b16 a[206:207], v4 offset:29056
v_mul_u32_u24 v172, 4608, v172
v_lshl_add_u32 v164, v164, 5, v172
v_mfma_f32_16x16x32_bf16 a[72:75], a[184:187], a[208:211], a[72:75]
ds_read_b64_tr_b16 a[160:161], v3 offset:1536
v_add_u32 v164, v164, v170
v_add_u32 v165, 40, v171
v_mfma_f32_16x16x32_bf16 a[72:75], a[188:191], a[216:219], a[72:75]
buffer_load_dwordx4 v20, s[16:19], s30 offen  lds
v_mul_u32_u24 v172, 57, v165
v_mfma_f32_16x16x32_bf16 a[76:79], a[184:187], a[212:215], a[76:79]
ds_read_b64_tr_b16 a[162:163], v3 offset:10752
ds_read_b64_tr_b16 a[164:165], v3 offset:19968
v_lshrrev_b32 v172, 9, v172
v_mfma_f32_16x16x32_bf16 a[76:79], a[188:191], a[220:223], a[76:79]
s_waitcnt lgkmcnt(3)
ds_read_b64_tr_b16 a[166:167], v3 offset:29184
v_mul_u32_u24 v173, 9, v172
v_sub_u32 v165, v165, v173
v_mfma_f32_16x16x32_bf16 a[80:83], a[192:195], a[208:211], a[80:83]
ds_read_b64_tr_b16 a[168:169], v4 offset:1664
v_mul_u32_u24 v172, 4608, v172
v_lshl_add_u32 v165, v165, 5, v172
v_mfma_f32_16x16x32_bf16 a[80:83], a[196:199], a[216:219], a[80:83]
s_add_u32 m0, s36, 6144
ds_read_b64_tr_b16 a[170:171], v4 offset:10880
v_add_u32 v165, v165, v170
v_mfma_f32_16x16x32_bf16 a[84:87], a[192:195], a[212:215], a[84:87]
ds_read_b64_tr_b16 a[172:173], v4 offset:20096
v_add_u32 v166, 48, v171
v_mul_u32_u24 v172, 57, v166
v_mfma_f32_16x16x32_bf16 a[84:87], a[196:199], a[220:223], a[84:87]
ds_read_b64_tr_b16 a[174:175], v4 offset:29312
v_lshrrev_b32 v172, 9, v172
v_mfma_f32_16x16x32_bf16 a[88:91], a[200:203], a[208:211], a[88:91]
buffer_load_dwordx4 v21, s[16:19], s30 offen  lds
v_mul_u32_u24 v173, 9, v172
v_mfma_f32_16x16x32_bf16 a[88:91], a[204:207], a[216:219], a[88:91]
ds_read_b64_tr_b16 a[176:177], v3 offset:1792
ds_read_b64_tr_b16 a[178:179], v3 offset:11008
v_sub_u32 v166, v166, v173
v_mfma_f32_16x16x32_bf16 a[92:95], a[200:203], a[212:215], a[92:95]
s_add_u32 s97, s97, 1
ds_read_b64_tr_b16 a[180:181], v3 offset:20224
v_mul_u32_u24 v172, 4608, v172
v_lshl_add_u32 v166, v166, 5, v172
v_mfma_f32_16x16x32_bf16 a[92:95], a[204:207], a[220:223], a[92:95]
s_waitcnt lgkmcnt(3)
ds_read_b64_tr_b16 a[182:183], v3 offset:29440
v_add_u32 v166, v166, v170
v_mfma_f32_16x16x32_bf16 a[96:99], a[160:163], a[208:211], a[96:99]
s_add_u32 m0, s36, 7168
ds_read_b64_tr_b16 a[184:185], v4 offset:1920
v_add_u32 v167, 56, v171
s_and_b32 s97, s97, 3
s_mul_i32 s39, s97, 36864
v_mfma_f32_16x16x32_bf16 a[96:99], a[164:167], a[216:219], a[96:99]
ds_read_b64_tr_b16 a[186:187], v4 offset:11136
v_mul_u32_u24 v172, 57, v167
v_lshrrev_b32 v172, 9, v172
v_mfma_f32_16x16x32_bf16 a[100:103], a[160:163], a[212:215], a[100:103]
ds_read_b64_tr_b16 a[188:189], v4 offset:20352
v_mul_u32_u24 v173, 9, v172
v_mfma_f32_16x16x32_bf16 a[100:103], a[164:167], a[220:223], a[100:103]
buffer_load_dwordx4 v22, s[16:19], s30 offen  lds
v_sub_u32 v167, v167, v173
v_mfma_f32_16x16x32_bf16 a[104:107], a[168:171], a[208:211], a[104:107]
ds_read_b64_tr_b16 a[190:191], v4 offset:29568
ds_read_b64_tr_b16 a[192:193], v3 offset:2048
v_mul_u32_u24 v172, 4608, v172
v_mfma_f32_16x16x32_bf16 a[104:107], a[172:175], a[216:219], a[104:107]
ds_read_b64_tr_b16 a[194:195], v3 offset:11264
v_lshl_add_u32 v167, v167, 5, v172
v_add_u32 v167, v167, v170
v_mfma_f32_16x16x32_bf16 a[108:111], a[168:171], a[212:215], a[108:111]
ds_read_b64_tr_b16 a[196:197], v3 offset:20480
v_add_u32 v168, 64, v171
v_mfma_f32_16x16x32_bf16 a[108:111], a[172:175], a[220:223], a[108:111]
s_waitcnt lgkmcnt(3)
ds_read_b64_tr_b16 a[198:199], v3 offset:29696
v_mul_u32_u24 v172, 57, v168
v_lshrrev_b32 v172, 9, v172
v_mfma_f32_16x16x32_bf16 a[112:115], a[176:179], a[208:211], a[112:115]
s_add_u32 m0, s36, 8192
ds_read_b64_tr_b16 a[200:201], v4 offset:2176
v_mul_u32_u24 v173, 9, v172
v_mfma_f32_16x16x32_bf16 a[112:115], a[180:183], a[216:219], a[112:115]
ds_read_b64_tr_b16 a[202:203], v4 offset:11392
v_sub_u32 v168, v168, v173
v_mfma_f32_16x16x32_bf16 a[116:119], a[176:179], a[212:215], a[116:119]
s_waitcnt vmcnt(14)
buffer_load_dwordx4 v23, s[16:19], s30 offen  lds
s_barrier
v_mfma_f32_16x16x32_bf16 a[116:119], a[180:183], a[220:223], a[116:119]
s_add_u32 s96, s96, 1
ds_read_b64_tr_b16 a[204:205], v4 offset:20608
ds_read_b64_tr_b16 a[206:207], v4 offset:29824
v_add_u32 v3, s39, v7
v_add_u32 v4, s39, v8
v_mfma_f32_16x16x32_bf16 a[120:123], a[184:187], a[208:211], a[120:123]
s_and_b32 s96, s96, 3
ds_read_b64_tr_b16 a[160:161], v3 offset:0
v_mul_u32_u24 v172, 4608, v172
v_lshl_add_u32 v168, v168, 5, v172
v_mfma_f32_16x16x32_bf16 a[120:123], a[188:191], a[216:219], a[120:123]
s_mul_i32 s36, s96, 36864
ds_read_b64_tr_b16 a[162:163], v3 offset:9216
v_add_u32 v168, v168, v170
v_lshrrev_b32 v171, 4, v0
s_add_u32 s36, s36, s38
v_mfma_f32_16x16x32_bf16 a[124:127], a[184:187], a[212:215], a[124:127]
ds_read_b64_tr_b16 a[164:165], v3 offset:18432
s_add_u32 s51, s34, 8192
buffer_load_dwordx4 a[240:243], v30, s[20:23], s51 offen offset:0 sc1
v_mfma_f32_16x16x32_bf16 a[124:127], a[188:191], a[220:223], a[124:127]
s_waitcnt lgkmcnt(3)
ds_read_b64_tr_b16 a[166:167], v3 offset:27648
v_mul_u32_u24 v171, 1152, v171
v_bfe_u32 v172, v0, 2, 2
v_mfma_f32_16x16x32_bf16 a[128:131], a[192:195], a[208:211], a[128:131]
ds_read_b64_tr_b16 a[168:169], v4 offset:128
buffer_load_dwordx4 a[244:247], v30, s[20:23], s51 offen offset:1024 sc1
v_mfma_f32_16x16x32_bf16 a[128:131], a[196:199], a[216:219], a[128:131]
ds_read_b64_tr_b16 a[170:171], v4 offset:9344
v_lshl_add_u32 v171, v172, 5, v171
v_and_b32 v172, 3, v0
v_mfma_f32_16x16x32_bf16 a[132:135], a[192:195], a[212:215], a[132:135]
ds_read_b64_tr_b16 a[172:173], v4 offset:18560
buffer_load_dwordx4 a[248:251], v30, s[20:23], s51 offen offset:2048 sc1
v_mfma_f32_16x16x32_bf16 a[132:135], a[196:199], a[220:223], a[132:135]
ds_read_b64_tr_b16 a[174:175], v4 offset:27776
v_lshl_add_u32 v169, v172, 3, v171
v_mfma_f32_16x16x32_bf16 a[136:139], a[200:203], a[208:211], a[136:139]
ds_read_b64_tr_b16 a[176:177], v3 offset:256
buffer_load_dwordx4 a[252:255], v30, s[20:23], s51 offen offset:3072 sc1
s_waitcnt vmcnt(15)
v_mfma_f32_16x16x32_bf16 a[136:139], a[204:207], a[216:219], a[136:139]
ds_read_b64_tr_b16 a[178:179], v3 offset:9472
v_mfma_f32_16x16x32_bf16 a[140:143], a[200:203], a[212:215], a[140:143]
ds_read_b64_tr_b16 a[180:181], v3 offset:18688
v_mfma_f32_16x16x32_bf16 a[140:143], a[204:207], a[220:223], a[140:143]
s_waitcnt lgkmcnt(3)
ds_read_b64_tr_b16 a[182:183], v3 offset:27904
v_mfma_f32_16x16x32_bf16 a[0:3], a[160:163], a[224:227], a[0:3]
s_mov_b32 m0, s36
ds_read_b64_tr_b16 a[184:185], v4 offset:384
v_mfma_f32_16x16x32_bf16 a[0:3], a[164:167], a[232:235], a[0:3]
ds_read_b64_tr_b16 a[186:187], v4 offset:9600
v_mfma_f32_16x16x32_bf16 a[4:7], a[160:163], a[228:231], a[4:7]
buffer_load_dwordx4 v160, s[16:19], s31 offen lds
v_mfma_f32_16x16x32_bf16 a[4:7], a[164:167], a[236:239], a[4:7]
ds_read_b64_tr_b16 a[188:189], v4 offset:18816
ds_read_b64_tr_b16 a[190:191], v4 offset:28032
v_mfma_f32_16x16x32_bf16 a[8:11], a[168:171], a[224:227], a[8:11]
ds_read_b64_tr_b16 a[192:193], v3 offset:512
v_mfma_f32_16x16x32_bf16 a[8:11], a[172:175], a[232:235], a[8:11]
ds_read_b64_tr_b16 a[194:195], v3 offset:9728
v_mfma_f32_16x16x32_bf16 a[12:15], a[168:171], a[228:231], a[12:15]
s_add_u32 m0, s36, 1024
ds_read_b64_tr_b16 a[196:197], v3 offset:18944
v_mfma_f32_16x16x32_bf16 a[12:15], a[172:175], a[236:239], a[12:15]
s_waitcnt lgkmcnt(3)
ds_read_b64_tr_b16 a[198:199], v3 offset:28160
v_mfma_f32_16x16x32_bf16 a[16:19], a[176:179], a[224:227], a[16:19]
ds_read_b64_tr_b16 a[200:201], v4 offset:640
s_waitcnt vmcnt(10)
v_mov_b32 v31, 5
buffer_store_dword v31, off, s[20:23], s43 sc1
v_mfma_f32_16x16x32_bf16 a[16:19], a[180:183], a[232:235], a[16:19]
buffer_load_dwordx4 v161, s[16:19], s31 offen lds
v_mfma_f32_16x16x32_bf16 a[20:23], a[176:179], a[228:231], a[20:23]
ds_read_b64_tr_b16 a[202:203], v4 offset:9856
ds_read_b64_tr_b16 a[204:205], v4 offset:19072
v_mfma_f32_16x16x32_bf16 a[20:23], a[180:183], a[236:239], a[20:23]
ds_read_b64_tr_b16 a[206:207], v4 offset:28288
v_mfma_f32_16x16x32_bf16 a[24:27], a[184:187], a[224:227], a[24:27]
ds_read_b64_tr_b16 a[160:161], v3 offset:768
v_mfma_f32_16x16x32_bf16 a[24:27], a[188:191], a[232:235], a[24:27]
s_add_u32 m0, s36, 2048
ds_read_b64_tr_b16 a[162:163], v3 offset:9984
v_mfma_f32_16x16x32_bf16 a[28:31], a[184:187], a[228:231], a[28:31]
ds_read_b64_tr_b16 a[164:165], v3 offset:19200
v_mfma_f32_16x16x32_bf16 a[28:31], a[188:191], a[236:239], a[28:31]
s_waitcnt lgkmcnt(3)
ds_read_b64_tr_b16 a[166:167], v3 offset:28416
v_mfma_f32_16x16x32_bf16 a[32:35], a[192:195], a[224:227], a[32:35]
buffer_load_dwordx4 v162, s[16:19], s31 offen lds
v_mfma_f32_16x16x32_bf16 a[32:35], a[196:199], a[232:235], a[32:35]
ds_read_b64_tr_b16 a[168:169], v4 offset:896
ds_read_b64_tr_b16 a[170:171], v4 offset:10112
v_mfma_f32_16x16x32_bf16 a[36:39], a[192:195], a[228:231], a[36:39]
ds_read_b64_tr_b16 a[172:173], v4 offset:19328
v_mfma_f32_16x16x32_bf16 a[36:39], a[196:199], a[236:239], a[36:39]
ds_read_b64_tr_b16 a[174:175], v4 offset:28544
v_mfma_f32_16x16x32_bf16 a[40:43], a[200:203], a[224:227], a[40:43]
s_add_u32 m0, s36, 3072
ds_read_b64_tr_b16 a[176:177], v3 offset:1024
v_mfma_f32_16x16x32_bf16 a[40:43], a[204:207], a[232:235], a[40:43]
ds_read_b64_tr_b16 a[178:179], v3 offset:10240
v_mfma_f32_16x16x32_bf16 a[44:47], a[200:203], a[228:231], a[44:47]
ds_read_b64_tr_b16 a[180:181], v3 offset:19456
v_mfma_f32_16x16x32_bf16 a[44:47], a[204:207], a[236:239], a[44:47]
s_waitcnt lgkmcnt(3)
buffer_load_dwordx4 v163, s[16:19], s31 offen lds
v_mfma_f32_16x16x32_bf16 a[48:51], a[160:163], a[224:227], a[48:51]
ds_read_b64_tr_b16 a[182:183], v3 offset:28672
ds_read_b64_tr_b16 a[184:185], v4 offset:1152
v_mfma_f32_16x16x32_bf16 a[48:51], a[164:167], a[232:235], a[48:51]
ds_read_b64_tr_b16 a[186:187], v4 offset:10368
v_mfma_f32_16x16x32_bf16 a[52:55], a[160:163], a[228:231], a[52:55]
ds_read_b64_tr_b16 a[188:189], v4 offset:19584
v_mfma_f32_16x16x32_bf16 a[52:55], a[164:167], a[236:239], a[52:55]
s_add_u32 m0, s36, 4096
ds_read_b64_tr_b16 a[190:191], v4 offset:28800
v_mfma_f32_16x16x32_bf16 a[56:59], a[168:171], a[224:227], a[56:59]
ds_read_b64_tr_b16 a[192:193], v3 offset:1280
v_mfma_f32_16x16x32_bf16 a[56:59], a[172:175], a[232:235], a[56:59]
ds_read_b64_tr_b16 a[194:195], v3 offset:10496
v_mfma_f32_16x16x32_bf16 a[60:63], a[168:171], a[228:231], a[60:63]
buffer_load_dwordx4 v164, s[16:19], s31 offen lds
v_mfma_f32_16x16x32_bf16 a[60:63], a[172:175], a[236:239], a[60:63]
s_waitcnt lgkmcnt(2)
ds_read_b64_tr_b16 a[196:197], v3 offset:19712
ds_read_b64_tr_b16 a[198:199], v3 offset:28928
v_mfma_f32_16x16x32_bf16 a[64:67], a[176:179], a[224:227], a[64:67]
ds_read_b64_tr_b16 a[200:201], v4 offset:1408
v_mfma_f32_16x16x32_bf16 a[64:67], a[180:183], a[232:235], a[64:67]
ds_read_b64_tr_b16 a[202:203], v4 offset:10624
v_mfma_f32_16x16x32_bf16 a[68:71], a[176:179], a[228:231], a[68:71]
s_add_u32 m0, s36, 5120
ds_read_b64_tr_b16 a[204:205], v4 offset:19840
v_mfma_f32_16x16x32_bf16 a[68:71], a[180:183], a[236:239], a[68:71]
ds_read_b64_tr_b16 a[206:207], v4 offset:29056
v_mfma_f32_16x16x32_bf16 a[72:75], a[184:187], a[224:227], a[72:75]
ds_read_b64_tr_b16 a[160:161], v3 offset:1536
v_mfma_f32_16x16x32_bf16 a[72:75], a[188:191], a[232:235], a[72:75]
buffer_load_dwordx4 v165, s[16:19], s31 offen lds
v_mfma_f32_16x16x32_bf16 a[76:79], a[184:187], a[228:231], a[76:79]
ds_read_b64_tr_b16 a[162:163], v3 offset:10752
ds_read_b64_tr_b16 a[164:165], v3 offset:19968
v_mfma_f32_16x16x32_bf16 a[76:79], a[188:191], a[236:239], a[76:79]
s_waitcnt lgkmcnt(3)
ds_read_b64_tr_b16 a[166:167], v3 offset:29184
v_mfma_f32_16x16x32_bf16 a[80:83], a[192:195], a[224:227], a[80:83]
ds_read_b64_tr_b16 a[168:169], v4 offset:1664
v_mfma_f32_16x16x32_bf16 a[80:83], a[196:199], a[232:235], a[80:83]
s_add_u32 m0, s36, 6144
ds_read_b64_tr_b16 a[170:171], v4 offset:10880
v_mfma_f32_16x16x32_bf16 a[84:87], a[192:195], a[228:231], a[84:87]
ds_read_b64_tr_b16 a[172:173], v4 offset:20096
v_mfma_f32_16x16x32_bf16 a[84:87], a[196:199], a[236:239], a[84:87]
ds_read_b64_tr_b16 a[174:175], v4 offset:29312
v_mfma_f32_16x16x32_bf16 a[88:91], a[200:203], a[224:227], a[88:91]
buffer_load_dwordx4 v166, s[16:19], s31 offen lds
v_mfma_f32_16x16x32_bf16 a[88:91], a[204:207], a[232:235], a[88:91]
ds_read_b64_tr_b16 a[176:177], v3 offset:1792
ds_read_b64_tr_b16 a[178:179], v3 offset:11008
v_mfma_f32_16x16x32_bf16 a[92:95], a[200:203], a[228:231], a[92:95]
s_add_u32 s97, s97, 1
ds_read_b64_tr_b16 a[180:181], v3 offset:20224
buffer_load_dword v1, off, s[20:23], s44 sc1
v_mfma_f32_16x16x32_bf16 a[92:95], a[204:207], a[236:239], a[92:95]
s_waitcnt lgkmcnt(3)
ds_read_b64_tr_b16 a[182:183], v3 offset:29440
v_mfma_f32_16x16x32_bf16 a[96:99], a[160:163], a[224:227], a[96:99]
s_add_u32 m0, s36, 7168
ds_read_b64_tr_b16 a[184:185], v4 offset:1920
s_and_b32 s97, s97, 3
s_mul_i32 s39, s97, 36864
v_mfma_f32_16x16x32_bf16 a[96:99], a[164:167], a[232:235], a[96:99]
ds_read_b64_tr_b16 a[186:187], v4 offset:11136
v_mfma_f32_16x16x32_bf16 a[100:103], a[160:163], a[228:231], a[100:103]
ds_read_b64_tr_b16 a[188:189], v4 offset:20352
v_mfma_f32_16x16x32_bf16 a[100:103], a[164:167], a[236:239], a[100:103]
buffer_load_dwordx4 v167, s[16:19], s31 offen lds
v_mfma_f32_16x16x32_bf16 a[104:107], a[168:171], a[224:227], a[104:107]
ds_read_b64_tr_b16 a[190:191], v4 offset:29568
ds_read_b64_tr_b16 a[192:193], v3 offset:2048
v_mfma_f32_16x16x32_bf16 a[104:107], a[172:175], a[232:235], a[104:107]
ds_read_b64_tr_b16 a[194:195], v3 offset:11264
v_mfma_f32_16x16x32_bf16 a[108:111], a[168:171], a[228:231], a[108:111]
ds_read_b64_tr_b16 a[196:197], v3 offset:20480
v_mfma_f32_16x16x32_bf16 a[108:111], a[172:175], a[236:239], a[108:111]
s_waitcnt lgkmcnt(3)
ds_read_b64_tr_b16 a[198:199], v3 offset:29696
v_mfma_f32_16x16x32_bf16 a[112:115], a[176:179], a[224:227], a[112:115]
s_add_u32 m0, s36, 8192
ds_read_b64_tr_b16 a[200:201], v4 offset:2176
v_mfma_f32_16x16x32_bf16 a[112:115], a[180:183], a[232:235], a[112:115]
ds_read_b64_tr_b16 a[202:203], v4 offset:11392
v_mfma_f32_16x16x32_bf16 a[116:119], a[176:179], a[228:231], a[116:119]
s_waitcnt vmcnt(14)
buffer_load_dwordx4 v168, s[16:19], s31 offen lds
s_barrier
v_mfma_f32_16x16x32_bf16 a[116:119], a[180:183], a[236:239], a[116:119]
s_add_u32 s96, s96, 1
ds_read_b64_tr_b16 a[204:205], v4 offset:20608
ds_read_b64_tr_b16 a[206:207], v4 offset:29824
v_add_u32 v3, s39, v7
v_add_u32 v4, s39, v8
v_mfma_f32_16x16x32_bf16 a[120:123], a[184:187], a[224:227], a[120:123]
s_and_b32 s96, s96, 3
ds_read_b64_tr_b16 a[160:161], v3 offset:0
v_mfma_f32_16x16x32_bf16 a[120:123], a[188:191], a[232:235], a[120:123]
s_mul_i32 s36, s96, 36864
ds_read_b64_tr_b16 a[162:163], v3 offset:9216
s_add_u32 s36, s36, s38
v_mfma_f32_16x16x32_bf16 a[124:127], a[184:187], a[228:231], a[124:127]
ds_read_b64_tr_b16 a[164:165], v3 offset:18432
v_mfma_f32_16x16x32_bf16 a[124:127], a[188:191], a[236:239], a[124:127]
s_waitcnt lgkmcnt(3)
ds_read_b64_tr_b16 a[166:167], v3 offset:27648
v_mfma_f32_16x16x32_bf16 a[128:131], a[192:195], a[224:227], a[128:131]
ds_read_b64_tr_b16 a[168:169], v4 offset:128
v_mfma_f32_16x16x32_bf16 a[128:131], a[196:199], a[232:235], a[128:131]
ds_read_b64_tr_b16 a[170:171], v4 offset:9344
v_mfma_f32_16x16x32_bf16 a[132:135], a[192:195], a[228:231], a[132:135]
ds_read_b64_tr_b16 a[172:173], v4 offset:18560
v_mfma_f32_16x16x32_bf16 a[132:135], a[196:199], a[236:239], a[132:135]
ds_read_b64_tr_b16 a[174:175], v4 offset:27776
v_mfma_f32_16x16x32_bf16 a[136:139], a[200:203], a[224:227], a[136:139]
ds_read_b64_tr_b16 a[176:177], v3 offset:256
s_waitcnt vmcnt(11)
v_mfma_f32_16x16x32_bf16 a[136:139], a[204:207], a[232:235], a[136:139]
ds_read_b64_tr_b16 a[178:179], v3 offset:9472
v_mfma_f32_16x16x32_bf16 a[140:143], a[200:203], a[228:231], a[140:143]
ds_read_b64_tr_b16 a[180:181], v3 offset:18688
v_mfma_f32_16x16x32_bf16 a[140:143], a[204:207], a[236:239], a[140:143]
s_waitcnt lgkmcnt(3)
ds_read_b64_tr_b16 a[182:183], v3 offset:27904
v_mfma_f32_16x16x32_bf16 a[0:3], a[160:163], a[240:243], a[0:3]
s_mov_b32 m0, s36
ds_read_b64_tr_b16 a[184:185], v4 offset:384
v_mfma_f32_16x16x32_bf16 a[0:3], a[164:167], a[248:251], a[0:3]
ds_read_b64_tr_b16 a[186:187], v4 offset:9600
v_mfma_f32_16x16x32_bf16 a[4:7], a[160:163], a[244:247], a[4:7]
buffer_load_dwordx4 v160, s[16:19], s32 offen lds
v_mfma_f32_16x16x32_bf16 a[4:7], a[164:167], a[252:255], a[4:7]
ds_read_b64_tr_b16 a[188:189], v4 offset:18816
ds_read_b64_tr_b16 a[190:191], v4 offset:28032
v_mfma_f32_16x16x32_bf16 a[8:11], a[168:171], a[240:243], a[8:11]
ds_read_b64_tr_b16 a[192:193], v3 offset:512
v_mfma_f32_16x16x32_bf16 a[8:11], a[172:175], a[248:251], a[8:11]
ds_read_b64_tr_b16 a[194:195], v3 offset:9728
v_mfma_f32_16x16x32_bf16 a[12:15], a[168:171], a[244:247], a[12:15]
s_add_u32 m0, s36, 1024
ds_read_b64_tr_b16 a[196:197], v3 offset:18944
v_mfma_f32_16x16x32_bf16 a[12:15], a[172:175], a[252:255], a[12:15]
s_waitcnt lgkmcnt(3)
ds_read_b64_tr_b16 a[198:199], v3 offset:28160
v_mfma_f32_16x16x32_bf16 a[16:19], a[176:179], a[240:243], a[16:19]
ds_read_b64_tr_b16 a[200:201], v4 offset:640
v_mfma_f32_16x16x32_bf16 a[16:19], a[180:183], a[248:251], a[16:19]
buffer_load_dwordx4 v161, s[16:19], s32 offen lds
s_waitcnt vmcnt(4)
v_readfirstlane_b32 s50, v1
s_nop 0
s_cmp_ge_u32 s50, 5
s_cbranch_scc0 L_sequential_preLN__sliding_local_dilated__glu_gated_geglu__prompt_kernel_slowb
L_sequential_preLN__sliding_local_dilated__glu_gated_geglu__prompt_kernel_backb:
v_mfma_f32_16x16x32_bf16 a[20:23], a[176:179], a[244:247], a[20:23]
ds_read_b64_tr_b16 a[202:203], v4 offset:9856
ds_read_b64_tr_b16 a[204:205], v4 offset:19072
v_mfma_f32_16x16x32_bf16 a[20:23], a[180:183], a[252:255], a[20:23]
ds_read_b64_tr_b16 a[206:207], v4 offset:28288
s_add_u32 s51, s34, 12288
buffer_load_dwordx4 v[128:131], v30, s[20:23], s51 offen offset:0 sc1
v_mfma_f32_16x16x32_bf16 a[24:27], a[184:187], a[240:243], a[24:27]
ds_read_b64_tr_b16 a[160:161], v3 offset:768
v_mfma_f32_16x16x32_bf16 a[24:27], a[188:191], a[248:251], a[24:27]
s_add_u32 m0, s36, 2048
ds_read_b64_tr_b16 a[162:163], v3 offset:9984
buffer_load_dwordx4 v[132:135], v30, s[20:23], s51 offen offset:1024 sc1
v_mfma_f32_16x16x32_bf16 a[28:31], a[184:187], a[244:247], a[28:31]
ds_read_b64_tr_b16 a[164:165], v3 offset:19200
v_mfma_f32_16x16x32_bf16 a[28:31], a[188:191], a[252:255], a[28:31]
s_waitcnt lgkmcnt(3)
ds_read_b64_tr_b16 a[166:167], v3 offset:28416
buffer_load_dwordx4 v[136:139], v30, s[20:23], s51 offen offset:2048 sc1
v_mfma_f32_16x16x32_bf16 a[32:35], a[192:195], a[240:243], a[32:35]
buffer_load_dwordx4 v162, s[16:19], s32 offen lds
v_mfma_f32_16x16x32_bf16 a[32:35], a[196:199], a[248:251], a[32:35]
ds_read_b64_tr_b16 a[168:169], v4 offset:896
ds_read_b64_tr_b16 a[170:171], v4 offset:10112
buffer_load_dwordx4 v[140:143], v30, s[20:23], s51 offen offset:3072 sc1
v_mfma_f32_16x16x32_bf16 a[36:39], a[192:195], a[244:247], a[36:39]
ds_read_b64_tr_b16 a[172:173], v4 offset:19328
v_mfma_f32_16x16x32_bf16 a[36:39], a[196:199], a[252:255], a[36:39]
ds_read_b64_tr_b16 a[174:175], v4 offset:28544
s_add_u32 s51, s34, 16384
buffer_load_dwordx4 v[144:147], v30, s[20:23], s51 offen offset:0 sc1
v_mfma_f32_16x16x32_bf16 a[40:43], a[200:203], a[240:243], a[40:43]
s_add_u32 m0, s36, 3072
ds_read_b64_tr_b16 a[176:177], v3 offset:1024
v_mfma_f32_16x16x32_bf16 a[40:43], a[204:207], a[248:251], a[40:43]
ds_read_b64_tr_b16 a[178:179], v3 offset:10240
buffer_load_dwordx4 v[148:151], v30, s[20:23], s51 offen offset:1024 sc1
v_mfma_f32_16x16x32_bf16 a[44:47], a[200:203], a[244:247], a[44:47]
ds_read_b64_tr_b16 a[180:181], v3 offset:19456
v_mfma_f32_16x16x32_bf16 a[44:47], a[204:207], a[252:255], a[44:47]
s_waitcnt lgkmcnt(3)
buffer_load_dwordx4 v163, s[16:19], s32 offen lds
v_mfma_f32_16x16x32_bf16 a[48:51], a[160:163], a[240:243], a[48:51]
ds_read_b64_tr_b16 a[182:183], v3 offset:28672
ds_read_b64_tr_b16 a[184:185], v4 offset:1152
v_mfma_f32_16x16x32_bf16 a[48:51], a[164:167], a[248:251], a[48:51]
ds_read_b64_tr_b16 a[186:187], v4 offset:10368
v_mfma_f32_16x16x32_bf16 a[52:55], a[160:163], a[244:247], a[52:55]
ds_read_b64_tr_b16 a[188:189], v4 offset:19584
v_mfma_f32_16x16x32_bf16 a[52:55], a[164:167], a[252:255], a[52:55]
s_add_u32 m0, s36, 4096
ds_read_b64_tr_b16 a[190:191], v4 offset:28800
v_mfma_f32_16x16x32_bf16 a[56:59], a[168:171], a[240:243], a[56:59]
ds_read_b64_tr_b16 a[192:193], v3 offset:1280
v_mfma_f32_16x16x32_bf16 a[56:59], a[172:175], a[248:251], a[56:59]
ds_read_b64_tr_b16 a[194:195], v3 offset:10496
v_mfma_f32_16x16x32_bf16 a[60:63], a[168:171], a[244:247], a[60:63]
buffer_load_dwordx4 v164, s[16:19], s32 offen lds
v_mfma_f32_16x16x32_bf16 a[60:63], a[172:175], a[252:255], a[60:63]
s_waitcnt lgkmcnt(2)
ds_read_b64_tr_b16 a[196:197], v3 offset:19712
ds_read_b64_tr_b16 a[198:199], v3 offset:28928
v_mfma_f32_16x16x32_bf16 a[64:67], a[176:179], a[240:243], a[64:67]
ds_read_b64_tr_b16 a[200:201], v4 offset:1408
v_mfma_f32_16x16x32_bf16 a[64:67], a[180:183], a[248:251], a[64:67]
ds_read_b64_tr_b16 a[202:203], v4 offset:10624
v_mfma_f32_16x16x32_bf16 a[68:71], a[176:179], a[244:247], a[68:71]
s_add_u32 m0, s36, 5120
ds_read_b64_tr_b16 a[204:205], v4 offset:19840
v_mfma_f32_16x16x32_bf16 a[68:71], a[180:183], a[252:255], a[68:71]
ds_read_b64_tr_b16 a[206:207], v4 offset:29056
v_mfma_f32_16x16x32_bf16 a[72:75], a[184:187], a[240:243], a[72:75]
ds_read_b64_tr_b16 a[160:161], v3 offset:1536
v_mfma_f32_16x16x32_bf16 a[72:75], a[188:191], a[248:251], a[72:75]
buffer_load_dwordx4 v165, s[16:19], s32 offen lds
v_mfma_f32_16x16x32_bf16 a[76:79], a[184:187], a[244:247], a[76:79]
ds_read_b64_tr_b16 a[162:163], v3 offset:10752
ds_read_b64_tr_b16 a[164:165], v3 offset:19968
v_mfma_f32_16x16x32_bf16 a[76:79], a[188:191], a[252:255], a[76:79]
s_waitcnt lgkmcnt(3)
ds_read_b64_tr_b16 a[166:167], v3 offset:29184
v_mfma_f32_16x16x32_bf16 a[80:83], a[192:195], a[240:243], a[80:83]
ds_read_b64_tr_b16 a[168:169], v4 offset:1664
v_mfma_f32_16x16x32_bf16 a[80:83], a[196:199], a[248:251], a[80:83]
s_add_u32 m0, s36, 6144
ds_read_b64_tr_b16 a[170:171], v4 offset:10880
v_mfma_f32_16x16x32_bf16 a[84:87], a[192:195], a[244:247], a[84:87]
ds_read_b64_tr_b16 a[172:173], v4 offset:20096
v_mfma_f32_16x16x32_bf16 a[84:87], a[196:199], a[252:255], a[84:87]
ds_read_b64_tr_b16 a[174:175], v4 offset:29312
v_mfma_f32_16x16x32_bf16 a[88:91], a[200:203], a[240:243], a[88:91]
buffer_load_dwordx4 v166, s[16:19], s32 offen lds
v_mfma_f32_16x16x32_bf16 a[88:91], a[204:207], a[248:251], a[88:91]
ds_read_b64_tr_b16 a[176:177], v3 offset:1792
ds_read_b64_tr_b16 a[178:179], v3 offset:11008
v_mfma_f32_16x16x32_bf16 a[92:95], a[200:203], a[244:247], a[92:95]
s_add_u32 s97, s97, 1
ds_read_b64_tr_b16 a[180:181], v3 offset:20224
v_mfma_f32_16x16x32_bf16 a[92:95], a[204:207], a[252:255], a[92:95]
s_waitcnt lgkmcnt(3)
ds_read_b64_tr_b16 a[182:183], v3 offset:29440
v_mfma_f32_16x16x32_bf16 a[96:99], a[160:163], a[240:243], a[96:99]
s_add_u32 m0, s36, 7168
ds_read_b64_tr_b16 a[184:185], v4 offset:1920
s_and_b32 s97, s97, 3
s_mul_i32 s39, s97, 36864
v_mfma_f32_16x16x32_bf16 a[96:99], a[164:167], a[248:251], a[96:99]
ds_read_b64_tr_b16 a[186:187], v4 offset:11136
v_mfma_f32_16x16x32_bf16 a[100:103], a[160:163], a[244:247], a[100:103]
ds_read_b64_tr_b16 a[188:189], v4 offset:20352
v_mfma_f32_16x16x32_bf16 a[100:103], a[164:167], a[252:255], a[100:103]
buffer_load_dwordx4 v167, s[16:19], s32 offen lds
v_mfma_f32_16x16x32_bf16 a[104:107], a[168:171], a[240:243], a[104:107]
ds_read_b64_tr_b16 a[190:191], v4 offset:29568
ds_read_b64_tr_b16 a[192:193], v3 offset:2048
v_mfma_f32_16x16x32_bf16 a[104:107], a[172:175], a[248:251], a[104:107]
ds_read_b64_tr_b16 a[194:195], v3 offset:11264
v_mfma_f32_16x16x32_bf16 a[108:111], a[168:171], a[244:247], a[108:111]
ds_read_b64_tr_b16 a[196:197], v3 offset:20480
v_mfma_f32_16x16x32_bf16 a[108:111], a[172:175], a[252:255], a[108:111]
s_waitcnt lgkmcnt(3)
ds_read_b64_tr_b16 a[198:199], v3 offset:29696
v_mfma_f32_16x16x32_bf16 a[112:115], a[176:179], a[240:243], a[112:115]
s_add_u32 m0, s36, 8192
ds_read_b64_tr_b16 a[200:201], v4 offset:2176
v_mfma_f32_16x16x32_bf16 a[112:115], a[180:183], a[248:251], a[112:115]
ds_read_b64_tr_b16 a[202:203], v4 offset:11392
v_mfma_f32_16x16x32_bf16 a[116:119], a[176:179], a[244:247], a[116:119]
s_waitcnt vmcnt(14)
buffer_load_dwordx4 v168, s[16:19], s32 offen lds
s_barrier
v_mfma_f32_16x16x32_bf16 a[116:119], a[180:183], a[252:255], a[116:119]
s_add_u32 s96, s96, 1
ds_read_b64_tr_b16 a[204:205], v4 offset:20608
ds_read_b64_tr_b16 a[206:207], v4 offset:29824
v_add_u32 v3, s39, v169
v_mfma_f32_16x16x32_bf16 a[120:123], a[184:187], a[240:243], a[120:123]
s_and_b32 s96, s96, 3
ds_read_b64_tr_b16 a[160:161], v3 offset:0
v_mfma_f32_16x16x32_bf16 a[120:123], a[188:191], a[248:251], a[120:123]
s_mul_i32 s36, s96, 36864
ds_read_b64_tr_b16 a[162:163], v3 offset:4608
s_add_u32 s36, s36, s38
v_mfma_f32_16x16x32_bf16 a[124:127], a[184:187], a[244:247], a[124:127]
ds_read_b64_tr_b16 a[164:165], v3 offset:9216
v_mfma_f32_16x16x32_bf16 a[124:127], a[188:191], a[252:255], a[124:127]
s_waitcnt lgkmcnt(3)
ds_read_b64_tr_b16 a[166:167], v3 offset:13824
v_mfma_f32_16x16x32_bf16 a[128:131], a[192:195], a[240:243], a[128:131]
ds_read_b64_tr_b16 a[168:169], v3 offset:18432
v_mfma_f32_16x16x32_bf16 a[128:131], a[196:199], a[248:251], a[128:131]
ds_read_b64_tr_b16 a[170:171], v3 offset:23040
v_mfma_f32_16x16x32_bf16 a[132:135], a[192:195], a[244:247], a[132:135]
ds_read_b64_tr_b16 a[172:173], v3 offset:27648
v_mfma_f32_16x16x32_bf16 a[132:135], a[196:199], a[252:255], a[132:135]
ds_read_b64_tr_b16 a[174:175], v3 offset:32256
v_mfma_f32_16x16x32_bf16 a[136:139], a[200:203], a[240:243], a[136:139]
ds_read_b64_tr_b16 a[176:177], v3 offset:128
v_mfma_f32_16x16x32_bf16 a[136:139], a[204:207], a[248:251], a[136:139]
ds_read_b64_tr_b16 a[178:179], v3 offset:4736
v_mfma_f32_16x16x32_bf16 a[140:143], a[200:203], a[244:247], a[140:143]
ds_read_b64_tr_b16 a[180:181], v3 offset:9344
s_waitcnt vmcnt(6)
v_mfma_f32_16x16x32_bf16 a[140:143], a[204:207], a[252:255], a[140:143]
s_waitcnt lgkmcnt(3)
ds_read_b64_tr_b16 a[182:183], v3 offset:13952
v_mfma_f32_16x16x32_bf16 a[0:3], a[160:163], v[56:59], a[0:3]
ds_read_b64_tr_b16 a[184:185], v3 offset:18560
v_mfma_f32_16x16x32_bf16 a[0:3], a[164:167], v[128:131], a[0:3]
ds_read_b64_tr_b16 a[186:187], v3 offset:23168
v_mfma_f32_16x16x32_bf16 a[0:3], a[168:171], v[136:139], a[0:3]
ds_read_b64_tr_b16 a[188:189], v3 offset:27776
v_mfma_f32_16x16x32_bf16 a[0:3], a[172:175], v[144:147], a[0:3]
ds_read_b64_tr_b16 a[190:191], v3 offset:32384
v_mfma_f32_16x16x32_bf16 a[4:7], a[160:163], v[60:63], a[4:7]
ds_read_b64_tr_b16 a[192:193], v3 offset:256
v_mfma_f32_16x16x32_bf16 a[4:7], a[164:167], v[132:135], a[4:7]
ds_read_b64_tr_b16 a[194:195], v3 offset:4864
v_mfma_f32_16x16x32_bf16 a[4:7], a[168:171], v[140:143], a[4:7]
ds_read_b64_tr_b16 a[196:197], v3 offset:9472
v_mfma_f32_16x16x32_bf16 a[4:7], a[172:175], v[148:151], a[4:7]
s_waitcnt lgkmcnt(3)
ds_read_b64_tr_b16 a[198:199], v3 offset:14080
v_mfma_f32_16x16x32_bf16 a[8:11], a[176:179], v[56:59], a[8:11]
ds_read_b64_tr_b16 a[200:201], v3 offset:18688
v_mfma_f32_16x16x32_bf16 a[8:11], a[180:183], v[128:131], a[8:11]
ds_read_b64_tr_b16 a[202:203], v3 offset:23296
v_mfma_f32_16x16x32_bf16 a[8:11], a[184:187], v[136:139], a[8:11]
ds_read_b64_tr_b16 a[204:205], v3 offset:27904
v_mfma_f32_16x16x32_bf16 a[8:11], a[188:191], v[144:147], a[8:11]
ds_read_b64_tr_b16 a[206:207], v3 offset:32512
v_mfma_f32_16x16x32_bf16 a[12:15], a[176:179], v[60:63], a[12:15]
ds_read_b64_tr_b16 a[160:161], v3 offset:384
v_mfma_f32_16x16x32_bf16 a[12:15], a[180:183], v[132:135], a[12:15]
ds_read_b64_tr_b16 a[162:163], v3 offset:4992
v_mfma_f32_16x16x32_bf16 a[12:15], a[184:187], v[140:143], a[12:15]
ds_read_b64_tr_b16 a[164:165], v3 offset:9600
v_mfma_f32_16x16x32_bf16 a[12:15], a[188:191], v[148:151], a[12:15]
s_waitcnt lgkmcnt(3)
ds_read_b64_tr_b16 a[166:167], v3 offset:14208
v_mfma_f32_16x16x32_bf16 a[16:19], a[192:195], v[56:59], a[16:19]
ds_read_b64_tr_b16 a[168:169], v3 offset:18816
v_mfma_f32_16x16x32_bf16 a[16:19], a[196:199], v[128:131], a[16:19]
ds_read_b64_tr_b16 a[170:171], v3 offset:23424
v_mfma_f32_16x16x32_bf16 a[16:19], a[200:203], v[136:139], a[16:19]
ds_read_b64_tr_b16 a[172:173], v3 offset:28032
v_accvgpr_read_b32 v64, a0
v_accvgpr_read_b32 v65, a1
v_mfma_f32_16x16x32_bf16 a[16:19], a[204:207], v[144:147], a[16:19]
ds_read_b64_tr_b16 a[174:175], v3 offset:32640
v_accvgpr_read_b32 v66, a2
v_accvgpr_read_b32 v67, a3
v_mfma_f32_16x16x32_bf16 a[20:23], a[192:195], v[60:63], a[20:23]
ds_read_b64_tr_b16 a[176:177], v3 offset:512
v_accvgpr_read_b32 v68, a8
v_accvgpr_read_b32 v69, a9
v_mfma_f32_16x16x32_bf16 a[20:23], a[196:199], v[132:135], a[20:23]
ds_read_b64_tr_b16 a[178:179], v3 offset:5120
v_accvgpr_read_b32 v70, a10
v_accvgpr_read_b32 v71, a11
v_mfma_f32_16x16x32_bf16 a[20:23], a[200:203], v[140:143], a[20:23]
ds_read_b64_tr_b16 a[180:181], v3 offset:9728
v_cvt_pk_bf16_f32 v40, v64, v65
v_cvt_pk_bf16_f32 v41, v66, v67
v_mfma_f32_16x16x32_bf16 a[20:23], a[204:207], v[148:151], a[20:23]
s_waitcnt lgkmcnt(3)
ds_read_b64_tr_b16 a[182:183], v3 offset:14336
v_cvt_pk_bf16_f32 v42, v68, v69
v_cvt_pk_bf16_f32 v43, v70, v71
v_mfma_f32_16x16x32_bf16 a[24:27], a[160:163], v[56:59], a[24:27]
ds_read_b64_tr_b16 a[184:185], v3 offset:18944
s_add_u32 s41, s35, 0
buffer_store_dwordx4 v[40:43], v30, s[20:23], s41 offen sc1
v_mfma_f32_16x16x32_bf16 a[24:27], a[164:167], v[128:131], a[24:27]
ds_read_b64_tr_b16 a[186:187], v3 offset:23552
v_accvgpr_read_b32 v80, a4
v_accvgpr_read_b32 v81, a5
v_mfma_f32_16x16x32_bf16 a[24:27], a[168:171], v[136:139], a[24:27]
ds_read_b64_tr_b16 a[188:189], v3 offset:28160
v_accvgpr_read_b32 v82, a6
v_accvgpr_read_b32 v83, a7
v_mfma_f32_16x16x32_bf16 a[24:27], a[172:175], v[144:147], a[24:27]
ds_read_b64_tr_b16 a[190:191], v3 offset:32768
v_accvgpr_read_b32 v84, a12
v_accvgpr_read_b32 v85, a13
v_mfma_f32_16x16x32_bf16 a[28:31], a[160:163], v[60:63], a[28:31]
ds_read_b64_tr_b16 a[192:193], v3 offset:640
v_accvgpr_read_b32 v86, a14
v_accvgpr_read_b32 v87, a15
v_mfma_f32_16x16x32_bf16 a[28:31], a[164:167], v[132:135], a[28:31]
ds_read_b64_tr_b16 a[194:195], v3 offset:5248
v_cvt_pk_bf16_f32 v44, v80, v81
v_cvt_pk_bf16_f32 v45, v82, v83
v_mfma_f32_16x16x32_bf16 a[28:31], a[168:171], v[140:143], a[28:31]
ds_read_b64_tr_b16 a[196:197], v3 offset:9856
v_cvt_pk_bf16_f32 v46, v84, v85
v_cvt_pk_bf16_f32 v47, v86, v87
v_mfma_f32_16x16x32_bf16 a[28:31], a[172:175], v[148:151], a[28:31]
s_waitcnt lgkmcnt(3)
ds_read_b64_tr_b16 a[198:199], v3 offset:14464
s_add_u32 s41, s35, 9216
buffer_store_dwordx4 v[44:47], v30, s[20:23], s41 offen sc1
v_mfma_f32_16x16x32_bf16 a[32:35], a[176:179], v[56:59], a[32:35]
ds_read_b64_tr_b16 a[200:201], v3 offset:19072
v_mfma_f32_16x16x32_bf16 a[32:35], a[180:183], v[128:131], a[32:35]
ds_read_b64_tr_b16 a[202:203], v3 offset:23680
v_mfma_f32_16x16x32_bf16 a[32:35], a[184:187], v[136:139], a[32:35]
ds_read_b64_tr_b16 a[204:205], v3 offset:28288
v_accvgpr_read_b32 v96, a16
v_accvgpr_read_b32 v97, a17
v_mfma_f32_16x16x32_bf16 a[32:35], a[188:191], v[144:147], a[32:35]
ds_read_b64_tr_b16 a[206:207], v3 offset:32896
v_accvgpr_read_b32 v98, a18
v_accvgpr_read_b32 v99, a19
v_mfma_f32_16x16x32_bf16 a[36:39], a[176:179], v[60:63], a[36:39]
ds_read_b64_tr_b16 a[160:161], v3 offset:768
v_accvgpr_read_b32 v100, a24
v_accvgpr_read_b32 v101, a25
v_mfma_f32_16x16x32_bf16 a[36:39], a[180:183], v[132:135], a[36:39]
ds_read_b64_tr_b16 a[162:163], v3 offset:5376
v_accvgpr_read_b32 v102, a26
v_accvgpr_read_b32 v103, a27
v_mfma_f32_16x16x32_bf16 a[36:39], a[184:187], v[140:143], a[36:39]
ds_read_b64_tr_b16 a[164:165], v3 offset:9984
v_cvt_pk_bf16_f32 v48, v96, v97
v_cvt_pk_bf16_f32 v49, v98, v99
v_mfma_f32_16x16x32_bf16 a[36:39], a[188:191], v[148:151], a[36:39]
s_waitcnt lgkmcnt(3)
ds_read_b64_tr_b16 a[166:167], v3 offset:14592
v_cvt_pk_bf16_f32 v50, v100, v101
v_cvt_pk_bf16_f32 v51, v102, v103
v_mfma_f32_16x16x32_bf16 a[40:43], a[192:195], v[56:59], a[40:43]
ds_read_b64_tr_b16 a[168:169], v3 offset:19200
s_add_u32 s41, s35, 1024
buffer_store_dwordx4 v[48:51], v30, s[20:23], s41 offen sc1
v_mfma_f32_16x16x32_bf16 a[40:43], a[196:199], v[128:131], a[40:43]
ds_read_b64_tr_b16 a[170:171], v3 offset:23808
v_accvgpr_read_b32 v112, a20
v_accvgpr_read_b32 v113, a21
v_mfma_f32_16x16x32_bf16 a[40:43], a[200:203], v[136:139], a[40:43]
ds_read_b64_tr_b16 a[172:173], v3 offset:28416
v_accvgpr_read_b32 v114, a22
v_accvgpr_read_b32 v115, a23
v_mfma_f32_16x16x32_bf16 a[40:43], a[204:207], v[144:147], a[40:43]
ds_read_b64_tr_b16 a[174:175], v3 offset:33024
v_accvgpr_read_b32 v116, a28
v_accvgpr_read_b32 v117, a29
v_mfma_f32_16x16x32_bf16 a[44:47], a[192:195], v[60:63], a[44:47]
ds_read_b64_tr_b16 a[176:177], v3 offset:896
v_accvgpr_read_b32 v118, a30
v_accvgpr_read_b32 v119, a31
v_mfma_f32_16x16x32_bf16 a[44:47], a[196:199], v[132:135], a[44:47]
ds_read_b64_tr_b16 a[178:179], v3 offset:5504
v_cvt_pk_bf16_f32 v52, v112, v113
v_cvt_pk_bf16_f32 v53, v114, v115
v_mfma_f32_16x16x32_bf16 a[44:47], a[200:203], v[140:143], a[44:47]
s_add_u32 s97, s97, 1
ds_read_b64_tr_b16 a[180:181], v3 offset:10112
v_cvt_pk_bf16_f32 v54, v116, v117
v_cvt_pk_bf16_f32 v55, v118, v119
v_mfma_f32_16x16x32_bf16 a[44:47], a[204:207], v[148:151], a[44:47]
s_waitcnt lgkmcnt(3)
ds_read_b64_tr_b16 a[182:183], v3 offset:14720
s_add_u32 s41, s35, 10240
buffer_store_dwordx4 v[52:55], v30, s[20:23], s41 offen sc1
v_mfma_f32_16x16x32_bf16 a[48:51], a[160:163], v[56:59], a[48:51]
s_and_b32 s97, s97, 3
ds_read_b64_tr_b16 a[184:185], v3 offset:19328
s_mul_i32 s39, s97, 36864
v_mfma_f32_16x16x32_bf16 a[48:51], a[164:167], v[128:131], a[48:51]
ds_read_b64_tr_b16 a[186:187], v3 offset:23936
v_mfma_f32_16x16x32_bf16 a[48:51], a[168:171], v[136:139], a[48:51]
ds_read_b64_tr_b16 a[188:189], v3 offset:28544
v_accvgpr_read_b32 v64, a32
v_accvgpr_read_b32 v65, a33
v_mfma_f32_16x16x32_bf16 a[48:51], a[172:175], v[144:147], a[48:51]
ds_read_b64_tr_b16 a[190:191], v3 offset:33152
v_accvgpr_read_b32 v66, a34
v_accvgpr_read_b32 v67, a35
v_mfma_f32_16x16x32_bf16 a[52:55], a[160:163], v[60:63], a[52:55]
ds_read_b64_tr_b16 a[192:193], v3 offset:1024
v_accvgpr_read_b32 v68, a40
v_accvgpr_read_b32 v69, a41
v_mfma_f32_16x16x32_bf16 a[52:55], a[164:167], v[132:135], a[52:55]
ds_read_b64_tr_b16 a[194:195], v3 offset:5632
v_accvgpr_read_b32 v70, a42
v_accvgpr_read_b32 v71, a43
v_mfma_f32_16x16x32_bf16 a[52:55], a[168:171], v[140:143], a[52:55]
ds_read_b64_tr_b16 a[196:197], v3 offset:10240
v_cvt_pk_bf16_f32 v40, v64, v65
v_cvt_pk_bf16_f32 v41, v66, v67
v_mfma_f32_16x16x32_bf16 a[52:55], a[172:175], v[148:151], a[52:55]
s_waitcnt lgkmcnt(3)
ds_read_b64_tr_b16 a[198:199], v3 offset:14848
v_cvt_pk_bf16_f32 v42, v68, v69
v_cvt_pk_bf16_f32 v43, v70, v71
v_mfma_f32_16x16x32_bf16 a[56:59], a[176:179], v[56:59], a[56:59]
ds_read_b64_tr_b16 a[200:201], v3 offset:19456
s_add_u32 s41, s35, 2048
buffer_store_dwordx4 v[40:43], v30, s[20:23], s41 offen sc1
v_mfma_f32_16x16x32_bf16 a[56:59], a[180:183], v[128:131], a[56:59]
ds_read_b64_tr_b16 a[202:203], v3 offset:24064
v_accvgpr_read_b32 v80, a36
v_accvgpr_read_b32 v81, a37
v_mfma_f32_16x16x32_bf16 a[56:59], a[184:187], v[136:139], a[56:59]
s_waitcnt vmcnt(5)
ds_read_b64_tr_b16 a[204:205], v3 offset:28672
s_barrier
v_accvgpr_read_b32 v82, a38
v_mfma_f32_16x16x32_bf16 a[56:59], a[188:191], v[144:147], a[56:59]
ds_read_b64_tr_b16 a[206:207], v3 offset:33280
v_add_u32 v3, s39, v169
v_accvgpr_read_b32 v83, a39
v_mfma_f32_16x16x32_bf16 a[60:63], a[176:179], v[60:63], a[60:63]
ds_read_b64_tr_b16 a[160:161], v3 offset:0
v_accvgpr_read_b32 v84, a44
v_accvgpr_read_b32 v85, a45
v_mfma_f32_16x16x32_bf16 a[60:63], a[180:183], v[132:135], a[60:63]
ds_read_b64_tr_b16 a[162:163], v3 offset:4608
v_accvgpr_read_b32 v86, a46
v_accvgpr_read_b32 v87, a47
v_mfma_f32_16x16x32_bf16 a[60:63], a[184:187], v[140:143], a[60:63]
ds_read_b64_tr_b16 a[164:165], v3 offset:9216
v_cvt_pk_bf16_f32 v44, v80, v81
v_cvt_pk_bf16_f32 v45, v82, v83
v_mfma_f32_16x16x32_bf16 a[60:63], a[188:191], v[148:151], a[60:63]
s_waitcnt lgkmcnt(3)
ds_read_b64_tr_b16 a[166:167], v3 offset:13824
v_cvt_pk_bf16_f32 v46, v84, v85
v_cvt_pk_bf16_f32 v47, v86, v87
v_mfma_f32_16x16x32_bf16 a[64:67], a[192:195], v[56:59], a[64:67]
ds_read_b64_tr_b16 a[168:169], v3 offset:18432
s_add_u32 s41, s35, 11264
buffer_store_dwordx4 v[44:47], v30, s[20:23], s41 offen sc1
v_mfma_f32_16x16x32_bf16 a[64:67], a[196:199], v[128:131], a[64:67]
ds_read_b64_tr_b16 a[170:171], v3 offset:23040
v_mfma_f32_16x16x32_bf16 a[64:67], a[200:203], v[136:139], a[64:67]
ds_read_b64_tr_b16 a[172:173], v3 offset:27648
v_accvgpr_read_b32 v96, a48
v_accvgpr_read_b32 v97, a49
v_mfma_f32_16x16x32_bf16 a[64:67], a[204:207], v[144:147], a[64:67]
ds_read_b64_tr_b16 a[174:175], v3 offset:32256
v_accvgpr_read_b32 v98, a50
v_accvgpr_read_b32 v99, a51
v_mfma_f32_16x16x32_bf16 a[68:71], a[192:195], v[60:63], a[68:71]
ds_read_b64_tr_b16 a[176:177], v3 offset:128
v_accvgpr_read_b32 v100, a56
v_accvgpr_read_b32 v101, a57
v_mfma_f32_16x16x32_bf16 a[68:71], a[196:199], v[132:135], a[68:71]
ds_read_b64_tr_b16 a[178:179], v3 offset:4736
v_accvgpr_read_b32 v102, a58
v_accvgpr_read_b32 v103, a59
v_mfma_f32_16x16x32_bf16 a[68:71], a[200:203], v[140:143], a[68:71]
ds_read_b64_tr_b16 a[180:181], v3 offset:9344
v_cvt_pk_bf16_f32 v48, v96, v97
v_cvt_pk_bf16_f32 v49, v98, v99
v_mfma_f32_16x16x32_bf16 a[68:71], a[204:207], v[148:151], a[68:71]
s_waitcnt lgkmcnt(3)
ds_read_b64_tr_b16 a[182:183], v3 offset:13952
v_cvt_pk_bf16_f32 v50, v100, v101
v_cvt_pk_bf16_f32 v51, v102, v103
v_mfma_f32_16x16x32_bf16 a[72:75], a[160:163], v[56:59], a[72:75]
ds_read_b64_tr_b16 a[184:185], v3 offset:18560
s_add_u32 s41, s35, 3072
buffer_store_dwordx4 v[48:51], v30, s[20:23], s41 offen sc1
v_mfma_f32_16x16x32_bf16 a[72:75], a[164:167], v[128:131], a[72:75]
ds_read_b64_tr_b16 a[186:187], v3 offset:23168
v_accvgpr_read_b32 v112, a52
v_accvgpr_read_b32 v113, a53
v_mfma_f32_16x16x32_bf16 a[72:75], a[168:171], v[136:139], a[72:75]
ds_read_b64_tr_b16 a[188:189], v3 offset:27776
v_accvgpr_read_b32 v114, a54
v_accvgpr_read_b32 v115, a55
v_mfma_f32_16x16x32_bf16 a[72:75], a[172:175], v[144:147], a[72:75]
ds_read_b64_tr_b16 a[190:191], v3 offset:32384
v_accvgpr_read_b32 v116, a60
v_accvgpr_read_b32 v117, a61
v_mfma_f32_16x16x32_bf16 a[76:79], a[160:163], v[60:63], a[76:79]
ds_read_b64_tr_b16 a[192:193], v3 offset:256
v_accvgpr_read_b32 v118, a62
v_accvgpr_read_b32 v119, a63
v_mfma_f32_16x16x32_bf16 a[76:79], a[164:167], v[132:135], a[76:79]
ds_read_b64_tr_b16 a[194:195], v3 offset:4864
v_cvt_pk_bf16_f32 v52, v112, v113
v_cvt_pk_bf16_f32 v53, v114, v115
v_mfma_f32_16x16x32_bf16 a[76:79], a[168:171], v[140:143], a[76:79]
ds_read_b64_tr_b16 a[196:197], v3 offset:9472
v_cvt_pk_bf16_f32 v54, v116, v117
v_cvt_pk_bf16_f32 v55, v118, v119
v_mfma_f32_16x16x32_bf16 a[76:79], a[172:175], v[148:151], a[76:79]
s_waitcnt lgkmcnt(3)
ds_read_b64_tr_b16 a[198:199], v3 offset:14080
s_add_u32 s41, s35, 12288
buffer_store_dwordx4 v[52:55], v30, s[20:23], s41 offen sc1
v_mfma_f32_16x16x32_bf16 a[80:83], a[176:179], v[56:59], a[80:83]
ds_read_b64_tr_b16 a[200:201], v3 offset:18688
v_mfma_f32_16x16x32_bf16 a[80:83], a[180:183], v[128:131], a[80:83]
ds_read_b64_tr_b16 a[202:203], v3 offset:23296
v_mfma_f32_16x16x32_bf16 a[80:83], a[184:187], v[136:139], a[80:83]
ds_read_b64_tr_b16 a[204:205], v3 offset:27904
v_accvgpr_read_b32 v64, a64
v_accvgpr_read_b32 v65, a65
v_mfma_f32_16x16x32_bf16 a[80:83], a[188:191], v[144:147], a[80:83]
ds_read_b64_tr_b16 a[206:207], v3 offset:32512
v_accvgpr_read_b32 v66, a66
v_accvgpr_read_b32 v67, a67
v_mfma_f32_16x16x32_bf16 a[84:87], a[176:179], v[60:63], a[84:87]
ds_read_b64_tr_b16 a[160:161], v3 offset:384
v_accvgpr_read_b32 v68, a72
v_accvgpr_read_b32 v69, a73
v_mfma_f32_16x16x32_bf16 a[84:87], a[180:183], v[132:135], a[84:87]
ds_read_b64_tr_b16 a[162:163], v3 offset:4992
v_accvgpr_read_b32 v70, a74
v_accvgpr_read_b32 v71, a75
v_mfma_f32_16x16x32_bf16 a[84:87], a[184:187], v[140:143], a[84:87]
ds_read_b64_tr_b16 a[164:165], v3 offset:9600
v_cvt_pk_bf16_f32 v40, v64, v65
v_cvt_pk_bf16_f32 v41, v66, v67
v_mfma_f32_16x16x32_bf16 a[84:87], a[188:191], v[148:151], a[84:87]
s_waitcnt lgkmcnt(3)
ds_read_b64_tr_b16 a[166:167], v3 offset:14208
v_cvt_pk_bf16_f32 v42, v68, v69
v_cvt_pk_bf16_f32 v43, v70, v71
v_mfma_f32_16x16x32_bf16 a[88:91], a[192:195], v[56:59], a[88:91]
ds_read_b64_tr_b16 a[168:169], v3 offset:18816
s_add_u32 s41, s35, 4096
buffer_store_dwordx4 v[40:43], v30, s[20:23], s41 offen sc1
v_mfma_f32_16x16x32_bf16 a[88:91], a[196:199], v[128:131], a[88:91]
ds_read_b64_tr_b16 a[170:171], v3 offset:23424
v_accvgpr_read_b32 v80, a68
v_accvgpr_read_b32 v81, a69
v_mfma_f32_16x16x32_bf16 a[88:91], a[200:203], v[136:139], a[88:91]
ds_read_b64_tr_b16 a[172:173], v3 offset:28032
v_accvgpr_read_b32 v82, a70
v_accvgpr_read_b32 v83, a71
v_mfma_f32_16x16x32_bf16 a[88:91], a[204:207], v[144:147], a[88:91]
ds_read_b64_tr_b16 a[174:175], v3 offset:32640
v_accvgpr_read_b32 v84, a76
v_accvgpr_read_b32 v85, a77
v_mfma_f32_16x16x32_bf16 a[92:95], a[192:195], v[60:63], a[92:95]
ds_read_b64_tr_b16 a[176:177], v3 offset:512
v_accvgpr_read_b32 v86, a78
v_accvgpr_read_b32 v87, a79
v_mfma_f32_16x16x32_bf16 a[92:95], a[196:199], v[132:135], a[92:95]
ds_read_b64_tr_b16 a[178:179], v3 offset:5120
v_cvt_pk_bf16_f32 v44, v80, v81
v_cvt_pk_bf16_f32 v45, v82, v83
v_mfma_f32_16x16x32_bf16 a[92:95], a[200:203], v[140:143], a[92:95]
ds_read_b64_tr_b16 a[180:181], v3 offset:9728
v_cvt_pk_bf16_f32 v46, v84, v85
v_cvt_pk_bf16_f32 v47, v86, v87
v_mfma_f32_16x16x32_bf16 a[92:95], a[204:207], v[148:151], a[92:95]
s_waitcnt lgkmcnt(3)
ds_read_b64_tr_b16 a[182:183], v3 offset:14336
s_add_u32 s41, s35, 13312
buffer_store_dwordx4 v[44:47], v30, s[20:23], s41 offen sc1
v_mfma_f32_16x16x32_bf16 a[96:99], a[160:163], v[56:59], a[96:99]
ds_read_b64_tr_b16 a[184:185], v3 offset:18944
v_mfma_f32_16x16x32_bf16 a[96:99], a[164:167], v[128:131], a[96:99]
ds_read_b64_tr_b16 a[186:187], v3 offset:23552
v_mfma_f32_16x16x32_bf16 a[96:99], a[168:171], v[136:139], a[96:99]
ds_read_b64_tr_b16 a[188:189], v3 offset:28160
v_accvgpr_read_b32 v96, a80
v_accvgpr_read_b32 v97, a81
v_mfma_f32_16x16x32_bf16 a[96:99], a[172:175], v[144:147], a[96:99]
ds_read_b64_tr_b16 a[190:191], v3 offset:32768
v_accvgpr_read_b32 v98, a82
v_accvgpr_read_b32 v99, a83
v_mfma_f32_16x16x32_bf16 a[100:103], a[160:163], v[60:63], a[100:103]
ds_read_b64_tr_b16 a[192:193], v3 offset:640
v_accvgpr_read_b32 v100, a88
v_accvgpr_read_b32 v101, a89
v_mfma_f32_16x16x32_bf16 a[100:103], a[164:167], v[132:135], a[100:103]
ds_read_b64_tr_b16 a[194:195], v3 offset:5248
v_accvgpr_read_b32 v102, a90
v_accvgpr_read_b32 v103, a91
v_mfma_f32_16x16x32_bf16 a[100:103], a[168:171], v[140:143], a[100:103]
ds_read_b64_tr_b16 a[196:197], v3 offset:9856
v_cvt_pk_bf16_f32 v48, v96, v97
v_cvt_pk_bf16_f32 v49, v98, v99
v_mfma_f32_16x16x32_bf16 a[100:103], a[172:175], v[148:151], a[100:103]
s_waitcnt lgkmcnt(3)
ds_read_b64_tr_b16 a[198:199], v3 offset:14464
v_cvt_pk_bf16_f32 v50, v100, v101
v_cvt_pk_bf16_f32 v51, v102, v103
v_mfma_f32_16x16x32_bf16 a[104:107], a[176:179], v[56:59], a[104:107]
ds_read_b64_tr_b16 a[200:201], v3 offset:19072
s_add_u32 s41, s35, 5120
buffer_store_dwordx4 v[48:51], v30, s[20:23], s41 offen sc1
v_mfma_f32_16x16x32_bf16 a[104:107], a[180:183], v[128:131], a[104:107]
ds_read_b64_tr_b16 a[202:203], v3 offset:23680
v_accvgpr_read_b32 v112, a84
v_accvgpr_read_b32 v113, a85
v_mfma_f32_16x16x32_bf16 a[104:107], a[184:187], v[136:139], a[104:107]
ds_read_b64_tr_b16 a[204:205], v3 offset:28288
v_accvgpr_read_b32 v114, a86
v_accvgpr_read_b32 v115, a87
v_mfma_f32_16x16x32_bf16 a[104:107], a[188:191], v[144:147], a[104:107]
ds_read_b64_tr_b16 a[206:207], v3 offset:32896
v_accvgpr_read_b32 v116, a92
v_accvgpr_read_b32 v117, a93
v_mfma_f32_16x16x32_bf16 a[108:111], a[176:179], v[60:63], a[108:111]
ds_read_b64_tr_b16 a[160:161], v3 offset:768
v_accvgpr_read_b32 v118, a94
v_accvgpr_read_b32 v119, a95
v_mfma_f32_16x16x32_bf16 a[108:111], a[180:183], v[132:135], a[108:111]
ds_read_b64_tr_b16 a[162:163], v3 offset:5376
v_cvt_pk_bf16_f32 v52, v112, v113
v_cvt_pk_bf16_f32 v53, v114, v115
v_mfma_f32_16x16x32_bf16 a[108:111], a[184:187], v[140:143], a[108:111]
ds_read_b64_tr_b16 a[164:165], v3 offset:9984
v_cvt_pk_bf16_f32 v54, v116, v117
v_cvt_pk_bf16_f32 v55, v118, v119
v_mfma_f32_16x16x32_bf16 a[108:111], a[188:191], v[148:151], a[108:111]
s_waitcnt lgkmcnt(3)
ds_read_b64_tr_b16 a[166:167], v3 offset:14592
s_add_u32 s41, s35, 14336
buffer_store_dwordx4 v[52:55], v30, s[20:23], s41 offen sc1
v_mfma_f32_16x16x32_bf16 a[112:115], a[192:195], v[56:59], a[112:115]
ds_read_b64_tr_b16 a[168:169], v3 offset:19200
v_mfma_f32_16x16x32_bf16 a[112:115], a[196:199], v[128:131], a[112:115]
ds_read_b64_tr_b16 a[170:171], v3 offset:23808
v_mfma_f32_16x16x32_bf16 a[112:115], a[200:203], v[136:139], a[112:115]
ds_read_b64_tr_b16 a[172:173], v3 offset:28416
v_accvgpr_read_b32 v64, a96
v_accvgpr_read_b32 v65, a97
v_mfma_f32_16x16x32_bf16 a[112:115], a[204:207], v[144:147], a[112:115]
ds_read_b64_tr_b16 a[174:175], v3 offset:33024
v_accvgpr_read_b32 v66, a98
v_accvgpr_read_b32 v67, a99
v_mfma_f32_16x16x32_bf16 a[116:119], a[192:195], v[60:63], a[116:119]
ds_read_b64_tr_b16 a[176:177], v3 offset:896
v_accvgpr_read_b32 v68, a104
v_accvgpr_read_b32 v69, a105
v_mfma_f32_16x16x32_bf16 a[116:119], a[196:199], v[132:135], a[116:119]
ds_read_b64_tr_b16 a[178:179], v3 offset:5504
v_accvgpr_read_b32 v70, a106
v_accvgpr_read_b32 v71, a107
v_mfma_f32_16x16x32_bf16 a[116:119], a[200:203], v[140:143], a[116:119]
ds_read_b64_tr_b16 a[180:181], v3 offset:10112
v_cvt_pk_bf16_f32 v40, v64, v65
v_cvt_pk_bf16_f32 v41, v66, v67
v_mfma_f32_16x16x32_bf16 a[116:119], a[204:207], v[148:151], a[116:119]
s_waitcnt lgkmcnt(3)
ds_read_b64_tr_b16 a[182:183], v3 offset:14720
v_cvt_pk_bf16_f32 v42, v68, v69
v_cvt_pk_bf16_f32 v43, v70, v71
v_mfma_f32_16x16x32_bf16 a[120:123], a[160:163], v[56:59], a[120:123]
ds_read_b64_tr_b16 a[184:185], v3 offset:19328
s_add_u32 s41, s35, 6144
buffer_store_dwordx4 v[40:43], v30, s[20:23], s41 offen sc1
v_mfma_f32_16x16x32_bf16 a[120:123], a[164:167], v[128:131], a[120:123]
ds_read_b64_tr_b16 a[186:187], v3 offset:23936
v_accvgpr_read_b32 v80, a100
v_accvgpr_read_b32 v81, a101
v_mfma_f32_16x16x32_bf16 a[120:123], a[168:171], v[136:139], a[120:123]
ds_read_b64_tr_b16 a[188:189], v3 offset:28544
v_accvgpr_read_b32 v82, a102
v_accvgpr_read_b32 v83, a103
v_mfma_f32_16x16x32_bf16 a[120:123], a[172:175], v[144:147], a[120:123]
ds_read_b64_tr_b16 a[190:191], v3 offset:33152
v_accvgpr_read_b32 v84, a108
v_accvgpr_read_b32 v85, a109
v_mfma_f32_16x16x32_bf16 a[124:127], a[160:163], v[60:63], a[124:127]
ds_read_b64_tr_b16 a[192:193], v3 offset:1024
v_accvgpr_read_b32 v86, a110
v_accvgpr_read_b32 v87, a111
v_mfma_f32_16x16x32_bf16 a[124:127], a[164:167], v[132:135], a[124:127]
ds_read_b64_tr_b16 a[194:195], v3 offset:5632
v_cvt_pk_bf16_f32 v44, v80, v81
v_cvt_pk_bf16_f32 v45, v82, v83
v_mfma_f32_16x16x32_bf16 a[124:127], a[168:171], v[140:143], a[124:127]
ds_read_b64_tr_b16 a[196:197], v3 offset:10240
v_cvt_pk_bf16_f32 v46, v84, v85
v_cvt_pk_bf16_f32 v47, v86, v87
v_mfma_f32_16x16x32_bf16 a[124:127], a[172:175], v[148:151], a[124:127]
s_waitcnt lgkmcnt(3)
ds_read_b64_tr_b16 a[198:199], v3 offset:14848
s_add_u32 s41, s35, 15360
buffer_store_dwordx4 v[44:47], v30, s[20:23], s41 offen sc1
v_mfma_f32_16x16x32_bf16 a[128:131], a[176:179], v[56:59], a[128:131]
ds_read_b64_tr_b16 a[200:201], v3 offset:19456
v_mfma_f32_16x16x32_bf16 a[128:131], a[180:183], v[128:131], a[128:131]
ds_read_b64_tr_b16 a[202:203], v3 offset:24064
v_mfma_f32_16x16x32_bf16 a[128:131], a[184:187], v[136:139], a[128:131]
ds_read_b64_tr_b16 a[204:205], v3 offset:28672
v_accvgpr_read_b32 v96, a112
v_accvgpr_read_b32 v97, a113
v_mfma_f32_16x16x32_bf16 a[128:131], a[188:191], v[144:147], a[128:131]
ds_read_b64_tr_b16 a[206:207], v3 offset:33280
v_accvgpr_read_b32 v98, a114
v_accvgpr_read_b32 v99, a115
v_mfma_f32_16x16x32_bf16 a[132:135], a[176:179], v[60:63], a[132:135]
s_waitcnt vmcnt(6)
s_lshl_b32 s50, s60, 1
s_add_u32 s50, s50, s59
s_lshl_b32 s50, s50, 8
s_add_u32 s50, s50, 0x4ba000
v_mov_b32 v2, 1
s_mov_b64 exec, 1
buffer_atomic_add v2, off, s[20:23], s50
s_mov_b64 exec, -1
s_nop 3
v_mfma_f32_16x16x32_bf16 a[132:135], a[180:183], v[132:135], a[132:135]
v_accvgpr_read_b32 v100, a120
v_accvgpr_read_b32 v101, a121
v_accvgpr_read_b32 v102, a122
v_mfma_f32_16x16x32_bf16 a[132:135], a[184:187], v[140:143], a[132:135]
v_accvgpr_read_b32 v103, a123
v_cvt_pk_bf16_f32 v48, v96, v97
v_cvt_pk_bf16_f32 v49, v98, v99
v_mfma_f32_16x16x32_bf16 a[132:135], a[188:191], v[148:151], a[132:135]
s_waitcnt lgkmcnt(0)
v_cvt_pk_bf16_f32 v50, v100, v101
v_cvt_pk_bf16_f32 v51, v102, v103
v_mfma_f32_16x16x32_bf16 a[136:139], a[192:195], v[56:59], a[136:139]
s_add_u32 s41, s35, 7168
buffer_store_dwordx4 v[48:51], v30, s[20:23], s41 offen sc1
v_accvgpr_read_b32 v112, a116
v_mfma_f32_16x16x32_bf16 a[136:139], a[196:199], v[128:131], a[136:139]
v_accvgpr_read_b32 v113, a117
v_accvgpr_read_b32 v114, a118
v_accvgpr_read_b32 v115, a119
v_mfma_f32_16x16x32_bf16 a[136:139], a[200:203], v[136:139], a[136:139]
v_accvgpr_read_b32 v116, a124
v_accvgpr_read_b32 v117, a125
v_accvgpr_read_b32 v118, a126
v_mfma_f32_16x16x32_bf16 a[136:139], a[204:207], v[144:147], a[136:139]
v_accvgpr_read_b32 v119, a127
v_cvt_pk_bf16_f32 v52, v112, v113
v_cvt_pk_bf16_f32 v53, v114, v115
v_mfma_f32_16x16x32_bf16 a[140:143], a[192:195], v[60:63], a[140:143]
v_cvt_pk_bf16_f32 v54, v116, v117
v_cvt_pk_bf16_f32 v55, v118, v119
s_add_u32 s41, s35, 16384
buffer_store_dwordx4 v[52:55], v30, s[20:23], s41 offen sc1
v_mfma_f32_16x16x32_bf16 a[140:143], a[196:199], v[132:135], a[140:143]
v_mfma_f32_16x16x32_bf16 a[140:143], a[200:203], v[140:143], a[140:143]
v_mfma_f32_16x16x32_bf16 a[140:143], a[204:207], v[148:151], a[140:143]
s_nop 7
v_accvgpr_read_b32 v64, a128
v_accvgpr_read_b32 v65, a129
v_accvgpr_read_b32 v66, a130
v_accvgpr_read_b32 v67, a131
v_accvgpr_read_b32 v68, a136
v_accvgpr_read_b32 v69, a137
v_accvgpr_read_b32 v70, a138
v_accvgpr_read_b32 v71, a139
v_cvt_pk_bf16_f32 v40, v64, v65
v_cvt_pk_bf16_f32 v41, v66, v67
v_cvt_pk_bf16_f32 v42, v68, v69
v_cvt_pk_bf16_f32 v43, v70, v71
s_add_u32 s41, s35, 8192
buffer_store_dwordx4 v[40:43], v30, s[20:23], s41 offen sc1
v_accvgpr_read_b32 v80, a132
v_accvgpr_read_b32 v81, a133
v_accvgpr_read_b32 v82, a134
v_accvgpr_read_b32 v83, a135
v_accvgpr_read_b32 v84, a140
v_accvgpr_read_b32 v85, a141
v_accvgpr_read_b32 v86, a142
v_accvgpr_read_b32 v87, a143
v_cvt_pk_bf16_f32 v44, v80, v81
v_cvt_pk_bf16_f32 v45, v82, v83
v_cvt_pk_bf16_f32 v46, v84, v85
v_cvt_pk_bf16_f32 v47, v86, v87
s_add_u32 s41, s35, 17408
buffer_store_dwordx4 v[44:47], v30, s[20:23], s41 offen sc1
s_load_dwordx2 s[4:5], s[0:1], 56
s_lshl_b32 s28, s60, 1
s_add_u32 s28, s28, s59
s_lshl_b32 s29, s60, 3
s_add_u32 s29, s29, s58
s_lshl_b32 s30, s28, 6
s_add_u32 s30, s30, s58
s_mul_i32 s30, s30, 9
s_add_u32 s30, s30, s24
s_lshl_b32 s30, s30, 10
s_add_u32 s30, s30, 0x1700000
s_mul_i32 s31, s59, 9
s_add_u32 s31, s31, s24
s_mul_i32 s32, s29, 18
s_add_u32 s32, s32, s31
s_lshl_b32 s32, s32, 10
s_add_u32 s32, s32, 0x2900000
v_and_b32 v2, 15, v0
v_lshlrev_b32 v3, 3, v2
s_lshl_b32 s41, s29, 7
s_add_u32 s41, s41, 0x480000
buffer_load_dword v4, v3, s[20:23], s41 offen sc1
s_lshl_b32 s42, s29, 4
v_add_u32 v5, s42, v2
v_mul_u32_u24 v5, 1152, v5
v_bfe_u32 v3, v0, 4, 1
v_lshl_add_u32 v5, v3, 5, v5
v_bfe_u32 v3, v0, 5, 1
v_lshl_add_u32 v5, v3, 4, v5
s_waitcnt lgkmcnt(0)
s_mov_b32 s6, 2359296
s_mov_b32 s7, 0x20000
s_cmp_lg_u32 s24, 0
s_cbranch_scc1 L_sequential_preLN__sliding_local_dilated__glu_gated_geglu__prompt_kernel_rago
s_lshl_b32 s51, s28, 8
s_add_u32 s51, s51, 0x4ba000
s_mov_b32 s52, 0x4000
L_sequential_preLN__sliding_local_dilated__glu_gated_geglu__prompt_kernel_rawait:
buffer_load_dword v6, off, s[20:23], s51 sc1
s_waitcnt vmcnt(0)
v_readfirstlane_b32 s53, v6
s_sub_u32 s52, s52, 1
s_cmp_eq_u32 s52, 0
s_cbranch_scc1 L_sequential_preLN__sliding_local_dilated__glu_gated_geglu__prompt_kernel_rago
s_cmp_ge_u32 s53, 32
s_cbranch_scc1 L_sequential_preLN__sliding_local_dilated__glu_gated_geglu__prompt_kernel_rago
s_sleep 2
s_branch L_sequential_preLN__sliding_local_dilated__glu_gated_geglu__prompt_kernel_rawait
L_sequential_preLN__sliding_local_dilated__glu_gated_geglu__prompt_kernel_rago:
s_barrier
s_add_u32 s41, s32, 0
buffer_load_dwordx4 v[64:67], v30, s[20:23], s41 offen sc1
s_add_u32 s41, s30, 0
buffer_load_dwordx4 v[68:71], v30, s[20:23], s41 offen sc1
s_add_u32 s41, s30, 73728
buffer_load_dwordx4 v[72:75], v30, s[20:23], s41 offen sc1
s_add_u32 s41, s30, 147456
buffer_load_dwordx4 v[76:79], v30, s[20:23], s41 offen sc1
s_add_u32 s41, s30, 221184
buffer_load_dwordx4 v[80:83], v30, s[20:23], s41 offen sc1
s_add_u32 s41, s30, 294912
buffer_load_dwordx4 v[84:87], v30, s[20:23], s41 offen sc1
s_add_u32 s41, s30, 368640
buffer_load_dwordx4 v[88:91], v30, s[20:23], s41 offen sc1
s_add_u32 s41, s30, 442368
buffer_load_dwordx4 v[92:95], v30, s[20:23], s41 offen sc1
s_add_u32 s41, s30, 516096
buffer_load_dwordx4 v[96:99], v30, s[20:23], s41 offen sc1
s_waitcnt vmcnt(10)
s_barrier
s_cmp_lg_u32 s24, 0
s_cbranch_scc1 L_sequential_preLN__sliding_local_dilated__glu_gated_geglu__prompt_kernel_rarr
s_lshl_b32 s51, s28, 8
s_add_u32 s51, s51, 0x4b4000
v_mov_b32 v2, 1
s_mov_b64 exec, 1
buffer_atomic_add v2, off, s[20:23], s51
s_mov_b64 exec, -1
L_sequential_preLN__sliding_local_dilated__glu_gated_geglu__prompt_kernel_rarr:
s_waitcnt vmcnt(8)
v_dot2_f32_bf16 v176, v64, s46, v4
v_dot2_f32_bf16 v177, v64, s47, v4
v_dot2_f32_bf16 v178, v65, s46, v4
v_dot2_f32_bf16 v179, v65, s47, v4
v_dot2_f32_bf16 v180, v66, s46, v4
v_dot2_f32_bf16 v181, v66, s47, v4
v_dot2_f32_bf16 v182, v67, s46, v4
v_dot2_f32_bf16 v183, v67, s47, v4
s_waitcnt vmcnt(7)
v_dot2_f32_bf16 v176, v68, s46, v176
v_dot2_f32_bf16 v177, v68, s47, v177
v_dot2_f32_bf16 v178, v69, s46, v178
v_dot2_f32_bf16 v179, v69, s47, v179
v_dot2_f32_bf16 v180, v70, s46, v180
v_dot2_f32_bf16 v181, v70, s47, v181
v_dot2_f32_bf16 v182, v71, s46, v182
v_dot2_f32_bf16 v183, v71, s47, v183
s_waitcnt vmcnt(6)
v_dot2_f32_bf16 v176, v72, s46, v176
v_dot2_f32_bf16 v177, v72, s47, v177
v_dot2_f32_bf16 v178, v73, s46, v178
v_dot2_f32_bf16 v179, v73, s47, v179
v_dot2_f32_bf16 v180, v74, s46, v180
v_dot2_f32_bf16 v181, v74, s47, v181
v_dot2_f32_bf16 v182, v75, s46, v182
v_dot2_f32_bf16 v183, v75, s47, v183
s_waitcnt vmcnt(5)
v_dot2_f32_bf16 v176, v76, s46, v176
v_dot2_f32_bf16 v177, v76, s47, v177
v_dot2_f32_bf16 v178, v77, s46, v178
v_dot2_f32_bf16 v179, v77, s47, v179
v_dot2_f32_bf16 v180, v78, s46, v180
v_dot2_f32_bf16 v181, v78, s47, v181
v_dot2_f32_bf16 v182, v79, s46, v182
v_dot2_f32_bf16 v183, v79, s47, v183
s_waitcnt vmcnt(4)
v_dot2_f32_bf16 v176, v80, s46, v176
v_dot2_f32_bf16 v177, v80, s47, v177
v_dot2_f32_bf16 v178, v81, s46, v178
v_dot2_f32_bf16 v179, v81, s47, v179
v_dot2_f32_bf16 v180, v82, s46, v180
v_dot2_f32_bf16 v181, v82, s47, v181
v_dot2_f32_bf16 v182, v83, s46, v182
v_dot2_f32_bf16 v183, v83, s47, v183
s_waitcnt vmcnt(3)
v_dot2_f32_bf16 v176, v84, s46, v176
v_dot2_f32_bf16 v177, v84, s47, v177
v_dot2_f32_bf16 v178, v85, s46, v178
v_dot2_f32_bf16 v179, v85, s47, v179
v_dot2_f32_bf16 v180, v86, s46, v180
v_dot2_f32_bf16 v181, v86, s47, v181
v_dot2_f32_bf16 v182, v87, s46, v182
v_dot2_f32_bf16 v183, v87, s47, v183
s_waitcnt vmcnt(2)
v_dot2_f32_bf16 v176, v88, s46, v176
v_dot2_f32_bf16 v177, v88, s47, v177
v_dot2_f32_bf16 v178, v89, s46, v178
v_dot2_f32_bf16 v179, v89, s47, v179
v_dot2_f32_bf16 v180, v90, s46, v180
v_dot2_f32_bf16 v181, v90, s47, v181
v_dot2_f32_bf16 v182, v91, s46, v182
v_dot2_f32_bf16 v183, v91, s47, v183
s_waitcnt vmcnt(1)
v_dot2_f32_bf16 v176, v92, s46, v176
v_dot2_f32_bf16 v177, v92, s47, v177
v_dot2_f32_bf16 v178, v93, s46, v178
v_dot2_f32_bf16 v179, v93, s47, v179
v_dot2_f32_bf16 v180, v94, s46, v180
v_dot2_f32_bf16 v181, v94, s47, v181
v_dot2_f32_bf16 v182, v95, s46, v182
v_dot2_f32_bf16 v183, v95, s47, v183
s_waitcnt vmcnt(0)
v_dot2_f32_bf16 v176, v96, s46, v176
v_dot2_f32_bf16 v177, v96, s47, v177
v_dot2_f32_bf16 v178, v97, s46, v178
v_dot2_f32_bf16 v179, v97, s47, v179
v_dot2_f32_bf16 v180, v98, s46, v180
v_dot2_f32_bf16 v181, v98, s47, v181
v_dot2_f32_bf16 v182, v99, s46, v182
v_dot2_f32_bf16 v183, v99, s47, v183
s_nop 2
v_cvt_pk_bf16_f32 v200, v176, v177
v_cvt_pk_bf16_f32 v201, v178, v179
v_cvt_pk_bf16_f32 v202, v180, v181
v_cvt_pk_bf16_f32 v203, v182, v183
s_nop 1
v_permlane16_swap_b32 v200, v202
v_permlane16_swap_b32 v201, v203
s_add_u32 s41, s31, 0
s_lshl_b32 s41, s41, 6
buffer_store_dwordx4 v[200:203], v5, s[4:7], s41 offen
s_cmp_lg_u32 s24, 0
s_cbranch_scc1 L_sequential_preLN__sliding_local_dilated__glu_gated_geglu__prompt_kernel_rbgo
s_lshl_b32 s51, s28, 8
s_add_u32 s51, s51, 0x4b4000
s_mov_b32 s52, 0x4000
L_sequential_preLN__sliding_local_dilated__glu_gated_geglu__prompt_kernel_rbwait:
buffer_load_dword v6, off, s[20:23], s51 sc1
s_waitcnt vmcnt(0)
v_readfirstlane_b32 s53, v6
s_sub_u32 s52, s52, 1
s_cmp_eq_u32 s52, 0
s_cbranch_scc1 L_sequential_preLN__sliding_local_dilated__glu_gated_geglu__prompt_kernel_rbgo
s_cmp_ge_u32 s53, 8
s_cbranch_scc1 L_sequential_preLN__sliding_local_dilated__glu_gated_geglu__prompt_kernel_rbgo
s_sleep 2
s_branch L_sequential_preLN__sliding_local_dilated__glu_gated_geglu__prompt_kernel_rbwait
L_sequential_preLN__sliding_local_dilated__glu_gated_geglu__prompt_kernel_rbgo:
s_barrier
s_add_u32 s41, s32, 4096
buffer_load_dwordx4 v[100:103], v30, s[20:23], s41 offen sc1
s_add_u32 s41, s30, 4096
buffer_load_dwordx4 v[104:107], v30, s[20:23], s41 offen sc1
s_add_u32 s41, s30, 77824
buffer_load_dwordx4 v[108:111], v30, s[20:23], s41 offen sc1
s_add_u32 s41, s30, 151552
buffer_load_dwordx4 v[112:115], v30, s[20:23], s41 offen sc1
s_add_u32 s41, s30, 225280
buffer_load_dwordx4 v[116:119], v30, s[20:23], s41 offen sc1
s_add_u32 s41, s30, 299008
buffer_load_dwordx4 v[120:123], v30, s[20:23], s41 offen sc1
s_add_u32 s41, s30, 372736
buffer_load_dwordx4 v[124:127], v30, s[20:23], s41 offen sc1
s_add_u32 s41, s30, 446464
buffer_load_dwordx4 v[128:131], v30, s[20:23], s41 offen sc1
s_add_u32 s41, s30, 520192
buffer_load_dwordx4 v[132:135], v30, s[20:23], s41 offen sc1
s_cmp_lg_u32 s24, 0
s_cbranch_scc1 L_sequential_preLN__sliding_local_dilated__glu_gated_geglu__prompt_kernel_r2
s_add_u32 s41, s32, 8192
buffer_load_dwordx4 v[136:139], v30, s[20:23], s41 offen sc1
s_add_u32 s41, s30, 8192
buffer_load_dwordx4 v[140:143], v30, s[20:23], s41 offen sc1
s_add_u32 s41, s30, 81920
buffer_load_dwordx4 v[144:147], v30, s[20:23], s41 offen sc1
s_add_u32 s41, s30, 155648
buffer_load_dwordx4 v[148:151], v30, s[20:23], s41 offen sc1
s_add_u32 s41, s30, 229376
buffer_load_dwordx4 v[152:155], v30, s[20:23], s41 offen sc1
s_add_u32 s41, s30, 303104
buffer_load_dwordx4 v[156:159], v30, s[20:23], s41 offen sc1
s_add_u32 s41, s30, 376832
buffer_load_dwordx4 v[160:163], v30, s[20:23], s41 offen sc1
s_add_u32 s41, s30, 450560
buffer_load_dwordx4 v[164:167], v30, s[20:23], s41 offen sc1
s_add_u32 s41, s30, 524288
buffer_load_dwordx4 v[168:171], v30, s[20:23], s41 offen sc1
s_waitcnt vmcnt(17)
v_dot2_f32_bf16 v184, v100, s46, v4
v_dot2_f32_bf16 v185, v100, s47, v4
v_dot2_f32_bf16 v186, v101, s46, v4
v_dot2_f32_bf16 v187, v101, s47, v4
v_dot2_f32_bf16 v188, v102, s46, v4
v_dot2_f32_bf16 v189, v102, s47, v4
v_dot2_f32_bf16 v190, v103, s46, v4
v_dot2_f32_bf16 v191, v103, s47, v4
s_waitcnt vmcnt(16)
v_dot2_f32_bf16 v184, v104, s46, v184
v_dot2_f32_bf16 v185, v104, s47, v185
v_dot2_f32_bf16 v186, v105, s46, v186
v_dot2_f32_bf16 v187, v105, s47, v187
v_dot2_f32_bf16 v188, v106, s46, v188
v_dot2_f32_bf16 v189, v106, s47, v189
v_dot2_f32_bf16 v190, v107, s46, v190
v_dot2_f32_bf16 v191, v107, s47, v191
s_waitcnt vmcnt(15)
v_dot2_f32_bf16 v184, v108, s46, v184
v_dot2_f32_bf16 v185, v108, s47, v185
v_dot2_f32_bf16 v186, v109, s46, v186
v_dot2_f32_bf16 v187, v109, s47, v187
v_dot2_f32_bf16 v188, v110, s46, v188
v_dot2_f32_bf16 v189, v110, s47, v189
v_dot2_f32_bf16 v190, v111, s46, v190
v_dot2_f32_bf16 v191, v111, s47, v191
s_waitcnt vmcnt(14)
v_dot2_f32_bf16 v184, v112, s46, v184
v_dot2_f32_bf16 v185, v112, s47, v185
v_dot2_f32_bf16 v186, v113, s46, v186
v_dot2_f32_bf16 v187, v113, s47, v187
v_dot2_f32_bf16 v188, v114, s46, v188
v_dot2_f32_bf16 v189, v114, s47, v189
v_dot2_f32_bf16 v190, v115, s46, v190
v_dot2_f32_bf16 v191, v115, s47, v191
s_waitcnt vmcnt(13)
v_dot2_f32_bf16 v184, v116, s46, v184
v_dot2_f32_bf16 v185, v116, s47, v185
v_dot2_f32_bf16 v186, v117, s46, v186
v_dot2_f32_bf16 v187, v117, s47, v187
v_dot2_f32_bf16 v188, v118, s46, v188
v_dot2_f32_bf16 v189, v118, s47, v189
v_dot2_f32_bf16 v190, v119, s46, v190
v_dot2_f32_bf16 v191, v119, s47, v191
s_waitcnt vmcnt(12)
v_dot2_f32_bf16 v184, v120, s46, v184
v_dot2_f32_bf16 v185, v120, s47, v185
v_dot2_f32_bf16 v186, v121, s46, v186
v_dot2_f32_bf16 v187, v121, s47, v187
v_dot2_f32_bf16 v188, v122, s46, v188
v_dot2_f32_bf16 v189, v122, s47, v189
v_dot2_f32_bf16 v190, v123, s46, v190
v_dot2_f32_bf16 v191, v123, s47, v191
s_waitcnt vmcnt(11)
v_dot2_f32_bf16 v184, v124, s46, v184
v_dot2_f32_bf16 v185, v124, s47, v185
v_dot2_f32_bf16 v186, v125, s46, v186
v_dot2_f32_bf16 v187, v125, s47, v187
v_dot2_f32_bf16 v188, v126, s46, v188
v_dot2_f32_bf16 v189, v126, s47, v189
v_dot2_f32_bf16 v190, v127, s46, v190
v_dot2_f32_bf16 v191, v127, s47, v191
s_waitcnt vmcnt(10)
v_dot2_f32_bf16 v184, v128, s46, v184
v_dot2_f32_bf16 v185, v128, s47, v185
v_dot2_f32_bf16 v186, v129, s46, v186
v_dot2_f32_bf16 v187, v129, s47, v187
v_dot2_f32_bf16 v188, v130, s46, v188
v_dot2_f32_bf16 v189, v130, s47, v189
v_dot2_f32_bf16 v190, v131, s46, v190
v_dot2_f32_bf16 v191, v131, s47, v191
s_waitcnt vmcnt(9)
v_dot2_f32_bf16 v184, v132, s46, v184
v_dot2_f32_bf16 v185, v132, s47, v185
v_dot2_f32_bf16 v186, v133, s46, v186
v_dot2_f32_bf16 v187, v133, s47, v187
v_dot2_f32_bf16 v188, v134, s46, v188
v_dot2_f32_bf16 v189, v134, s47, v189
v_dot2_f32_bf16 v190, v135, s46, v190
v_dot2_f32_bf16 v191, v135, s47, v191
s_nop 2
v_cvt_pk_bf16_f32 v204, v184, v185
v_cvt_pk_bf16_f32 v205, v186, v187
v_cvt_pk_bf16_f32 v206, v188, v189
v_cvt_pk_bf16_f32 v207, v190, v191
s_nop 1
v_permlane16_swap_b32 v204, v206
v_permlane16_swap_b32 v205, v207
s_add_u32 s41, s31, 4
s_lshl_b32 s41, s41, 6
buffer_store_dwordx4 v[204:207], v5, s[4:7], s41 offen
s_waitcnt vmcnt(9)
v_dot2_f32_bf16 v192, v136, s46, v4
v_dot2_f32_bf16 v193, v136, s47, v4
v_dot2_f32_bf16 v194, v137, s46, v4
v_dot2_f32_bf16 v195, v137, s47, v4
v_dot2_f32_bf16 v196, v138, s46, v4
v_dot2_f32_bf16 v197, v138, s47, v4
v_dot2_f32_bf16 v198, v139, s46, v4
v_dot2_f32_bf16 v199, v139, s47, v4
s_waitcnt vmcnt(8)
v_dot2_f32_bf16 v192, v140, s46, v192
v_dot2_f32_bf16 v193, v140, s47, v193
v_dot2_f32_bf16 v194, v141, s46, v194
v_dot2_f32_bf16 v195, v141, s47, v195
v_dot2_f32_bf16 v196, v142, s46, v196
v_dot2_f32_bf16 v197, v142, s47, v197
v_dot2_f32_bf16 v198, v143, s46, v198
v_dot2_f32_bf16 v199, v143, s47, v199
s_waitcnt vmcnt(7)
v_dot2_f32_bf16 v192, v144, s46, v192
v_dot2_f32_bf16 v193, v144, s47, v193
v_dot2_f32_bf16 v194, v145, s46, v194
v_dot2_f32_bf16 v195, v145, s47, v195
v_dot2_f32_bf16 v196, v146, s46, v196
v_dot2_f32_bf16 v197, v146, s47, v197
v_dot2_f32_bf16 v198, v147, s46, v198
v_dot2_f32_bf16 v199, v147, s47, v199
s_waitcnt vmcnt(6)
v_dot2_f32_bf16 v192, v148, s46, v192
v_dot2_f32_bf16 v193, v148, s47, v193
v_dot2_f32_bf16 v194, v149, s46, v194
v_dot2_f32_bf16 v195, v149, s47, v195
v_dot2_f32_bf16 v196, v150, s46, v196
v_dot2_f32_bf16 v197, v150, s47, v197
v_dot2_f32_bf16 v198, v151, s46, v198
v_dot2_f32_bf16 v199, v151, s47, v199
s_waitcnt vmcnt(5)
v_dot2_f32_bf16 v192, v152, s46, v192
v_dot2_f32_bf16 v193, v152, s47, v193
v_dot2_f32_bf16 v194, v153, s46, v194
v_dot2_f32_bf16 v195, v153, s47, v195
v_dot2_f32_bf16 v196, v154, s46, v196
v_dot2_f32_bf16 v197, v154, s47, v197
v_dot2_f32_bf16 v198, v155, s46, v198
v_dot2_f32_bf16 v199, v155, s47, v199
s_waitcnt vmcnt(4)
v_dot2_f32_bf16 v192, v156, s46, v192
v_dot2_f32_bf16 v193, v156, s47, v193
v_dot2_f32_bf16 v194, v157, s46, v194
v_dot2_f32_bf16 v195, v157, s47, v195
v_dot2_f32_bf16 v196, v158, s46, v196
v_dot2_f32_bf16 v197, v158, s47, v197
v_dot2_f32_bf16 v198, v159, s46, v198
v_dot2_f32_bf16 v199, v159, s47, v199
s_waitcnt vmcnt(3)
v_dot2_f32_bf16 v192, v160, s46, v192
v_dot2_f32_bf16 v193, v160, s47, v193
v_dot2_f32_bf16 v194, v161, s46, v194
v_dot2_f32_bf16 v195, v161, s47, v195
v_dot2_f32_bf16 v196, v162, s46, v196
v_dot2_f32_bf16 v197, v162, s47, v197
v_dot2_f32_bf16 v198, v163, s46, v198
v_dot2_f32_bf16 v199, v163, s47, v199
s_waitcnt vmcnt(2)
v_dot2_f32_bf16 v192, v164, s46, v192
v_dot2_f32_bf16 v193, v164, s47, v193
v_dot2_f32_bf16 v194, v165, s46, v194
v_dot2_f32_bf16 v195, v165, s47, v195
v_dot2_f32_bf16 v196, v166, s46, v196
v_dot2_f32_bf16 v197, v166, s47, v197
v_dot2_f32_bf16 v198, v167, s46, v198
v_dot2_f32_bf16 v199, v167, s47, v199
s_waitcnt vmcnt(1)
v_dot2_f32_bf16 v192, v168, s46, v192
v_dot2_f32_bf16 v193, v168, s47, v193
v_dot2_f32_bf16 v194, v169, s46, v194
v_dot2_f32_bf16 v195, v169, s47, v195
v_dot2_f32_bf16 v196, v170, s46, v196
v_dot2_f32_bf16 v197, v170, s47, v197
v_dot2_f32_bf16 v198, v171, s46, v198
v_dot2_f32_bf16 v199, v171, s47, v199
s_nop 2
v_cvt_pk_bf16_f32 v208, v192, v193
v_cvt_pk_bf16_f32 v209, v194, v195
v_cvt_pk_bf16_f32 v210, v196, v197
v_cvt_pk_bf16_f32 v211, v198, v199
s_nop 1
v_permlane16_swap_b32 v208, v210
v_permlane16_swap_b32 v209, v211
s_add_u32 s41, s31, 8
s_lshl_b32 s41, s41, 6
buffer_store_dwordx4 v[208:211], v5, s[4:7], s41 offen
s_branch L_sequential_preLN__sliding_local_dilated__glu_gated_geglu__prompt_kernel_rend
L_sequential_preLN__sliding_local_dilated__glu_gated_geglu__prompt_kernel_r2:
s_waitcnt vmcnt(8)
v_dot2_f32_bf16 v184, v100, s46, v4
v_dot2_f32_bf16 v185, v100, s47, v4
v_dot2_f32_bf16 v186, v101, s46, v4
v_dot2_f32_bf16 v187, v101, s47, v4
v_dot2_f32_bf16 v188, v102, s46, v4
v_dot2_f32_bf16 v189, v102, s47, v4
v_dot2_f32_bf16 v190, v103, s46, v4
v_dot2_f32_bf16 v191, v103, s47, v4
s_waitcnt vmcnt(7)
v_dot2_f32_bf16 v184, v104, s46, v184
v_dot2_f32_bf16 v185, v104, s47, v185
v_dot2_f32_bf16 v186, v105, s46, v186
v_dot2_f32_bf16 v187, v105, s47, v187
v_dot2_f32_bf16 v188, v106, s46, v188
v_dot2_f32_bf16 v189, v106, s47, v189
v_dot2_f32_bf16 v190, v107, s46, v190
v_dot2_f32_bf16 v191, v107, s47, v191
s_waitcnt vmcnt(6)
v_dot2_f32_bf16 v184, v108, s46, v184
v_dot2_f32_bf16 v185, v108, s47, v185
v_dot2_f32_bf16 v186, v109, s46, v186
v_dot2_f32_bf16 v187, v109, s47, v187
v_dot2_f32_bf16 v188, v110, s46, v188
v_dot2_f32_bf16 v189, v110, s47, v189
v_dot2_f32_bf16 v190, v111, s46, v190
v_dot2_f32_bf16 v191, v111, s47, v191
s_waitcnt vmcnt(5)
v_dot2_f32_bf16 v184, v112, s46, v184
v_dot2_f32_bf16 v185, v112, s47, v185
v_dot2_f32_bf16 v186, v113, s46, v186
v_dot2_f32_bf16 v187, v113, s47, v187
v_dot2_f32_bf16 v188, v114, s46, v188
v_dot2_f32_bf16 v189, v114, s47, v189
v_dot2_f32_bf16 v190, v115, s46, v190
v_dot2_f32_bf16 v191, v115, s47, v191
s_waitcnt vmcnt(4)
v_dot2_f32_bf16 v184, v116, s46, v184
v_dot2_f32_bf16 v185, v116, s47, v185
v_dot2_f32_bf16 v186, v117, s46, v186
v_dot2_f32_bf16 v187, v117, s47, v187
v_dot2_f32_bf16 v188, v118, s46, v188
v_dot2_f32_bf16 v189, v118, s47, v189
v_dot2_f32_bf16 v190, v119, s46, v190
v_dot2_f32_bf16 v191, v119, s47, v191
s_waitcnt vmcnt(3)
v_dot2_f32_bf16 v184, v120, s46, v184
v_dot2_f32_bf16 v185, v120, s47, v185
v_dot2_f32_bf16 v186, v121, s46, v186
v_dot2_f32_bf16 v187, v121, s47, v187
v_dot2_f32_bf16 v188, v122, s46, v188
v_dot2_f32_bf16 v189, v122, s47, v189
v_dot2_f32_bf16 v190, v123, s46, v190
v_dot2_f32_bf16 v191, v123, s47, v191
s_waitcnt vmcnt(2)
v_dot2_f32_bf16 v184, v124, s46, v184
v_dot2_f32_bf16 v185, v124, s47, v185
v_dot2_f32_bf16 v186, v125, s46, v186
v_dot2_f32_bf16 v187, v125, s47, v187
v_dot2_f32_bf16 v188, v126, s46, v188
v_dot2_f32_bf16 v189, v126, s47, v189
v_dot2_f32_bf16 v190, v127, s46, v190
v_dot2_f32_bf16 v191, v127, s47, v191
s_waitcnt vmcnt(1)
v_dot2_f32_bf16 v184, v128, s46, v184
v_dot2_f32_bf16 v185, v128, s47, v185
v_dot2_f32_bf16 v186, v129, s46, v186
v_dot2_f32_bf16 v187, v129, s47, v187
v_dot2_f32_bf16 v188, v130, s46, v188
v_dot2_f32_bf16 v189, v130, s47, v189
v_dot2_f32_bf16 v190, v131, s46, v190
v_dot2_f32_bf16 v191, v131, s47, v191
s_waitcnt vmcnt(0)
v_dot2_f32_bf16 v184, v132, s46, v184
v_dot2_f32_bf16 v185, v132, s47, v185
v_dot2_f32_bf16 v186, v133, s46, v186
v_dot2_f32_bf16 v187, v133, s47, v187
v_dot2_f32_bf16 v188, v134, s46, v188
v_dot2_f32_bf16 v189, v134, s47, v189
v_dot2_f32_bf16 v190, v135, s46, v190
v_dot2_f32_bf16 v191, v135, s47, v191
s_nop 2
v_cvt_pk_bf16_f32 v204, v184, v185
v_cvt_pk_bf16_f32 v205, v186, v187
v_cvt_pk_bf16_f32 v206, v188, v189
v_cvt_pk_bf16_f32 v207, v190, v191
s_nop 1
v_permlane16_swap_b32 v204, v206
v_permlane16_swap_b32 v205, v207
s_add_u32 s41, s31, 4
s_lshl_b32 s41, s41, 6
buffer_store_dwordx4 v[204:207], v5, s[4:7], s41 offen
L_sequential_preLN__sliding_local_dilated__glu_gated_geglu__prompt_kernel_rend:
L_sequential_preLN__sliding_local_dilated__glu_gated_geglu__prompt_kernel_end:
s_endpgm
L_sequential_preLN__sliding_local_dilated__glu_gated_geglu__prompt_kernel_slowa:
s_mov_b32 s52, 0x8000
L_sequential_preLN__sliding_local_dilated__glu_gated_geglu__prompt_kernel_spina:
s_sleep 2
buffer_load_dword v1, off, s[20:23], s44 sc1
s_waitcnt vmcnt(0)
v_readfirstlane_b32 s50, v1
s_sub_u32 s52, s52, 1
s_cmp_eq_u32 s52, 0
s_cbranch_scc1 L_sequential_preLN__sliding_local_dilated__glu_gated_geglu__prompt_kernel_backa
s_cmp_ge_u32 s50, 3
s_cbranch_scc0 L_sequential_preLN__sliding_local_dilated__glu_gated_geglu__prompt_kernel_spina
s_branch L_sequential_preLN__sliding_local_dilated__glu_gated_geglu__prompt_kernel_backa
L_sequential_preLN__sliding_local_dilated__glu_gated_geglu__prompt_kernel_slowb:
s_mov_b32 s52, 0x8000
L_sequential_preLN__sliding_local_dilated__glu_gated_geglu__prompt_kernel_spinb:
s_sleep 2
buffer_load_dword v1, off, s[20:23], s44 sc1
s_waitcnt vmcnt(0)
v_readfirstlane_b32 s50, v1
s_sub_u32 s52, s52, 1
s_cmp_eq_u32 s52, 0
s_cbranch_scc1 L_sequential_preLN__sliding_local_dilated__glu_gated_geglu__prompt_kernel_backb
s_cmp_ge_u32 s50, 5
s_cbranch_scc0 L_sequential_preLN__sliding_local_dilated__glu_gated_geglu__prompt_kernel_spinb
s_branch L_sequential_preLN__sliding_local_dilated__glu_gated_geglu__prompt_kernel_backb

L_text_end:
.section .rodata,"a"
.p2align 6
.amdhsa_kernel sequential_preLN__sliding_local_dilated__glu_gated_geglu__prompt_kernel
  .amdhsa_next_free_vgpr 512
  .amdhsa_next_free_sgpr 102
  .amdhsa_accum_offset 256
  .amdhsa_group_segment_fixed_size 0
  .amdhsa_kernarg_size 80
  .amdhsa_user_sgpr_count 2
  .amdhsa_user_sgpr_kernarg_segment_ptr 1
  .amdhsa_system_sgpr_workgroup_id_x 1
.end_amdhsa_kernel
```
